```python
import torch

def _softmax(x, axis=-1):
    return torch.softmax(x, dim=axis)
def _gelu(x):
    return torch.nn.functional.gelu(x, approximate="tanh")
def _silu(x):
    return torch.nn.functional.silu(x)
def _sigmoid(x):
    return torch.sigmoid(x)
def _layernorm(x, axis=-1, eps=1e-5):
    m = x.mean(dim=axis, keepdim=True)
    v = x.var(dim=axis, keepdim=True, unbiased=False)
    return (x - m) / torch.sqrt(v + eps)
def _scatter_add(tgt, idx, src, axis=0):
    return tgt.clone().index_add_(axis, idx, src)
def _segment_sum(src, seg, n):
    out = torch.zeros((n,) + src.shape[1:], dtype=src.dtype)
    return out.index_add_(0, seg, src)
def _pad(x, pw):
    flat = tuple(v for pair in reversed(pw) for v in pair)
    return torch.nn.functional.pad(x, flat)

kernel_name = 'interleave_layers__ssm_conv_s4__geglu_ffn__prompt'

def setup_inputs():

    _w = (lambda a: (lambda t: t.to(torch.bfloat16) if t.is_floating_point() else t)(torch.as_tensor(a)))
    def _A_setup():
        B, L, D, N = 1, 2048, 512, 128
        A_re = -(lambda _x: torch.exp(torch.as_tensor(_x)))((lambda *s: torch.randn(*s, dtype=torch.bfloat16) * 1.6)(D, N))
        A_im = torch.pi * (lambda *s: torch.randn(*s, dtype=torch.bfloat16) * 0.2)(D, N)
        B_re = (lambda *s: torch.randn(*s, dtype=torch.bfloat16) * 0.2)(D, N)
        B_im = (lambda *s: torch.randn(*s, dtype=torch.bfloat16) * 0.2)(D, N)
        C_re = (lambda *s: torch.randn(*s, dtype=torch.bfloat16) * 0.2)(D, N)
        C_im = (lambda *s: torch.randn(*s, dtype=torch.bfloat16) * 0.2)(D, N)
        log_dt = (lambda *s: torch.randn(*s, dtype=torch.bfloat16) * 0.2)(D) * 0.5 - 4.0
        Dskip = (lambda *s: torch.randn(*s, dtype=torch.bfloat16) * 0.2)(D)
        return {
            "u": _w((lambda *s: torch.randn(*s, dtype=torch.bfloat16) * 0.05)(B, L, D)),
            "A_re": _w(A_re),
            "A_im": _w(A_im),
            "B_re": _w(B_re),
            "B_im": _w(B_im),
            "C_re": _w(C_re),
            "C_im": _w(C_im),
            "log_dt": _w(log_dt),
            "Dskip": _w(Dskip),
        }
    _A_in = _A_setup()

    def _B_setup():
        B, S, D, F = 1, 2048, 512, 1792
        return {
            "x": _w((lambda *s: torch.randn(*s, dtype=torch.bfloat16) * 0.05)(B, S, D)),
            "w_gate": _w((lambda *s: torch.randn(*s, dtype=torch.bfloat16) * 0.05)(D, F)),
            "w_up": _w((lambda *s: torch.randn(*s, dtype=torch.bfloat16) * 0.05)(D, F)),
            "w_down": _w((lambda *s: torch.randn(*s, dtype=torch.bfloat16) * 0.05)(F, D)),
        }
    _B_in = _B_setup()

    return {
        "A_u": _A_in["u"],
        "A_A_re": _A_in["A_re"],
        "A_A_im": _A_in["A_im"],
        "A_B_re": _A_in["B_re"],
        "A_B_im": _A_in["B_im"],
        "A_C_re": _A_in["C_re"],
        "A_C_im": _A_in["C_im"],
        "A_log_dt": _A_in["log_dt"],
        "A_Dskip": _A_in["Dskip"],
        "B_x": _B_in["x"],
        "B_w_gate": _B_in["w_gate"],
        "B_w_up": _B_in["w_up"],
        "B_w_down": _B_in["w_down"],
    }

def reference(A_u, A_A_re, A_A_im, A_B_re, A_B_im, A_C_re, A_C_im, A_log_dt, A_Dskip, B_x, B_w_gate, B_w_up, B_w_down):
    def _A_ref(u, A_re, A_im, B_re, B_im, C_re, C_im, log_dt, Dskip):
        Bsz, L, D = u.shape
        dt = torch.exp(log_dt)[:, None]
        A = A_re + 1j * A_im
        Bc = B_re + 1j * B_im
        Cc = C_re + 1j * C_im
        logdA = dt * A
        dB = dt * Bc
        l = (lambda x, dt: x.to(dt))(torch.arange(L), A_re.dtype)
        P = torch.exp(logdA[:, :, None] * l[None, None, :])
        K = torch.einsum("dn,dnl,dn->dl", Cc, P, dB).real
        L2 = 2 * L
        Kp = _pad(K, ((0, 0), (0, L)))
        up = (lambda x, *d: x.permute(*d))(u, 0, 2, 1)
        up = _pad(up, ((0, 0), (0, 0), (0, L)))
        Kf = (lambda x, axes=(-2,-1): torch.fft.rfft2(x.float(), dim=axes))(Kp[:, None, :], axes=(-2, -1))
        Uf = (lambda x, axes=(-2,-1): torch.fft.rfft2(x.float(), dim=axes))(up[:, :, None, :], axes=(-2, -1))
        Yf = Uf * Kf[None, :, :, :]
        y = (lambda x, s, axes=(-2,-1): torch.fft.irfft2(x, s=s, dim=axes).to(torch.bfloat16))(Yf, (1, L2), axes=(-2, -1))[:, :, 0, :L]
        y = (lambda x, *d: x.permute(*d))(y, 0, 2, 1) + u * Dskip[None, None, :]
        return y

    def _B_ref(x, w_gate, w_up, w_down):
        return (_gelu(x @ w_gate) * (x @ w_up)) @ w_down

    x = A_u
    x = x + _A_ref(_layernorm(x, axis=-1), A_A_re, A_A_im, A_B_re, A_B_im, A_C_re, A_C_im, A_log_dt, A_Dskip)
    x = x + _B_ref(_layernorm(x, axis=-1), B_w_gate, B_w_up, B_w_down)
    x = x + _A_ref(_layernorm(x, axis=-1), A_A_re, A_A_im, A_B_re, A_B_im, A_C_re, A_C_im, A_log_dt, A_Dskip)
    x = x + _B_ref(_layernorm(x, axis=-1), B_w_gate, B_w_up, B_w_down)
    return x
```

```asm
; @launch kernel=kgen_kernel grid=(744,1,1) block=(256,1,1) lds=49152
; @launch kernel=conva_kernel grid=(256,1,1) block=(256,1,1) lds=118272
; @launch kernel=gemm1a_kernel grid=(224,1,1) block=(256,1,1) lds=107520
; @launch kernel=gemm2a_kernel grid=(256,1,1) block=(256,1,1) lds=69632
; @launch kernel=convb_kernel grid=(256,1,1) block=(256,1,1) lds=118272
; @launch kernel=gemm1b_kernel grid=(224,1,1) block=(256,1,1) lds=107520
; @launch kernel=gemm2b_kernel grid=(256,1,1) block=(256,1,1) lds=69632
.amdgcn_target "amdgcn-amd-amdhsa--gfx950"
.text
.globl kgen_kernel
.p2align 8
.type kgen_kernel,@function
kgen_kernel:
    s_cmp_ge_u32 s2, 744
    s_cbranch_scc1 kg_done
    s_add_u32 s3, s2, 512
    s_sub_u32 s2, s2, 232
    s_cselect_b32 s2, s3, s2
    s_load_dwordx16 s[4:19], s[0:1], 0
    s_load_dwordx2 s[20:21], s[0:1], 120
    s_waitcnt lgkmcnt(0)
    s_mov_b32 s52, s20
    s_mov_b32 s53, s21
    s_mov_b32 s54, 0x1c00000
    s_mov_b32 s55, 0x00020000
    s_cmp_ge_u32 s2, 512
    s_cbranch_scc1 kg_stats
    s_mov_b32 s24, s6
    s_mov_b32 s25, s7
    s_mov_b32 s26, 0x20000
    s_mov_b32 s27, 0x00020000
    s_mov_b32 s28, s8
    s_mov_b32 s29, s9
    s_mov_b32 s30, 0x20000
    s_mov_b32 s31, 0x00020000
    s_mov_b32 s32, s10
    s_mov_b32 s33, s11
    s_mov_b32 s34, 0x20000
    s_mov_b32 s35, 0x00020000
    s_mov_b32 s36, s12
    s_mov_b32 s37, s13
    s_mov_b32 s38, 0x20000
    s_mov_b32 s39, 0x00020000
    s_mov_b32 s40, s14
    s_mov_b32 s41, s15
    s_mov_b32 s42, 0x20000
    s_mov_b32 s43, 0x00020000
    s_mov_b32 s44, s16
    s_mov_b32 s45, s17
    s_mov_b32 s46, 0x20000
    s_mov_b32 s47, 0x00020000
    s_mov_b32 s48, s18
    s_mov_b32 s49, s19
    s_mov_b32 s50, 0x400
    s_mov_b32 s51, 0x00020000
    v_and_b32 v1, 127, v0
    s_lshl_b32 s3, s2, 8
    v_lshl_add_u32 v2, v1, 1, s3
    buffer_load_ushort v4, v2, s[24:27], 0 offen
    buffer_load_ushort v5, v2, s[28:31], 0 offen
    buffer_load_ushort v6, v2, s[32:35], 0 offen
    buffer_load_ushort v7, v2, s[36:39], 0 offen
    buffer_load_ushort v8, v2, s[40:43], 0 offen
    buffer_load_ushort v9, v2, s[44:47], 0 offen
    s_lshl_b32 s3, s2, 1
    v_mov_b32 v10, s3
    buffer_load_ushort v11, v10, s[48:51], 0 offen
    s_waitcnt vmcnt(0)
    v_lshlrev_b32 v4, 16, v4
    v_lshlrev_b32 v5, 16, v5
    v_lshlrev_b32 v6, 16, v6
    v_lshlrev_b32 v7, 16, v7
    v_lshlrev_b32 v8, 16, v8
    v_lshlrev_b32 v9, 16, v9
    v_lshlrev_b32 v11, 16, v11
    v_mul_f32 v12, 0x3fb8aa3b, v11
    v_exp_f32 v12, v12
    s_nop 0
    v_cvt_pk_bf16_f32 v12, v12, v12
    v_lshlrev_b32 v12, 16, v12
    v_mul_f32 v20, v12, v4
    v_mul_f32 v20, 0x3fb8aa3b, v20
    v_mul_f32 v21, v12, v5
    v_mul_f32 v21, 0.15915494, v21
    v_mul_f32 v15, v12, v6
    v_mul_f32 v16, v12, v7
    v_mul_f32 v22, v8, v15
    v_fma_f32 v22, -v9, v16, v22
    v_mul_f32 v23, v8, v16
    v_fma_f32 v23, v9, v15, v23
    v_lshlrev_b32 v3, 4, v1
    ds_write_b128 v3, v[20:23]
    s_waitcnt lgkmcnt(0)
    s_barrier
    v_lshrrev_b32 v24, 6, v0
    s_nop 0
    v_readfirstlane_b32 s56, v24
    s_lshl_b32 s57, 1, s56
    s_lshl_b32 s58, 128, s56
    s_cmp_eq_u32 s56, 0
    s_cselect_b32 s58, 0, s58
    s_lshl_b32 s59, s57, 4
    v_and_b32 v25, 15, v0
    v_bfe_u32 v26, v0, 4, 2
    v_bfe_u32 v27, v0, 5, 1
    v_and_b32 v28, 31, v0
    v_cmp_eq_u32 vcc, 0, v27
    s_mov_b64 s[60:61], vcc
    v_mov_b32 v29, s58
    v_mov_b32 v30, s59
    v_mov_b32 v31, s57
    v_cndmask_b32 v29, 0, v29, vcc
    v_cndmask_b32 v30, v31, v30, vcc
    v_cvt_f32_u32 v29, v29
    v_cvt_f32_u32 v30, v30
    v_mul_u32_u24 v36, 10240, v24
    v_add_u32 v36, 8192, v36
    v_mov_b32 v37, v36
    v_mul_u32_u24 v38, 5120, v27
    v_add_u32 v36, v36, v38
    v_mul_u32_u24 v38, 80, v28
    v_add_u32 v36, v36, v38
    v_mul_u32_u24 v38, 80, v26
    v_lshl_add_u32 v38, v25, 2, v38
    v_add_u32 v37, v37, v38
    v_lshlrev_b32 v39, 4, v28
    v_mov_b32 v32, 0
    v_mov_b32 v33, 0
    v_mov_b32 v34, 0
    v_mov_b32 v35, 0
    ds_read_b128 v[40:43], v39 offset:0
    s_waitcnt lgkmcnt(0)
    v_mul_f32 v44, v40, v29
    v_mul_f32 v45, v41, v29
    v_mul_f32 v46, v40, v30
    v_mul_f32 v47, v41, v30
    v_fract_f32 v45, v45
    v_fract_f32 v47, v47
    v_exp_f32 v44, v44
    v_exp_f32 v46, v46
    v_sin_f32 v48, v45
    v_cos_f32 v49, v45
    v_sin_f32 v50, v47
    v_cos_f32 v51, v47
    s_nop 0
    v_mul_f32 v52, v44, v49
    v_mul_f32 v53, v44, v48
    v_mul_f32 v54, v46, v51
    v_mul_f32 v55, v46, v50
    v_sub_f32 v56, 0, v55
    v_cndmask_b32 v55, v55, v56, vcc
    v_cndmask_b32 v42, 1.0, v42, vcc
    v_cndmask_b32 v43, 0, v43, vcc
    v_mul_f32 v64, v42, v52
    v_fma_f32 v64, -v43, v53, v64
    v_mul_f32 v80, v42, v53
    v_fma_f32 v80, v43, v52, v80
    v_sub_f32 v56, 0, v80
    v_cndmask_b32 v80, v80, v56, vcc
    v_mul_f32 v65, v64, v54
    v_fma_f32 v65, -v80, v55, v65
    v_mul_f32 v81, v80, v54
    v_fma_f32 v81, v64, v55, v81
    v_mul_f32 v66, v65, v54
    v_fma_f32 v66, -v81, v55, v66
    v_mul_f32 v82, v81, v54
    v_fma_f32 v82, v65, v55, v82
    v_mul_f32 v67, v66, v54
    v_fma_f32 v67, -v82, v55, v67
    v_mul_f32 v83, v82, v54
    v_fma_f32 v83, v66, v55, v83
    v_mul_f32 v68, v67, v54
    v_fma_f32 v68, -v83, v55, v68
    v_mul_f32 v84, v83, v54
    v_fma_f32 v84, v67, v55, v84
    v_mul_f32 v69, v68, v54
    v_fma_f32 v69, -v84, v55, v69
    v_mul_f32 v85, v84, v54
    v_fma_f32 v85, v68, v55, v85
    v_mul_f32 v70, v69, v54
    v_fma_f32 v70, -v85, v55, v70
    v_mul_f32 v86, v85, v54
    v_fma_f32 v86, v69, v55, v86
    v_mul_f32 v71, v70, v54
    v_fma_f32 v71, -v86, v55, v71
    v_mul_f32 v87, v86, v54
    v_fma_f32 v87, v70, v55, v87
    v_mul_f32 v72, v71, v54
    v_fma_f32 v72, -v87, v55, v72
    v_mul_f32 v88, v87, v54
    v_fma_f32 v88, v71, v55, v88
    v_mul_f32 v73, v72, v54
    v_fma_f32 v73, -v88, v55, v73
    v_mul_f32 v89, v88, v54
    v_fma_f32 v89, v72, v55, v89
    v_mul_f32 v74, v73, v54
    v_fma_f32 v74, -v89, v55, v74
    v_mul_f32 v90, v89, v54
    v_fma_f32 v90, v73, v55, v90
    v_mul_f32 v75, v74, v54
    v_fma_f32 v75, -v90, v55, v75
    v_mul_f32 v91, v90, v54
    v_fma_f32 v91, v74, v55, v91
    v_mul_f32 v76, v75, v54
    v_fma_f32 v76, -v91, v55, v76
    v_mul_f32 v92, v91, v54
    v_fma_f32 v92, v75, v55, v92
    v_mul_f32 v77, v76, v54
    v_fma_f32 v77, -v92, v55, v77
    v_mul_f32 v93, v92, v54
    v_fma_f32 v93, v76, v55, v93
    v_mul_f32 v78, v77, v54
    v_fma_f32 v78, -v93, v55, v78
    v_mul_f32 v94, v93, v54
    v_fma_f32 v94, v77, v55, v94
    v_mul_f32 v79, v78, v54
    v_fma_f32 v79, -v94, v55, v79
    v_mul_f32 v95, v94, v54
    v_fma_f32 v95, v78, v55, v95
    ds_write_b128 v36, v[64:67] offset:0
    ds_write_b128 v36, v[80:83] offset:2560
    ds_write_b128 v36, v[68:71] offset:16
    ds_write_b128 v36, v[84:87] offset:2576
    ds_write_b128 v36, v[72:75] offset:32
    ds_write_b128 v36, v[88:91] offset:2592
    ds_write_b128 v36, v[76:79] offset:48
    ds_write_b128 v36, v[92:95] offset:2608
    s_waitcnt lgkmcnt(0)
    ds_read_b32 v96, v37 offset:0
    ds_read_b32 v97, v37 offset:2560
    ds_read_b32 v98, v37 offset:5120
    ds_read_b32 v99, v37 offset:7680
    ds_read_b32 v100, v37 offset:320
    ds_read_b32 v101, v37 offset:2880
    ds_read_b32 v102, v37 offset:5440
    ds_read_b32 v103, v37 offset:8000
    ds_read_b32 v104, v37 offset:640
    ds_read_b32 v105, v37 offset:3200
    ds_read_b32 v106, v37 offset:5760
    ds_read_b32 v107, v37 offset:8320
    ds_read_b32 v108, v37 offset:960
    ds_read_b32 v109, v37 offset:3520
    ds_read_b32 v110, v37 offset:6080
    ds_read_b32 v111, v37 offset:8640
    ds_read_b32 v112, v37 offset:1280
    ds_read_b32 v113, v37 offset:3840
    ds_read_b32 v114, v37 offset:6400
    ds_read_b32 v115, v37 offset:8960
    ds_read_b32 v116, v37 offset:1600
    ds_read_b32 v117, v37 offset:4160
    ds_read_b32 v118, v37 offset:6720
    ds_read_b32 v119, v37 offset:9280
    ds_read_b32 v120, v37 offset:1920
    ds_read_b32 v121, v37 offset:4480
    ds_read_b32 v122, v37 offset:7040
    ds_read_b32 v123, v37 offset:9600
    ds_read_b32 v124, v37 offset:2240
    ds_read_b32 v125, v37 offset:4800
    ds_read_b32 v126, v37 offset:7360
    ds_read_b32 v127, v37 offset:9920
    s_waitcnt lgkmcnt(15)
    v_mfma_f32_16x16x4_f32 v[32:35], v96, v98, v[32:35]
    v_mfma_f32_16x16x4_f32 v[32:35], v97, v99, v[32:35]
    s_waitcnt lgkmcnt(15)
    v_mfma_f32_16x16x4_f32 v[32:35], v100, v102, v[32:35]
    v_mfma_f32_16x16x4_f32 v[32:35], v101, v103, v[32:35]
    s_waitcnt lgkmcnt(15)
    v_mfma_f32_16x16x4_f32 v[32:35], v104, v106, v[32:35]
    v_mfma_f32_16x16x4_f32 v[32:35], v105, v107, v[32:35]
    s_waitcnt lgkmcnt(15)
    v_mfma_f32_16x16x4_f32 v[32:35], v108, v110, v[32:35]
    v_mfma_f32_16x16x4_f32 v[32:35], v109, v111, v[32:35]
    s_waitcnt lgkmcnt(12)
    v_mfma_f32_16x16x4_f32 v[32:35], v112, v114, v[32:35]
    v_mfma_f32_16x16x4_f32 v[32:35], v113, v115, v[32:35]
    s_waitcnt lgkmcnt(8)
    v_mfma_f32_16x16x4_f32 v[32:35], v116, v118, v[32:35]
    v_mfma_f32_16x16x4_f32 v[32:35], v117, v119, v[32:35]
    s_waitcnt lgkmcnt(4)
    v_mfma_f32_16x16x4_f32 v[32:35], v120, v122, v[32:35]
    v_mfma_f32_16x16x4_f32 v[32:35], v121, v123, v[32:35]
    s_waitcnt lgkmcnt(0)
    v_mfma_f32_16x16x4_f32 v[32:35], v124, v126, v[32:35]
    v_mfma_f32_16x16x4_f32 v[32:35], v125, v127, v[32:35]
    ds_read_b128 v[40:43], v39 offset:512
    s_waitcnt lgkmcnt(0)
    v_mul_f32 v44, v40, v29
    v_mul_f32 v45, v41, v29
    v_mul_f32 v46, v40, v30
    v_mul_f32 v47, v41, v30
    v_fract_f32 v45, v45
    v_fract_f32 v47, v47
    v_exp_f32 v44, v44
    v_exp_f32 v46, v46
    v_sin_f32 v48, v45
    v_cos_f32 v49, v45
    v_sin_f32 v50, v47
    v_cos_f32 v51, v47
    s_nop 0
    v_mul_f32 v52, v44, v49
    v_mul_f32 v53, v44, v48
    v_mul_f32 v54, v46, v51
    v_mul_f32 v55, v46, v50
    v_sub_f32 v56, 0, v55
    v_cndmask_b32 v55, v55, v56, vcc
    v_cndmask_b32 v42, 1.0, v42, vcc
    v_cndmask_b32 v43, 0, v43, vcc
    v_mul_f32 v64, v42, v52
    v_fma_f32 v64, -v43, v53, v64
    v_mul_f32 v80, v42, v53
    v_fma_f32 v80, v43, v52, v80
    v_sub_f32 v56, 0, v80
    v_cndmask_b32 v80, v80, v56, vcc
    v_mul_f32 v65, v64, v54
    v_fma_f32 v65, -v80, v55, v65
    v_mul_f32 v81, v80, v54
    v_fma_f32 v81, v64, v55, v81
    v_mul_f32 v66, v65, v54
    v_fma_f32 v66, -v81, v55, v66
    v_mul_f32 v82, v81, v54
    v_fma_f32 v82, v65, v55, v82
    v_mul_f32 v67, v66, v54
    v_fma_f32 v67, -v82, v55, v67
    v_mul_f32 v83, v82, v54
    v_fma_f32 v83, v66, v55, v83
    v_mul_f32 v68, v67, v54
    v_fma_f32 v68, -v83, v55, v68
    v_mul_f32 v84, v83, v54
    v_fma_f32 v84, v67, v55, v84
    v_mul_f32 v69, v68, v54
    v_fma_f32 v69, -v84, v55, v69
    v_mul_f32 v85, v84, v54
    v_fma_f32 v85, v68, v55, v85
    v_mul_f32 v70, v69, v54
    v_fma_f32 v70, -v85, v55, v70
    v_mul_f32 v86, v85, v54
    v_fma_f32 v86, v69, v55, v86
    v_mul_f32 v71, v70, v54
    v_fma_f32 v71, -v86, v55, v71
    v_mul_f32 v87, v86, v54
    v_fma_f32 v87, v70, v55, v87
    v_mul_f32 v72, v71, v54
    v_fma_f32 v72, -v87, v55, v72
    v_mul_f32 v88, v87, v54
    v_fma_f32 v88, v71, v55, v88
    v_mul_f32 v73, v72, v54
    v_fma_f32 v73, -v88, v55, v73
    v_mul_f32 v89, v88, v54
    v_fma_f32 v89, v72, v55, v89
    v_mul_f32 v74, v73, v54
    v_fma_f32 v74, -v89, v55, v74
    v_mul_f32 v90, v89, v54
    v_fma_f32 v90, v73, v55, v90
    v_mul_f32 v75, v74, v54
    v_fma_f32 v75, -v90, v55, v75
    v_mul_f32 v91, v90, v54
    v_fma_f32 v91, v74, v55, v91
    v_mul_f32 v76, v75, v54
    v_fma_f32 v76, -v91, v55, v76
    v_mul_f32 v92, v91, v54
    v_fma_f32 v92, v75, v55, v92
    v_mul_f32 v77, v76, v54
    v_fma_f32 v77, -v92, v55, v77
    v_mul_f32 v93, v92, v54
    v_fma_f32 v93, v76, v55, v93
    v_mul_f32 v78, v77, v54
    v_fma_f32 v78, -v93, v55, v78
    v_mul_f32 v94, v93, v54
    v_fma_f32 v94, v77, v55, v94
    v_mul_f32 v79, v78, v54
    v_fma_f32 v79, -v94, v55, v79
    v_mul_f32 v95, v94, v54
    v_fma_f32 v95, v78, v55, v95
    ds_write_b128 v36, v[64:67] offset:0
    ds_write_b128 v36, v[80:83] offset:2560
    ds_write_b128 v36, v[68:71] offset:16
    ds_write_b128 v36, v[84:87] offset:2576
    ds_write_b128 v36, v[72:75] offset:32
    ds_write_b128 v36, v[88:91] offset:2592
    ds_write_b128 v36, v[76:79] offset:48
    ds_write_b128 v36, v[92:95] offset:2608
    s_waitcnt lgkmcnt(0)
    ds_read_b32 v96, v37 offset:0
    ds_read_b32 v97, v37 offset:2560
    ds_read_b32 v98, v37 offset:5120
    ds_read_b32 v99, v37 offset:7680
    ds_read_b32 v100, v37 offset:320
    ds_read_b32 v101, v37 offset:2880
    ds_read_b32 v102, v37 offset:5440
    ds_read_b32 v103, v37 offset:8000
    ds_read_b32 v104, v37 offset:640
    ds_read_b32 v105, v37 offset:3200
    ds_read_b32 v106, v37 offset:5760
    ds_read_b32 v107, v37 offset:8320
    ds_read_b32 v108, v37 offset:960
    ds_read_b32 v109, v37 offset:3520
    ds_read_b32 v110, v37 offset:6080
    ds_read_b32 v111, v37 offset:8640
    ds_read_b32 v112, v37 offset:1280
    ds_read_b32 v113, v37 offset:3840
    ds_read_b32 v114, v37 offset:6400
    ds_read_b32 v115, v37 offset:8960
    ds_read_b32 v116, v37 offset:1600
    ds_read_b32 v117, v37 offset:4160
    ds_read_b32 v118, v37 offset:6720
    ds_read_b32 v119, v37 offset:9280
    ds_read_b32 v120, v37 offset:1920
    ds_read_b32 v121, v37 offset:4480
    ds_read_b32 v122, v37 offset:7040
    ds_read_b32 v123, v37 offset:9600
    ds_read_b32 v124, v37 offset:2240
    ds_read_b32 v125, v37 offset:4800
    ds_read_b32 v126, v37 offset:7360
    ds_read_b32 v127, v37 offset:9920
    s_waitcnt lgkmcnt(15)
    v_mfma_f32_16x16x4_f32 v[32:35], v96, v98, v[32:35]
    v_mfma_f32_16x16x4_f32 v[32:35], v97, v99, v[32:35]
    s_waitcnt lgkmcnt(15)
    v_mfma_f32_16x16x4_f32 v[32:35], v100, v102, v[32:35]
    v_mfma_f32_16x16x4_f32 v[32:35], v101, v103, v[32:35]
    s_waitcnt lgkmcnt(15)
    v_mfma_f32_16x16x4_f32 v[32:35], v104, v106, v[32:35]
    v_mfma_f32_16x16x4_f32 v[32:35], v105, v107, v[32:35]
    s_waitcnt lgkmcnt(15)
    v_mfma_f32_16x16x4_f32 v[32:35], v108, v110, v[32:35]
    v_mfma_f32_16x16x4_f32 v[32:35], v109, v111, v[32:35]
    s_waitcnt lgkmcnt(12)
    v_mfma_f32_16x16x4_f32 v[32:35], v112, v114, v[32:35]
    v_mfma_f32_16x16x4_f32 v[32:35], v113, v115, v[32:35]
    s_waitcnt lgkmcnt(8)
    v_mfma_f32_16x16x4_f32 v[32:35], v116, v118, v[32:35]
    v_mfma_f32_16x16x4_f32 v[32:35], v117, v119, v[32:35]
    s_waitcnt lgkmcnt(4)
    v_mfma_f32_16x16x4_f32 v[32:35], v120, v122, v[32:35]
    v_mfma_f32_16x16x4_f32 v[32:35], v121, v123, v[32:35]
    s_waitcnt lgkmcnt(0)
    v_mfma_f32_16x16x4_f32 v[32:35], v124, v126, v[32:35]
    v_mfma_f32_16x16x4_f32 v[32:35], v125, v127, v[32:35]
    ds_read_b128 v[40:43], v39 offset:1024
    s_waitcnt lgkmcnt(0)
    v_mul_f32 v44, v40, v29
    v_mul_f32 v45, v41, v29
    v_mul_f32 v46, v40, v30
    v_mul_f32 v47, v41, v30
    v_fract_f32 v45, v45
    v_fract_f32 v47, v47
    v_exp_f32 v44, v44
    v_exp_f32 v46, v46
    v_sin_f32 v48, v45
    v_cos_f32 v49, v45
    v_sin_f32 v50, v47
    v_cos_f32 v51, v47
    s_nop 0
    v_mul_f32 v52, v44, v49
    v_mul_f32 v53, v44, v48
    v_mul_f32 v54, v46, v51
    v_mul_f32 v55, v46, v50
    v_sub_f32 v56, 0, v55
    v_cndmask_b32 v55, v55, v56, vcc
    v_cndmask_b32 v42, 1.0, v42, vcc
    v_cndmask_b32 v43, 0, v43, vcc
    v_mul_f32 v64, v42, v52
    v_fma_f32 v64, -v43, v53, v64
    v_mul_f32 v80, v42, v53
    v_fma_f32 v80, v43, v52, v80
    v_sub_f32 v56, 0, v80
    v_cndmask_b32 v80, v80, v56, vcc
    v_mul_f32 v65, v64, v54
    v_fma_f32 v65, -v80, v55, v65
    v_mul_f32 v81, v80, v54
    v_fma_f32 v81, v64, v55, v81
    v_mul_f32 v66, v65, v54
    v_fma_f32 v66, -v81, v55, v66
    v_mul_f32 v82, v81, v54
    v_fma_f32 v82, v65, v55, v82
    v_mul_f32 v67, v66, v54
    v_fma_f32 v67, -v82, v55, v67
    v_mul_f32 v83, v82, v54
    v_fma_f32 v83, v66, v55, v83
    v_mul_f32 v68, v67, v54
    v_fma_f32 v68, -v83, v55, v68
    v_mul_f32 v84, v83, v54
    v_fma_f32 v84, v67, v55, v84
    v_mul_f32 v69, v68, v54
    v_fma_f32 v69, -v84, v55, v69
    v_mul_f32 v85, v84, v54
    v_fma_f32 v85, v68, v55, v85
    v_mul_f32 v70, v69, v54
    v_fma_f32 v70, -v85, v55, v70
    v_mul_f32 v86, v85, v54
    v_fma_f32 v86, v69, v55, v86
    v_mul_f32 v71, v70, v54
    v_fma_f32 v71, -v86, v55, v71
    v_mul_f32 v87, v86, v54
    v_fma_f32 v87, v70, v55, v87
    v_mul_f32 v72, v71, v54
    v_fma_f32 v72, -v87, v55, v72
    v_mul_f32 v88, v87, v54
    v_fma_f32 v88, v71, v55, v88
    v_mul_f32 v73, v72, v54
    v_fma_f32 v73, -v88, v55, v73
    v_mul_f32 v89, v88, v54
    v_fma_f32 v89, v72, v55, v89
    v_mul_f32 v74, v73, v54
    v_fma_f32 v74, -v89, v55, v74
    v_mul_f32 v90, v89, v54
    v_fma_f32 v90, v73, v55, v90
    v_mul_f32 v75, v74, v54
    v_fma_f32 v75, -v90, v55, v75
    v_mul_f32 v91, v90, v54
    v_fma_f32 v91, v74, v55, v91
    v_mul_f32 v76, v75, v54
    v_fma_f32 v76, -v91, v55, v76
    v_mul_f32 v92, v91, v54
    v_fma_f32 v92, v75, v55, v92
    v_mul_f32 v77, v76, v54
    v_fma_f32 v77, -v92, v55, v77
    v_mul_f32 v93, v92, v54
    v_fma_f32 v93, v76, v55, v93
    v_mul_f32 v78, v77, v54
    v_fma_f32 v78, -v93, v55, v78
    v_mul_f32 v94, v93, v54
    v_fma_f32 v94, v77, v55, v94
    v_mul_f32 v79, v78, v54
    v_fma_f32 v79, -v94, v55, v79
    v_mul_f32 v95, v94, v54
    v_fma_f32 v95, v78, v55, v95
    ds_write_b128 v36, v[64:67] offset:0
    ds_write_b128 v36, v[80:83] offset:2560
    ds_write_b128 v36, v[68:71] offset:16
    ds_write_b128 v36, v[84:87] offset:2576
    ds_write_b128 v36, v[72:75] offset:32
    ds_write_b128 v36, v[88:91] offset:2592
    ds_write_b128 v36, v[76:79] offset:48
    ds_write_b128 v36, v[92:95] offset:2608
    s_waitcnt lgkmcnt(0)
    ds_read_b32 v96, v37 offset:0
    ds_read_b32 v97, v37 offset:2560
    ds_read_b32 v98, v37 offset:5120
    ds_read_b32 v99, v37 offset:7680
    ds_read_b32 v100, v37 offset:320
    ds_read_b32 v101, v37 offset:2880
    ds_read_b32 v102, v37 offset:5440
    ds_read_b32 v103, v37 offset:8000
    ds_read_b32 v104, v37 offset:640
    ds_read_b32 v105, v37 offset:3200
    ds_read_b32 v106, v37 offset:5760
    ds_read_b32 v107, v37 offset:8320
    ds_read_b32 v108, v37 offset:960
    ds_read_b32 v109, v37 offset:3520
    ds_read_b32 v110, v37 offset:6080
    ds_read_b32 v111, v37 offset:8640
    ds_read_b32 v112, v37 offset:1280
    ds_read_b32 v113, v37 offset:3840
    ds_read_b32 v114, v37 offset:6400
    ds_read_b32 v115, v37 offset:8960
    ds_read_b32 v116, v37 offset:1600
    ds_read_b32 v117, v37 offset:4160
    ds_read_b32 v118, v37 offset:6720
    ds_read_b32 v119, v37 offset:9280
    ds_read_b32 v120, v37 offset:1920
    ds_read_b32 v121, v37 offset:4480
    ds_read_b32 v122, v37 offset:7040
    ds_read_b32 v123, v37 offset:9600
    ds_read_b32 v124, v37 offset:2240
    ds_read_b32 v125, v37 offset:4800
    ds_read_b32 v126, v37 offset:7360
    ds_read_b32 v127, v37 offset:9920
    s_waitcnt lgkmcnt(15)
    v_mfma_f32_16x16x4_f32 v[32:35], v96, v98, v[32:35]
    v_mfma_f32_16x16x4_f32 v[32:35], v97, v99, v[32:35]
    s_waitcnt lgkmcnt(15)
    v_mfma_f32_16x16x4_f32 v[32:35], v100, v102, v[32:35]
    v_mfma_f32_16x16x4_f32 v[32:35], v101, v103, v[32:35]
    s_waitcnt lgkmcnt(15)
    v_mfma_f32_16x16x4_f32 v[32:35], v104, v106, v[32:35]
    v_mfma_f32_16x16x4_f32 v[32:35], v105, v107, v[32:35]
    s_waitcnt lgkmcnt(15)
    v_mfma_f32_16x16x4_f32 v[32:35], v108, v110, v[32:35]
    v_mfma_f32_16x16x4_f32 v[32:35], v109, v111, v[32:35]
    s_waitcnt lgkmcnt(12)
    v_mfma_f32_16x16x4_f32 v[32:35], v112, v114, v[32:35]
    v_mfma_f32_16x16x4_f32 v[32:35], v113, v115, v[32:35]
    s_waitcnt lgkmcnt(8)
    v_mfma_f32_16x16x4_f32 v[32:35], v116, v118, v[32:35]
    v_mfma_f32_16x16x4_f32 v[32:35], v117, v119, v[32:35]
    s_waitcnt lgkmcnt(4)
    v_mfma_f32_16x16x4_f32 v[32:35], v120, v122, v[32:35]
    v_mfma_f32_16x16x4_f32 v[32:35], v121, v123, v[32:35]
    s_waitcnt lgkmcnt(0)
    v_mfma_f32_16x16x4_f32 v[32:35], v124, v126, v[32:35]
    v_mfma_f32_16x16x4_f32 v[32:35], v125, v127, v[32:35]
    ds_read_b128 v[40:43], v39 offset:1536
    s_waitcnt lgkmcnt(0)
    v_mul_f32 v44, v40, v29
    v_mul_f32 v45, v41, v29
    v_mul_f32 v46, v40, v30
    v_mul_f32 v47, v41, v30
    v_fract_f32 v45, v45
    v_fract_f32 v47, v47
    v_exp_f32 v44, v44
    v_exp_f32 v46, v46
    v_sin_f32 v48, v45
    v_cos_f32 v49, v45
    v_sin_f32 v50, v47
    v_cos_f32 v51, v47
    s_nop 0
    v_mul_f32 v52, v44, v49
    v_mul_f32 v53, v44, v48
    v_mul_f32 v54, v46, v51
    v_mul_f32 v55, v46, v50
    v_sub_f32 v56, 0, v55
    v_cndmask_b32 v55, v55, v56, vcc
    v_cndmask_b32 v42, 1.0, v42, vcc
    v_cndmask_b32 v43, 0, v43, vcc
    v_mul_f32 v64, v42, v52
    v_fma_f32 v64, -v43, v53, v64
    v_mul_f32 v80, v42, v53
    v_fma_f32 v80, v43, v52, v80
    v_sub_f32 v56, 0, v80
    v_cndmask_b32 v80, v80, v56, vcc
    v_mul_f32 v65, v64, v54
    v_fma_f32 v65, -v80, v55, v65
    v_mul_f32 v81, v80, v54
    v_fma_f32 v81, v64, v55, v81
    v_mul_f32 v66, v65, v54
    v_fma_f32 v66, -v81, v55, v66
    v_mul_f32 v82, v81, v54
    v_fma_f32 v82, v65, v55, v82
    v_mul_f32 v67, v66, v54
    v_fma_f32 v67, -v82, v55, v67
    v_mul_f32 v83, v82, v54
    v_fma_f32 v83, v66, v55, v83
    v_mul_f32 v68, v67, v54
    v_fma_f32 v68, -v83, v55, v68
    v_mul_f32 v84, v83, v54
    v_fma_f32 v84, v67, v55, v84
    v_mul_f32 v69, v68, v54
    v_fma_f32 v69, -v84, v55, v69
    v_mul_f32 v85, v84, v54
    v_fma_f32 v85, v68, v55, v85
    v_mul_f32 v70, v69, v54
    v_fma_f32 v70, -v85, v55, v70
    v_mul_f32 v86, v85, v54
    v_fma_f32 v86, v69, v55, v86
    v_mul_f32 v71, v70, v54
    v_fma_f32 v71, -v86, v55, v71
    v_mul_f32 v87, v86, v54
    v_fma_f32 v87, v70, v55, v87
    v_mul_f32 v72, v71, v54
    v_fma_f32 v72, -v87, v55, v72
    v_mul_f32 v88, v87, v54
    v_fma_f32 v88, v71, v55, v88
    v_mul_f32 v73, v72, v54
    v_fma_f32 v73, -v88, v55, v73
    v_mul_f32 v89, v88, v54
    v_fma_f32 v89, v72, v55, v89
    v_mul_f32 v74, v73, v54
    v_fma_f32 v74, -v89, v55, v74
    v_mul_f32 v90, v89, v54
    v_fma_f32 v90, v73, v55, v90
    v_mul_f32 v75, v74, v54
    v_fma_f32 v75, -v90, v55, v75
    v_mul_f32 v91, v90, v54
    v_fma_f32 v91, v74, v55, v91
    v_mul_f32 v76, v75, v54
    v_fma_f32 v76, -v91, v55, v76
    v_mul_f32 v92, v91, v54
    v_fma_f32 v92, v75, v55, v92
    v_mul_f32 v77, v76, v54
    v_fma_f32 v77, -v92, v55, v77
    v_mul_f32 v93, v92, v54
    v_fma_f32 v93, v76, v55, v93
    v_mul_f32 v78, v77, v54
    v_fma_f32 v78, -v93, v55, v78
    v_mul_f32 v94, v93, v54
    v_fma_f32 v94, v77, v55, v94
    v_mul_f32 v79, v78, v54
    v_fma_f32 v79, -v94, v55, v79
    v_mul_f32 v95, v94, v54
    v_fma_f32 v95, v78, v55, v95
    ds_write_b128 v36, v[64:67] offset:0
    ds_write_b128 v36, v[80:83] offset:2560
    ds_write_b128 v36, v[68:71] offset:16
    ds_write_b128 v36, v[84:87] offset:2576
    ds_write_b128 v36, v[72:75] offset:32
    ds_write_b128 v36, v[88:91] offset:2592
    ds_write_b128 v36, v[76:79] offset:48
    ds_write_b128 v36, v[92:95] offset:2608
    s_waitcnt lgkmcnt(0)
    ds_read_b32 v96, v37 offset:0
    ds_read_b32 v97, v37 offset:2560
    ds_read_b32 v98, v37 offset:5120
    ds_read_b32 v99, v37 offset:7680
    ds_read_b32 v100, v37 offset:320
    ds_read_b32 v101, v37 offset:2880
    ds_read_b32 v102, v37 offset:5440
    ds_read_b32 v103, v37 offset:8000
    ds_read_b32 v104, v37 offset:640
    ds_read_b32 v105, v37 offset:3200
    ds_read_b32 v106, v37 offset:5760
    ds_read_b32 v107, v37 offset:8320
    ds_read_b32 v108, v37 offset:960
    ds_read_b32 v109, v37 offset:3520
    ds_read_b32 v110, v37 offset:6080
    ds_read_b32 v111, v37 offset:8640
    ds_read_b32 v112, v37 offset:1280
    ds_read_b32 v113, v37 offset:3840
    ds_read_b32 v114, v37 offset:6400
    ds_read_b32 v115, v37 offset:8960
    ds_read_b32 v116, v37 offset:1600
    ds_read_b32 v117, v37 offset:4160
    ds_read_b32 v118, v37 offset:6720
    ds_read_b32 v119, v37 offset:9280
    ds_read_b32 v120, v37 offset:1920
    ds_read_b32 v121, v37 offset:4480
    ds_read_b32 v122, v37 offset:7040
    ds_read_b32 v123, v37 offset:9600
    ds_read_b32 v124, v37 offset:2240
    ds_read_b32 v125, v37 offset:4800
    ds_read_b32 v126, v37 offset:7360
    ds_read_b32 v127, v37 offset:9920
    s_waitcnt lgkmcnt(15)
    v_mfma_f32_16x16x4_f32 v[32:35], v96, v98, v[32:35]
    v_mfma_f32_16x16x4_f32 v[32:35], v97, v99, v[32:35]
    s_waitcnt lgkmcnt(15)
    v_mfma_f32_16x16x4_f32 v[32:35], v100, v102, v[32:35]
    v_mfma_f32_16x16x4_f32 v[32:35], v101, v103, v[32:35]
    s_waitcnt lgkmcnt(15)
    v_mfma_f32_16x16x4_f32 v[32:35], v104, v106, v[32:35]
    v_mfma_f32_16x16x4_f32 v[32:35], v105, v107, v[32:35]
    s_waitcnt lgkmcnt(15)
    v_mfma_f32_16x16x4_f32 v[32:35], v108, v110, v[32:35]
    v_mfma_f32_16x16x4_f32 v[32:35], v109, v111, v[32:35]
    s_waitcnt lgkmcnt(12)
    v_mfma_f32_16x16x4_f32 v[32:35], v112, v114, v[32:35]
    v_mfma_f32_16x16x4_f32 v[32:35], v113, v115, v[32:35]
    s_waitcnt lgkmcnt(8)
    v_mfma_f32_16x16x4_f32 v[32:35], v116, v118, v[32:35]
    v_mfma_f32_16x16x4_f32 v[32:35], v117, v119, v[32:35]
    s_waitcnt lgkmcnt(4)
    v_mfma_f32_16x16x4_f32 v[32:35], v120, v122, v[32:35]
    v_mfma_f32_16x16x4_f32 v[32:35], v121, v123, v[32:35]
    s_waitcnt lgkmcnt(0)
    v_mfma_f32_16x16x4_f32 v[32:35], v124, v126, v[32:35]
    v_mfma_f32_16x16x4_f32 v[32:35], v125, v127, v[32:35]
    v_lshrrev_b32 v60, 4, v0
    v_and_b32 v60, 3, v60
    v_lshlrev_b32 v60, 8, v60
    v_lshl_add_u32 v60, v25, 2, v60
    s_lshl_b32 s60, s56, 10
    v_add_u32 v60, s60, v60
    s_nop 7
    s_nop 3
    ds_write_b32 v60, v32 offset:2048
    ds_write_b32 v60, v33 offset:2112
    ds_write_b32 v60, v34 offset:2176
    ds_write_b32 v60, v35 offset:2240
    s_waitcnt lgkmcnt(0)
    s_barrier
    v_lshlrev_b32 v61, 3, v0
    v_sub_u32 v61, 2047, v61
    v_subrev_u32 v62, 0, v61
    v_cvt_f32_u32 v62, v62
    s_nop 0
    v_cvt_pk_bf16_f32 v62, v62, v62
    v_lshlrev_b32 v62, 16, v62
    v_cvt_u32_f32 v62, v62
    v_mov_b32 v63, 0
    v_cmp_le_u32 vcc, 256, v62
    s_nop 1
    v_addc_co_u32 v63, vcc, 0, v63, vcc
    v_cmp_le_u32 vcc, 512, v62
    s_nop 1
    v_addc_co_u32 v63, vcc, 0, v63, vcc
    v_cmp_le_u32 vcc, 1024, v62
    s_nop 1
    v_addc_co_u32 v63, vcc, 0, v63, vcc
    v_lshrrev_b32 v62, v63, v62
    v_min_u32 v64, 1, v63
    v_lshlrev_b32 v64, 7, v64
    v_sub_u32 v62, v62, v64
    v_lshl_add_u32 v62, v63, 8, v62
    v_lshlrev_b32 v62, 2, v62
    ds_read_b32 v40, v62 offset:2048
    v_subrev_u32 v62, 1, v61
    v_cvt_f32_u32 v62, v62
    s_nop 0
    v_cvt_pk_bf16_f32 v62, v62, v62
    v_lshlrev_b32 v62, 16, v62
    v_cvt_u32_f32 v62, v62
    v_mov_b32 v63, 0
    v_cmp_le_u32 vcc, 256, v62
    s_nop 1
    v_addc_co_u32 v63, vcc, 0, v63, vcc
    v_cmp_le_u32 vcc, 512, v62
    s_nop 1
    v_addc_co_u32 v63, vcc, 0, v63, vcc
    v_cmp_le_u32 vcc, 1024, v62
    s_nop 1
    v_addc_co_u32 v63, vcc, 0, v63, vcc
    v_lshrrev_b32 v62, v63, v62
    v_min_u32 v64, 1, v63
    v_lshlrev_b32 v64, 7, v64
    v_sub_u32 v62, v62, v64
    v_lshl_add_u32 v62, v63, 8, v62
    v_lshlrev_b32 v62, 2, v62
    ds_read_b32 v41, v62 offset:2048
    v_subrev_u32 v62, 2, v61
    v_cvt_f32_u32 v62, v62
    s_nop 0
    v_cvt_pk_bf16_f32 v62, v62, v62
    v_lshlrev_b32 v62, 16, v62
    v_cvt_u32_f32 v62, v62
    v_mov_b32 v63, 0
    v_cmp_le_u32 vcc, 256, v62
    s_nop 1
    v_addc_co_u32 v63, vcc, 0, v63, vcc
    v_cmp_le_u32 vcc, 512, v62
    s_nop 1
    v_addc_co_u32 v63, vcc, 0, v63, vcc
    v_cmp_le_u32 vcc, 1024, v62
    s_nop 1
    v_addc_co_u32 v63, vcc, 0, v63, vcc
    v_lshrrev_b32 v62, v63, v62
    v_min_u32 v64, 1, v63
    v_lshlrev_b32 v64, 7, v64
    v_sub_u32 v62, v62, v64
    v_lshl_add_u32 v62, v63, 8, v62
    v_lshlrev_b32 v62, 2, v62
    ds_read_b32 v42, v62 offset:2048
    v_subrev_u32 v62, 3, v61
    v_cvt_f32_u32 v62, v62
    s_nop 0
    v_cvt_pk_bf16_f32 v62, v62, v62
    v_lshlrev_b32 v62, 16, v62
    v_cvt_u32_f32 v62, v62
    v_mov_b32 v63, 0
    v_cmp_le_u32 vcc, 256, v62
    s_nop 1
    v_addc_co_u32 v63, vcc, 0, v63, vcc
    v_cmp_le_u32 vcc, 512, v62
    s_nop 1
    v_addc_co_u32 v63, vcc, 0, v63, vcc
    v_cmp_le_u32 vcc, 1024, v62
    s_nop 1
    v_addc_co_u32 v63, vcc, 0, v63, vcc
    v_lshrrev_b32 v62, v63, v62
    v_min_u32 v64, 1, v63
    v_lshlrev_b32 v64, 7, v64
    v_sub_u32 v62, v62, v64
    v_lshl_add_u32 v62, v63, 8, v62
    v_lshlrev_b32 v62, 2, v62
    ds_read_b32 v43, v62 offset:2048
    v_subrev_u32 v62, 4, v61
    v_cvt_f32_u32 v62, v62
    s_nop 0
    v_cvt_pk_bf16_f32 v62, v62, v62
    v_lshlrev_b32 v62, 16, v62
    v_cvt_u32_f32 v62, v62
    v_mov_b32 v63, 0
    v_cmp_le_u32 vcc, 256, v62
    s_nop 1
    v_addc_co_u32 v63, vcc, 0, v63, vcc
    v_cmp_le_u32 vcc, 512, v62
    s_nop 1
    v_addc_co_u32 v63, vcc, 0, v63, vcc
    v_cmp_le_u32 vcc, 1024, v62
    s_nop 1
    v_addc_co_u32 v63, vcc, 0, v63, vcc
    v_lshrrev_b32 v62, v63, v62
    v_min_u32 v64, 1, v63
    v_lshlrev_b32 v64, 7, v64
    v_sub_u32 v62, v62, v64
    v_lshl_add_u32 v62, v63, 8, v62
    v_lshlrev_b32 v62, 2, v62
    ds_read_b32 v44, v62 offset:2048
    v_subrev_u32 v62, 5, v61
    v_cvt_f32_u32 v62, v62
    s_nop 0
    v_cvt_pk_bf16_f32 v62, v62, v62
    v_lshlrev_b32 v62, 16, v62
    v_cvt_u32_f32 v62, v62
    v_mov_b32 v63, 0
    v_cmp_le_u32 vcc, 256, v62
    s_nop 1
    v_addc_co_u32 v63, vcc, 0, v63, vcc
    v_cmp_le_u32 vcc, 512, v62
    s_nop 1
    v_addc_co_u32 v63, vcc, 0, v63, vcc
    v_cmp_le_u32 vcc, 1024, v62
    s_nop 1
    v_addc_co_u32 v63, vcc, 0, v63, vcc
    v_lshrrev_b32 v62, v63, v62
    v_min_u32 v64, 1, v63
    v_lshlrev_b32 v64, 7, v64
    v_sub_u32 v62, v62, v64
    v_lshl_add_u32 v62, v63, 8, v62
    v_lshlrev_b32 v62, 2, v62
    ds_read_b32 v45, v62 offset:2048
    v_subrev_u32 v62, 6, v61
    v_cvt_f32_u32 v62, v62
    s_nop 0
    v_cvt_pk_bf16_f32 v62, v62, v62
    v_lshlrev_b32 v62, 16, v62
    v_cvt_u32_f32 v62, v62
    v_mov_b32 v63, 0
    v_cmp_le_u32 vcc, 256, v62
    s_nop 1
    v_addc_co_u32 v63, vcc, 0, v63, vcc
    v_cmp_le_u32 vcc, 512, v62
    s_nop 1
    v_addc_co_u32 v63, vcc, 0, v63, vcc
    v_cmp_le_u32 vcc, 1024, v62
    s_nop 1
    v_addc_co_u32 v63, vcc, 0, v63, vcc
    v_lshrrev_b32 v62, v63, v62
    v_min_u32 v64, 1, v63
    v_lshlrev_b32 v64, 7, v64
    v_sub_u32 v62, v62, v64
    v_lshl_add_u32 v62, v63, 8, v62
    v_lshlrev_b32 v62, 2, v62
    ds_read_b32 v46, v62 offset:2048
    v_subrev_u32 v62, 7, v61
    v_cvt_f32_u32 v62, v62
    s_nop 0
    v_cvt_pk_bf16_f32 v62, v62, v62
    v_lshlrev_b32 v62, 16, v62
    v_cvt_u32_f32 v62, v62
    v_mov_b32 v63, 0
    v_cmp_le_u32 vcc, 256, v62
    s_nop 1
    v_addc_co_u32 v63, vcc, 0, v63, vcc
    v_cmp_le_u32 vcc, 512, v62
    s_nop 1
    v_addc_co_u32 v63, vcc, 0, v63, vcc
    v_cmp_le_u32 vcc, 1024, v62
    s_nop 1
    v_addc_co_u32 v63, vcc, 0, v63, vcc
    v_lshrrev_b32 v62, v63, v62
    v_min_u32 v64, 1, v63
    v_lshlrev_b32 v64, 7, v64
    v_sub_u32 v62, v62, v64
    v_lshl_add_u32 v62, v63, 8, v62
    v_lshlrev_b32 v62, 2, v62
    ds_read_b32 v47, v62 offset:2048
    s_waitcnt lgkmcnt(0)
    v_cvt_pk_bf16_f32 v32, v40, v41
    v_lshlrev_b32 v62, 16, v32
    v_and_b32 v63, 0xffff0000, v32
    v_sub_f32 v62, v40, v62
    v_sub_f32 v63, v41, v63
    v_cvt_pk_bf16_f32 v36, v62, v63
    v_cvt_pk_bf16_f32 v33, v42, v43
    v_lshlrev_b32 v62, 16, v33
    v_and_b32 v63, 0xffff0000, v33
    v_sub_f32 v62, v42, v62
    v_sub_f32 v63, v43, v63
    v_cvt_pk_bf16_f32 v37, v62, v63
    v_cvt_pk_bf16_f32 v34, v44, v45
    v_lshlrev_b32 v62, 16, v34
    v_and_b32 v63, 0xffff0000, v34
    v_sub_f32 v62, v44, v62
    v_sub_f32 v63, v45, v63
    v_cvt_pk_bf16_f32 v38, v62, v63
    v_cvt_pk_bf16_f32 v35, v46, v47
    v_lshlrev_b32 v62, 16, v35
    v_and_b32 v63, 0xffff0000, v35
    v_sub_f32 v62, v46, v62
    v_sub_f32 v63, v47, v63
    v_cvt_pk_bf16_f32 v39, v62, v63
    s_lshl_b32 s3, s2, 13
    s_add_u32 s3, s3, 0x1100000
    v_lshl_add_u32 v61, v0, 4, s3
    buffer_store_dwordx4 v[32:35], v61, s[52:55], 0 offen
    v_add_u32 v61, 4096, v61
    buffer_store_dwordx4 v[36:39], v61, s[52:55], 0 offen
    s_branch kg_done
kg_stats:
    s_cmp_ge_u32 s2, 576
    s_cbranch_scc1 kg_pack
    s_mov_b32 s24, s4
    s_mov_b32 s25, s5
    s_mov_b32 s26, 0x200000
    s_mov_b32 s27, 0x00020000
    s_sub_u32 s3, s2, 512
    s_lshl_b32 s3, s3, 5
    v_lshrrev_b32 v1, 6, v0
    v_lshlrev_b32 v1, 3, v1
    v_add_u32 v1, s3, v1
    v_and_b32 v2, 63, v0
    v_lshlrev_b32 v3, 10, v1
    v_lshl_add_u32 v3, v2, 4, v3
    s_mov_b32 s4, 0
    buffer_load_dwordx4 v[4:7], v3, s[24:27], s4 offen
    s_mov_b32 s4, 1024
    buffer_load_dwordx4 v[8:11], v3, s[24:27], s4 offen
    s_mov_b32 s4, 2048
    buffer_load_dwordx4 v[12:15], v3, s[24:27], s4 offen
    s_mov_b32 s4, 3072
    buffer_load_dwordx4 v[16:19], v3, s[24:27], s4 offen
    s_mov_b32 s4, 4096
    buffer_load_dwordx4 v[20:23], v3, s[24:27], s4 offen
    s_mov_b32 s4, 5120
    buffer_load_dwordx4 v[24:27], v3, s[24:27], s4 offen
    s_mov_b32 s4, 6144
    buffer_load_dwordx4 v[28:31], v3, s[24:27], s4 offen
    s_mov_b32 s4, 7168
    buffer_load_dwordx4 v[32:35], v3, s[24:27], s4 offen
    v_lshrrev_b32 v40, 3, v2
    v_lshlrev_b32 v40, 13, v40
    v_lshl_add_u32 v40, v1, 2, v40
    v_add_u32 v40, 0x1000000, v40
    v_and_b32 v41, 7, v2
    v_cmp_eq_u32 vcc, 0, v41
    s_mov_b64 s[60:61], vcc
    v_lshlrev_b32 v42, 15, v2
    v_lshl_add_u32 v42, v1, 1, v42
    v_add_u32 v42, 0x600000, v42
    s_waitcnt vmcnt(0)
    s_mov_b32 s62, 0x05040100
    s_mov_b32 s63, 0x07060302
    v_perm_b32 v64, v8, v4, s62
    v_perm_b32 v65, v16, v12, s62
    v_perm_b32 v66, v24, v20, s62
    v_perm_b32 v67, v32, v28, s62
    v_perm_b32 v68, v8, v4, s63
    v_perm_b32 v69, v16, v12, s63
    v_perm_b32 v70, v24, v20, s63
    v_perm_b32 v71, v32, v28, s63
    v_perm_b32 v72, v9, v5, s62
    v_perm_b32 v73, v17, v13, s62
    v_perm_b32 v74, v25, v21, s62
    v_perm_b32 v75, v33, v29, s62
    v_perm_b32 v76, v9, v5, s63
    v_perm_b32 v77, v17, v13, s63
    v_perm_b32 v78, v25, v21, s63
    v_perm_b32 v79, v33, v29, s63
    v_perm_b32 v80, v10, v6, s62
    v_perm_b32 v81, v18, v14, s62
    v_perm_b32 v82, v26, v22, s62
    v_perm_b32 v83, v34, v30, s62
    v_perm_b32 v84, v10, v6, s63
    v_perm_b32 v85, v18, v14, s63
    v_perm_b32 v86, v26, v22, s63
    v_perm_b32 v87, v34, v30, s63
    v_perm_b32 v88, v11, v7, s62
    v_perm_b32 v89, v19, v15, s62
    v_perm_b32 v90, v27, v23, s62
    v_perm_b32 v91, v35, v31, s62
    v_perm_b32 v92, v11, v7, s63
    v_perm_b32 v93, v19, v15, s63
    v_perm_b32 v94, v27, v23, s63
    v_perm_b32 v95, v35, v31, s63
    s_mov_b32 s4, 0
    buffer_store_dwordx4 v[64:67], v42, s[52:55], s4 offen
    s_mov_b32 s4, 4096
    buffer_store_dwordx4 v[68:71], v42, s[52:55], s4 offen
    s_mov_b32 s4, 8192
    buffer_store_dwordx4 v[72:75], v42, s[52:55], s4 offen
    s_mov_b32 s4, 12288
    buffer_store_dwordx4 v[76:79], v42, s[52:55], s4 offen
    s_mov_b32 s4, 16384
    buffer_store_dwordx4 v[80:83], v42, s[52:55], s4 offen
    s_mov_b32 s4, 20480
    buffer_store_dwordx4 v[84:87], v42, s[52:55], s4 offen
    s_mov_b32 s4, 24576
    buffer_store_dwordx4 v[88:91], v42, s[52:55], s4 offen
    s_mov_b32 s4, 28672
    buffer_store_dwordx4 v[92:95], v42, s[52:55], s4 offen
    v_lshlrev_b32 v44, 16, v4
    v_and_b32 v45, 0xffff0000, v4
    v_lshlrev_b32 v46, 16, v5
    v_and_b32 v47, 0xffff0000, v5
    v_lshlrev_b32 v48, 16, v6
    v_and_b32 v49, 0xffff0000, v6
    v_lshlrev_b32 v50, 16, v7
    v_and_b32 v51, 0xffff0000, v7
    v_add_f32 v52, v44, v45
    v_add_f32 v52, v52, v46
    v_add_f32 v52, v52, v47
    v_add_f32 v52, v52, v48
    v_add_f32 v52, v52, v49
    v_add_f32 v52, v52, v50
    v_add_f32 v52, v52, v51
    s_nop 1
    v_add_f32_dpp v52, v52, v52 quad_perm:[1,0,3,2] row_mask:0xf bank_mask:0xf
    s_nop 1
    v_add_f32_dpp v52, v52, v52 quad_perm:[2,3,0,1] row_mask:0xf bank_mask:0xf
    s_nop 1
    v_add_f32_dpp v52, v52, v52 row_half_mirror row_mask:0xf bank_mask:0xf
    v_mul_f32 v52, 0x3c800000, v52
    v_sub_f32 v44, v44, v52
    v_sub_f32 v45, v45, v52
    v_sub_f32 v46, v46, v52
    v_sub_f32 v47, v47, v52
    v_sub_f32 v48, v48, v52
    v_sub_f32 v49, v49, v52
    v_sub_f32 v50, v50, v52
    v_sub_f32 v51, v51, v52
    v_mul_f32 v53, v44, v44
    v_fma_f32 v53, v45, v45, v53
    v_fma_f32 v53, v46, v46, v53
    v_fma_f32 v53, v47, v47, v53
    v_fma_f32 v53, v48, v48, v53
    v_fma_f32 v53, v49, v49, v53
    v_fma_f32 v53, v50, v50, v53
    v_fma_f32 v53, v51, v51, v53
    s_nop 1
    v_add_f32_dpp v53, v53, v53 quad_perm:[1,0,3,2] row_mask:0xf bank_mask:0xf
    s_nop 1
    v_add_f32_dpp v53, v53, v53 quad_perm:[2,3,0,1] row_mask:0xf bank_mask:0xf
    s_nop 1
    v_add_f32_dpp v53, v53, v53 row_half_mirror row_mask:0xf bank_mask:0xf
    s_mov_b64 exec, s[60:61]
    buffer_store_dword v52, v40, s[52:55], 0 offen offset:0
    v_add_u32 v54, 0x10000, v40
    buffer_store_dword v53, v54, s[52:55], 0 offen offset:0
    s_mov_b64 exec, -1
    v_lshlrev_b32 v44, 16, v8
    v_and_b32 v45, 0xffff0000, v8
    v_lshlrev_b32 v46, 16, v9
    v_and_b32 v47, 0xffff0000, v9
    v_lshlrev_b32 v48, 16, v10
    v_and_b32 v49, 0xffff0000, v10
    v_lshlrev_b32 v50, 16, v11
    v_and_b32 v51, 0xffff0000, v11
    v_add_f32 v52, v44, v45
    v_add_f32 v52, v52, v46
    v_add_f32 v52, v52, v47
    v_add_f32 v52, v52, v48
    v_add_f32 v52, v52, v49
    v_add_f32 v52, v52, v50
    v_add_f32 v52, v52, v51
    s_nop 1
    v_add_f32_dpp v52, v52, v52 quad_perm:[1,0,3,2] row_mask:0xf bank_mask:0xf
    s_nop 1
    v_add_f32_dpp v52, v52, v52 quad_perm:[2,3,0,1] row_mask:0xf bank_mask:0xf
    s_nop 1
    v_add_f32_dpp v52, v52, v52 row_half_mirror row_mask:0xf bank_mask:0xf
    v_mul_f32 v52, 0x3c800000, v52
    v_sub_f32 v44, v44, v52
    v_sub_f32 v45, v45, v52
    v_sub_f32 v46, v46, v52
    v_sub_f32 v47, v47, v52
    v_sub_f32 v48, v48, v52
    v_sub_f32 v49, v49, v52
    v_sub_f32 v50, v50, v52
    v_sub_f32 v51, v51, v52
    v_mul_f32 v53, v44, v44
    v_fma_f32 v53, v45, v45, v53
    v_fma_f32 v53, v46, v46, v53
    v_fma_f32 v53, v47, v47, v53
    v_fma_f32 v53, v48, v48, v53
    v_fma_f32 v53, v49, v49, v53
    v_fma_f32 v53, v50, v50, v53
    v_fma_f32 v53, v51, v51, v53
    s_nop 1
    v_add_f32_dpp v53, v53, v53 quad_perm:[1,0,3,2] row_mask:0xf bank_mask:0xf
    s_nop 1
    v_add_f32_dpp v53, v53, v53 quad_perm:[2,3,0,1] row_mask:0xf bank_mask:0xf
    s_nop 1
    v_add_f32_dpp v53, v53, v53 row_half_mirror row_mask:0xf bank_mask:0xf
    s_mov_b64 exec, s[60:61]
    buffer_store_dword v52, v40, s[52:55], 0 offen offset:4
    v_add_u32 v54, 0x10000, v40
    buffer_store_dword v53, v54, s[52:55], 0 offen offset:4
    s_mov_b64 exec, -1
    v_lshlrev_b32 v44, 16, v12
    v_and_b32 v45, 0xffff0000, v12
    v_lshlrev_b32 v46, 16, v13
    v_and_b32 v47, 0xffff0000, v13
    v_lshlrev_b32 v48, 16, v14
    v_and_b32 v49, 0xffff0000, v14
    v_lshlrev_b32 v50, 16, v15
    v_and_b32 v51, 0xffff0000, v15
    v_add_f32 v52, v44, v45
    v_add_f32 v52, v52, v46
    v_add_f32 v52, v52, v47
    v_add_f32 v52, v52, v48
    v_add_f32 v52, v52, v49
    v_add_f32 v52, v52, v50
    v_add_f32 v52, v52, v51
    s_nop 1
    v_add_f32_dpp v52, v52, v52 quad_perm:[1,0,3,2] row_mask:0xf bank_mask:0xf
    s_nop 1
    v_add_f32_dpp v52, v52, v52 quad_perm:[2,3,0,1] row_mask:0xf bank_mask:0xf
    s_nop 1
    v_add_f32_dpp v52, v52, v52 row_half_mirror row_mask:0xf bank_mask:0xf
    v_mul_f32 v52, 0x3c800000, v52
    v_sub_f32 v44, v44, v52
    v_sub_f32 v45, v45, v52
    v_sub_f32 v46, v46, v52
    v_sub_f32 v47, v47, v52
    v_sub_f32 v48, v48, v52
    v_sub_f32 v49, v49, v52
    v_sub_f32 v50, v50, v52
    v_sub_f32 v51, v51, v52
    v_mul_f32 v53, v44, v44
    v_fma_f32 v53, v45, v45, v53
    v_fma_f32 v53, v46, v46, v53
    v_fma_f32 v53, v47, v47, v53
    v_fma_f32 v53, v48, v48, v53
    v_fma_f32 v53, v49, v49, v53
    v_fma_f32 v53, v50, v50, v53
    v_fma_f32 v53, v51, v51, v53
    s_nop 1
    v_add_f32_dpp v53, v53, v53 quad_perm:[1,0,3,2] row_mask:0xf bank_mask:0xf
    s_nop 1
    v_add_f32_dpp v53, v53, v53 quad_perm:[2,3,0,1] row_mask:0xf bank_mask:0xf
    s_nop 1
    v_add_f32_dpp v53, v53, v53 row_half_mirror row_mask:0xf bank_mask:0xf
    s_mov_b64 exec, s[60:61]
    buffer_store_dword v52, v40, s[52:55], 0 offen offset:8
    v_add_u32 v54, 0x10000, v40
    buffer_store_dword v53, v54, s[52:55], 0 offen offset:8
    s_mov_b64 exec, -1
    v_lshlrev_b32 v44, 16, v16
    v_and_b32 v45, 0xffff0000, v16
    v_lshlrev_b32 v46, 16, v17
    v_and_b32 v47, 0xffff0000, v17
    v_lshlrev_b32 v48, 16, v18
    v_and_b32 v49, 0xffff0000, v18
    v_lshlrev_b32 v50, 16, v19
    v_and_b32 v51, 0xffff0000, v19
    v_add_f32 v52, v44, v45
    v_add_f32 v52, v52, v46
    v_add_f32 v52, v52, v47
    v_add_f32 v52, v52, v48
    v_add_f32 v52, v52, v49
    v_add_f32 v52, v52, v50
    v_add_f32 v52, v52, v51
    s_nop 1
    v_add_f32_dpp v52, v52, v52 quad_perm:[1,0,3,2] row_mask:0xf bank_mask:0xf
    s_nop 1
    v_add_f32_dpp v52, v52, v52 quad_perm:[2,3,0,1] row_mask:0xf bank_mask:0xf
    s_nop 1
    v_add_f32_dpp v52, v52, v52 row_half_mirror row_mask:0xf bank_mask:0xf
    v_mul_f32 v52, 0x3c800000, v52
    v_sub_f32 v44, v44, v52
    v_sub_f32 v45, v45, v52
    v_sub_f32 v46, v46, v52
    v_sub_f32 v47, v47, v52
    v_sub_f32 v48, v48, v52
    v_sub_f32 v49, v49, v52
    v_sub_f32 v50, v50, v52
    v_sub_f32 v51, v51, v52
    v_mul_f32 v53, v44, v44
    v_fma_f32 v53, v45, v45, v53
    v_fma_f32 v53, v46, v46, v53
    v_fma_f32 v53, v47, v47, v53
    v_fma_f32 v53, v48, v48, v53
    v_fma_f32 v53, v49, v49, v53
    v_fma_f32 v53, v50, v50, v53
    v_fma_f32 v53, v51, v51, v53
    s_nop 1
    v_add_f32_dpp v53, v53, v53 quad_perm:[1,0,3,2] row_mask:0xf bank_mask:0xf
    s_nop 1
    v_add_f32_dpp v53, v53, v53 quad_perm:[2,3,0,1] row_mask:0xf bank_mask:0xf
    s_nop 1
    v_add_f32_dpp v53, v53, v53 row_half_mirror row_mask:0xf bank_mask:0xf
    s_mov_b64 exec, s[60:61]
    buffer_store_dword v52, v40, s[52:55], 0 offen offset:12
    v_add_u32 v54, 0x10000, v40
    buffer_store_dword v53, v54, s[52:55], 0 offen offset:12
    s_mov_b64 exec, -1
    v_lshlrev_b32 v44, 16, v20
    v_and_b32 v45, 0xffff0000, v20
    v_lshlrev_b32 v46, 16, v21
    v_and_b32 v47, 0xffff0000, v21
    v_lshlrev_b32 v48, 16, v22
    v_and_b32 v49, 0xffff0000, v22
    v_lshlrev_b32 v50, 16, v23
    v_and_b32 v51, 0xffff0000, v23
    v_add_f32 v52, v44, v45
    v_add_f32 v52, v52, v46
    v_add_f32 v52, v52, v47
    v_add_f32 v52, v52, v48
    v_add_f32 v52, v52, v49
    v_add_f32 v52, v52, v50
    v_add_f32 v52, v52, v51
    s_nop 1
    v_add_f32_dpp v52, v52, v52 quad_perm:[1,0,3,2] row_mask:0xf bank_mask:0xf
    s_nop 1
    v_add_f32_dpp v52, v52, v52 quad_perm:[2,3,0,1] row_mask:0xf bank_mask:0xf
    s_nop 1
    v_add_f32_dpp v52, v52, v52 row_half_mirror row_mask:0xf bank_mask:0xf
    v_mul_f32 v52, 0x3c800000, v52
    v_sub_f32 v44, v44, v52
    v_sub_f32 v45, v45, v52
    v_sub_f32 v46, v46, v52
    v_sub_f32 v47, v47, v52
    v_sub_f32 v48, v48, v52
    v_sub_f32 v49, v49, v52
    v_sub_f32 v50, v50, v52
    v_sub_f32 v51, v51, v52
    v_mul_f32 v53, v44, v44
    v_fma_f32 v53, v45, v45, v53
    v_fma_f32 v53, v46, v46, v53
    v_fma_f32 v53, v47, v47, v53
    v_fma_f32 v53, v48, v48, v53
    v_fma_f32 v53, v49, v49, v53
    v_fma_f32 v53, v50, v50, v53
    v_fma_f32 v53, v51, v51, v53
    s_nop 1
    v_add_f32_dpp v53, v53, v53 quad_perm:[1,0,3,2] row_mask:0xf bank_mask:0xf
    s_nop 1
    v_add_f32_dpp v53, v53, v53 quad_perm:[2,3,0,1] row_mask:0xf bank_mask:0xf
    s_nop 1
    v_add_f32_dpp v53, v53, v53 row_half_mirror row_mask:0xf bank_mask:0xf
    s_mov_b64 exec, s[60:61]
    buffer_store_dword v52, v40, s[52:55], 0 offen offset:16
    v_add_u32 v54, 0x10000, v40
    buffer_store_dword v53, v54, s[52:55], 0 offen offset:16
    s_mov_b64 exec, -1
    v_lshlrev_b32 v44, 16, v24
    v_and_b32 v45, 0xffff0000, v24
    v_lshlrev_b32 v46, 16, v25
    v_and_b32 v47, 0xffff0000, v25
    v_lshlrev_b32 v48, 16, v26
    v_and_b32 v49, 0xffff0000, v26
    v_lshlrev_b32 v50, 16, v27
    v_and_b32 v51, 0xffff0000, v27
    v_add_f32 v52, v44, v45
    v_add_f32 v52, v52, v46
    v_add_f32 v52, v52, v47
    v_add_f32 v52, v52, v48
    v_add_f32 v52, v52, v49
    v_add_f32 v52, v52, v50
    v_add_f32 v52, v52, v51
    s_nop 1
    v_add_f32_dpp v52, v52, v52 quad_perm:[1,0,3,2] row_mask:0xf bank_mask:0xf
    s_nop 1
    v_add_f32_dpp v52, v52, v52 quad_perm:[2,3,0,1] row_mask:0xf bank_mask:0xf
    s_nop 1
    v_add_f32_dpp v52, v52, v52 row_half_mirror row_mask:0xf bank_mask:0xf
    v_mul_f32 v52, 0x3c800000, v52
    v_sub_f32 v44, v44, v52
    v_sub_f32 v45, v45, v52
    v_sub_f32 v46, v46, v52
    v_sub_f32 v47, v47, v52
    v_sub_f32 v48, v48, v52
    v_sub_f32 v49, v49, v52
    v_sub_f32 v50, v50, v52
    v_sub_f32 v51, v51, v52
    v_mul_f32 v53, v44, v44
    v_fma_f32 v53, v45, v45, v53
    v_fma_f32 v53, v46, v46, v53
    v_fma_f32 v53, v47, v47, v53
    v_fma_f32 v53, v48, v48, v53
    v_fma_f32 v53, v49, v49, v53
    v_fma_f32 v53, v50, v50, v53
    v_fma_f32 v53, v51, v51, v53
    s_nop 1
    v_add_f32_dpp v53, v53, v53 quad_perm:[1,0,3,2] row_mask:0xf bank_mask:0xf
    s_nop 1
    v_add_f32_dpp v53, v53, v53 quad_perm:[2,3,0,1] row_mask:0xf bank_mask:0xf
    s_nop 1
    v_add_f32_dpp v53, v53, v53 row_half_mirror row_mask:0xf bank_mask:0xf
    s_mov_b64 exec, s[60:61]
    buffer_store_dword v52, v40, s[52:55], 0 offen offset:20
    v_add_u32 v54, 0x10000, v40
    buffer_store_dword v53, v54, s[52:55], 0 offen offset:20
    s_mov_b64 exec, -1
    v_lshlrev_b32 v44, 16, v28
    v_and_b32 v45, 0xffff0000, v28
    v_lshlrev_b32 v46, 16, v29
    v_and_b32 v47, 0xffff0000, v29
    v_lshlrev_b32 v48, 16, v30
    v_and_b32 v49, 0xffff0000, v30
    v_lshlrev_b32 v50, 16, v31
    v_and_b32 v51, 0xffff0000, v31
    v_add_f32 v52, v44, v45
    v_add_f32 v52, v52, v46
    v_add_f32 v52, v52, v47
    v_add_f32 v52, v52, v48
    v_add_f32 v52, v52, v49
    v_add_f32 v52, v52, v50
    v_add_f32 v52, v52, v51
    s_nop 1
    v_add_f32_dpp v52, v52, v52 quad_perm:[1,0,3,2] row_mask:0xf bank_mask:0xf
    s_nop 1
    v_add_f32_dpp v52, v52, v52 quad_perm:[2,3,0,1] row_mask:0xf bank_mask:0xf
    s_nop 1
    v_add_f32_dpp v52, v52, v52 row_half_mirror row_mask:0xf bank_mask:0xf
    v_mul_f32 v52, 0x3c800000, v52
    v_sub_f32 v44, v44, v52
    v_sub_f32 v45, v45, v52
    v_sub_f32 v46, v46, v52
    v_sub_f32 v47, v47, v52
    v_sub_f32 v48, v48, v52
    v_sub_f32 v49, v49, v52
    v_sub_f32 v50, v50, v52
    v_sub_f32 v51, v51, v52
    v_mul_f32 v53, v44, v44
    v_fma_f32 v53, v45, v45, v53
    v_fma_f32 v53, v46, v46, v53
    v_fma_f32 v53, v47, v47, v53
    v_fma_f32 v53, v48, v48, v53
    v_fma_f32 v53, v49, v49, v53
    v_fma_f32 v53, v50, v50, v53
    v_fma_f32 v53, v51, v51, v53
    s_nop 1
    v_add_f32_dpp v53, v53, v53 quad_perm:[1,0,3,2] row_mask:0xf bank_mask:0xf
    s_nop 1
    v_add_f32_dpp v53, v53, v53 quad_perm:[2,3,0,1] row_mask:0xf bank_mask:0xf
    s_nop 1
    v_add_f32_dpp v53, v53, v53 row_half_mirror row_mask:0xf bank_mask:0xf
    s_mov_b64 exec, s[60:61]
    buffer_store_dword v52, v40, s[52:55], 0 offen offset:24
    v_add_u32 v54, 0x10000, v40
    buffer_store_dword v53, v54, s[52:55], 0 offen offset:24
    s_mov_b64 exec, -1
    v_lshlrev_b32 v44, 16, v32
    v_and_b32 v45, 0xffff0000, v32
    v_lshlrev_b32 v46, 16, v33
    v_and_b32 v47, 0xffff0000, v33
    v_lshlrev_b32 v48, 16, v34
    v_and_b32 v49, 0xffff0000, v34
    v_lshlrev_b32 v50, 16, v35
    v_and_b32 v51, 0xffff0000, v35
    v_add_f32 v52, v44, v45
    v_add_f32 v52, v52, v46
    v_add_f32 v52, v52, v47
    v_add_f32 v52, v52, v48
    v_add_f32 v52, v52, v49
    v_add_f32 v52, v52, v50
    v_add_f32 v52, v52, v51
    s_nop 1
    v_add_f32_dpp v52, v52, v52 quad_perm:[1,0,3,2] row_mask:0xf bank_mask:0xf
    s_nop 1
    v_add_f32_dpp v52, v52, v52 quad_perm:[2,3,0,1] row_mask:0xf bank_mask:0xf
    s_nop 1
    v_add_f32_dpp v52, v52, v52 row_half_mirror row_mask:0xf bank_mask:0xf
    v_mul_f32 v52, 0x3c800000, v52
    v_sub_f32 v44, v44, v52
    v_sub_f32 v45, v45, v52
    v_sub_f32 v46, v46, v52
    v_sub_f32 v47, v47, v52
    v_sub_f32 v48, v48, v52
    v_sub_f32 v49, v49, v52
    v_sub_f32 v50, v50, v52
    v_sub_f32 v51, v51, v52
    v_mul_f32 v53, v44, v44
    v_fma_f32 v53, v45, v45, v53
    v_fma_f32 v53, v46, v46, v53
    v_fma_f32 v53, v47, v47, v53
    v_fma_f32 v53, v48, v48, v53
    v_fma_f32 v53, v49, v49, v53
    v_fma_f32 v53, v50, v50, v53
    v_fma_f32 v53, v51, v51, v53
    s_nop 1
    v_add_f32_dpp v53, v53, v53 quad_perm:[1,0,3,2] row_mask:0xf bank_mask:0xf
    s_nop 1
    v_add_f32_dpp v53, v53, v53 quad_perm:[2,3,0,1] row_mask:0xf bank_mask:0xf
    s_nop 1
    v_add_f32_dpp v53, v53, v53 row_half_mirror row_mask:0xf bank_mask:0xf
    s_mov_b64 exec, s[60:61]
    buffer_store_dword v52, v40, s[52:55], 0 offen offset:28
    v_add_u32 v54, 0x10000, v40
    buffer_store_dword v53, v54, s[52:55], 0 offen offset:28
    s_mov_b64 exec, -1
    s_branch kg_done
kg_pack:
    s_load_dwordx4 s[4:7], s[0:1], 80
    s_load_dwordx2 s[8:9], s[0:1], 96
    s_sub_u32 s3, s2, 576
    s_waitcnt lgkmcnt(0)
    s_mov_b32 s10, 0x1600000
    s_mov_b32 s11, 12
    s_cmp_lt_u32 s3, 56
    s_cbranch_scc1 kg_pk_sel
    s_sub_u32 s3, s3, 56
    s_mov_b32 s4, s6
    s_mov_b32 s5, s7
    s_mov_b32 s10, 0x1800000
    s_cmp_lt_u32 s3, 56
    s_cbranch_scc1 kg_pk_sel
    s_sub_u32 s3, s3, 56
    s_mov_b32 s4, s8
    s_mov_b32 s5, s9
    s_mov_b32 s10, 0x1a00000
    s_mov_b32 s12, 1024
    s_mov_b32 s13, 112
    s_and_b32 s14, s3, 1
    s_lshr_b32 s15, s3, 1
    s_branch kg_pk_go
kg_pk_sel:
    s_mov_b32 s12, 3584
    s_mov_b32 s13, 32
    s_mul_i32 s15, s3, 37
    s_lshr_b32 s15, s15, 8
    s_mul_i32 s14, s15, 7
    s_sub_u32 s14, s3, s14
kg_pk_go:
    s_mov_b32 s24, s4
    s_mov_b32 s25, s5
    s_mov_b32 s26, 0x1c0000
    s_mov_b32 s27, 0x00020000
    v_and_b32 v1, 31, v0
    s_lshl_b32 s14, s14, 5
    v_add_u32 v1, s14, v1
    v_lshrrev_b32 v2, 5, v0
    s_lshl_b32 s15, s15, 3
    v_add_u32 v2, s15, v2
    v_lshlrev_b32 v3, 3, v2
    v_mul_lo_u32 v3, v3, s12
    v_lshl_add_u32 v3, v1, 4, v3
    s_mov_b32 s16, 0
    buffer_load_dwordx4 v[4:7], v3, s[24:27], s16 offen
    s_add_u32 s16, s16, s12
    buffer_load_dwordx4 v[8:11], v3, s[24:27], s16 offen
    s_add_u32 s16, s16, s12
    buffer_load_dwordx4 v[12:15], v3, s[24:27], s16 offen
    s_add_u32 s16, s16, s12
    buffer_load_dwordx4 v[16:19], v3, s[24:27], s16 offen
    s_add_u32 s16, s16, s12
    buffer_load_dwordx4 v[20:23], v3, s[24:27], s16 offen
    s_add_u32 s16, s16, s12
    buffer_load_dwordx4 v[24:27], v3, s[24:27], s16 offen
    s_add_u32 s16, s16, s12
    buffer_load_dwordx4 v[28:31], v3, s[24:27], s16 offen
    s_add_u32 s16, s16, s12
    buffer_load_dwordx4 v[32:35], v3, s[24:27], s16 offen
    s_add_u32 s16, s16, s12
    v_lshrrev_b32 v40, 2, v1
    v_mul_lo_u32 v40, v40, s13
    v_lshrrev_b32 v41, 1, v2
    v_add_u32 v40, v40, v41
    v_lshlrev_b32 v40, 6, v40
    v_and_b32 v41, 3, v1
    v_lshl_add_u32 v40, v41, 3, v40
    v_and_b32 v41, 1, v2
    v_lshl_add_u32 v40, v41, 5, v40
    v_lshlrev_b32 v40, 4, v40
    v_add_u32 v40, s10, v40
    s_waitcnt vmcnt(0)
    s_mov_b32 s62, 0x05040100
    s_mov_b32 s63, 0x07060302
    v_perm_b32 v64, v8, v4, s62
    v_perm_b32 v65, v16, v12, s62
    v_perm_b32 v66, v24, v20, s62
    v_perm_b32 v67, v32, v28, s62
    v_perm_b32 v68, v8, v4, s63
    v_perm_b32 v69, v16, v12, s63
    v_perm_b32 v70, v24, v20, s63
    v_perm_b32 v71, v32, v28, s63
    v_perm_b32 v72, v9, v5, s62
    v_perm_b32 v73, v17, v13, s62
    v_perm_b32 v74, v25, v21, s62
    v_perm_b32 v75, v33, v29, s62
    v_perm_b32 v76, v9, v5, s63
    v_perm_b32 v77, v17, v13, s63
    v_perm_b32 v78, v25, v21, s63
    v_perm_b32 v79, v33, v29, s63
    v_perm_b32 v80, v10, v6, s62
    v_perm_b32 v81, v18, v14, s62
    v_perm_b32 v82, v26, v22, s62
    v_perm_b32 v83, v34, v30, s62
    v_perm_b32 v84, v10, v6, s63
    v_perm_b32 v85, v18, v14, s63
    v_perm_b32 v86, v26, v22, s63
    v_perm_b32 v87, v34, v30, s63
    v_perm_b32 v88, v11, v7, s62
    v_perm_b32 v89, v19, v15, s62
    v_perm_b32 v90, v27, v23, s62
    v_perm_b32 v91, v35, v31, s62
    v_perm_b32 v92, v11, v7, s63
    v_perm_b32 v93, v19, v15, s63
    v_perm_b32 v94, v27, v23, s63
    v_perm_b32 v95, v35, v31, s63
    buffer_store_dwordx4 v[64:67], v40, s[52:55], 0 offen offset:0
    buffer_store_dwordx4 v[68:71], v40, s[52:55], 0 offen offset:16
    buffer_store_dwordx4 v[72:75], v40, s[52:55], 0 offen offset:32
    buffer_store_dwordx4 v[76:79], v40, s[52:55], 0 offen offset:48
    buffer_store_dwordx4 v[80:83], v40, s[52:55], 0 offen offset:64
    buffer_store_dwordx4 v[84:87], v40, s[52:55], 0 offen offset:80
    buffer_store_dwordx4 v[88:91], v40, s[52:55], 0 offen offset:96
    buffer_store_dwordx4 v[92:95], v40, s[52:55], 0 offen offset:112
kg_done:
    s_endpgm
.globl conva_kernel
.p2align 8
.type conva_kernel,@function
conva_kernel:
    s_mov_b32 s20, 0
    s_branch conv_common
.globl convb_kernel
.p2align 8
.type convb_kernel,@function
convb_kernel:
    s_mov_b32 s20, 1
conv_common:
    s_cmp_ge_u32 s2, 256
    s_cbranch_scc1 conv_done
    s_load_dwordx2 s[4:5], s[0:1], 0
    s_load_dwordx2 s[6:7], s[0:1], 120
    s_load_dwordx2 s[8:9], s[0:1], 64
    s_waitcnt lgkmcnt(0)
    s_mov_b32 s28, s6
    s_mov_b32 s29, s7
    s_mov_b32 s30, 0x1c00000
    s_mov_b32 s31, 0x00020000
    s_lshl_b32 s3, s2, 2
    s_load_dword s21, s[8:9], s3
    s_cmp_eq_u32 s20, 0
    s_mov_b32 s22, 0x1020000
    s_mov_b32 s23, 0x400000
    s_cmp_eq_u32 s20, 0
    s_cselect_b32 s22, 0x1000000, s22
    s_cselect_b32 s23, 0x0, s23
    s_mov_b32 s10, 0x200000
    s_cselect_b32 s10, 0x600000, s10
    s_add_u32 s24, s6, s10
    s_addc_u32 s25, s7, 0
    s_mov_b32 s26, 0x200000
    s_mov_b32 s27, 0x00020000
    v_lshrrev_b32 v1, 7, v0
    v_and_b32 v2, 127, v0
    s_lshl_b32 s3, s2, 1
    v_add_u32 v3, s3, v1
    v_lshlrev_b32 v6, 12, v3
    v_lshl_add_u32 v6, v2, 5, v6
    v_add_u32 v6, -16, v6
    buffer_load_dwordx4 v[144:147], v6, s[24:27], 0 offen
    buffer_load_dwordx4 v[148:151], v6, s[24:27], 0 offen offset:16
    buffer_load_dwordx4 v[152:155], v6, s[24:27], 0 offen offset:32
    v_lshlrev_b32 v5, 13, v3
    v_lshl_add_u32 v5, v2, 4, v5
    v_add_u32 v5, 0x1100000, v5
    s_mov_b32 s40, 0
    buffer_load_dwordx4 v[128:131], v5, s[28:31], s40 offen
    s_mov_b32 s40, 2048
    buffer_load_dwordx4 v[132:135], v5, s[28:31], s40 offen
    s_mov_b32 s40, 4096
    buffer_load_dwordx4 v[136:139], v5, s[28:31], s40 offen
    s_mov_b32 s40, 6144
    buffer_load_dwordx4 v[140:143], v5, s[28:31], s40 offen
    v_lshlrev_b32 v4, 5, v0
    v_add_u32 v4, s22, v4
    s_mov_b32 s40, 0
    buffer_load_dwordx4 v[8:11], v4, s[28:31], s40 offen
    s_mov_b32 s40, 16
    buffer_load_dwordx4 v[12:15], v4, s[28:31], s40 offen
    s_mov_b32 s40, 8192
    buffer_load_dwordx4 v[16:19], v4, s[28:31], s40 offen
    s_mov_b32 s40, 8208
    buffer_load_dwordx4 v[20:23], v4, s[28:31], s40 offen
    s_mov_b32 s40, 16384
    buffer_load_dwordx4 v[24:27], v4, s[28:31], s40 offen
    s_mov_b32 s40, 16400
    buffer_load_dwordx4 v[28:31], v4, s[28:31], s40 offen
    s_mov_b32 s40, 24576
    buffer_load_dwordx4 v[32:35], v4, s[28:31], s40 offen
    s_mov_b32 s40, 24592
    buffer_load_dwordx4 v[36:39], v4, s[28:31], s40 offen
    s_mov_b32 s40, 32768
    buffer_load_dwordx4 v[40:43], v4, s[28:31], s40 offen
    s_mov_b32 s40, 32784
    buffer_load_dwordx4 v[44:47], v4, s[28:31], s40 offen
    s_mov_b32 s40, 40960
    buffer_load_dwordx4 v[48:51], v4, s[28:31], s40 offen
    s_mov_b32 s40, 40976
    buffer_load_dwordx4 v[52:55], v4, s[28:31], s40 offen
    s_mov_b32 s40, 49152
    buffer_load_dwordx4 v[56:59], v4, s[28:31], s40 offen
    s_mov_b32 s40, 49168
    buffer_load_dwordx4 v[60:63], v4, s[28:31], s40 offen
    s_mov_b32 s40, 57344
    buffer_load_dwordx4 v[64:67], v4, s[28:31], s40 offen
    s_mov_b32 s40, 57360
    buffer_load_dwordx4 v[68:71], v4, s[28:31], s40 offen
    s_mov_b32 s40, 65536
    buffer_load_dwordx4 v[184:187], v4, s[28:31], s40 offen
    s_mov_b32 s40, 65552
    buffer_load_dwordx4 v[188:191], v4, s[28:31], s40 offen
    s_mov_b32 s40, 73728
    buffer_load_dwordx4 v[192:195], v4, s[28:31], s40 offen
    s_mov_b32 s40, 73744
    buffer_load_dwordx4 v[196:199], v4, s[28:31], s40 offen
    s_mov_b32 s40, 81920
    buffer_load_dwordx4 v[200:203], v4, s[28:31], s40 offen
    s_mov_b32 s40, 81936
    buffer_load_dwordx4 v[204:207], v4, s[28:31], s40 offen
    s_mov_b32 s40, 90112
    buffer_load_dwordx4 v[208:211], v4, s[28:31], s40 offen
    s_mov_b32 s40, 90128
    buffer_load_dwordx4 v[212:215], v4, s[28:31], s40 offen
    s_mov_b32 s40, 98304
    buffer_load_dwordx4 v[216:219], v4, s[28:31], s40 offen
    s_mov_b32 s40, 98320
    buffer_load_dwordx4 v[220:223], v4, s[28:31], s40 offen
    s_mov_b32 s40, 106496
    buffer_load_dwordx4 v[224:227], v4, s[28:31], s40 offen
    s_mov_b32 s40, 106512
    buffer_load_dwordx4 v[228:231], v4, s[28:31], s40 offen
    s_mov_b32 s40, 114688
    buffer_load_dwordx4 v[232:235], v4, s[28:31], s40 offen
    s_mov_b32 s40, 114704
    buffer_load_dwordx4 v[236:239], v4, s[28:31], s40 offen
    s_mov_b32 s40, 122880
    buffer_load_dwordx4 v[240:243], v4, s[28:31], s40 offen
    s_mov_b32 s40, 122896
    buffer_load_dwordx4 v[244:247], v4, s[28:31], s40 offen
    v_mov_b32 v72, 0
    v_mov_b32 v73, 0
    v_mov_b32 v74, 0
    v_mov_b32 v75, 0
    v_mul_u32_u24 v7, 50816, v1
    v_add_u32 v7, 16640, v7
    v_lshl_add_u32 v85, v2, 4, v7
    v_cmp_gt_u32 vcc, 32, v2
    s_and_saveexec_b64 s[42:43], vcc
    ds_write_b128 v85, v[72:75] offset:4096
    ds_write_b128 v85, v[72:75] offset:8704
    ds_write_b128 v85, v[72:75] offset:50304
    s_mov_b64 exec, s[42:43]
    s_waitcnt vmcnt(16)
    v_add_f32 v80, v8, v16
    v_add_f32 v81, v24, v32
    v_add_f32 v82, v40, v48
    v_add_f32 v83, v56, v64
    v_add_f32 v80, v80, v81
    v_add_f32 v82, v82, v83
    v_add_f32 v80, v80, v82
    v_mul_f32 v72, 0.125, v80
    v_sub_f32 v81, v8, v72
    v_mul_f32 v88, v81, v81
    v_sub_f32 v81, v16, v72
    v_fma_f32 v88, v81, v81, v88
    v_sub_f32 v81, v24, v72
    v_fma_f32 v88, v81, v81, v88
    v_sub_f32 v81, v32, v72
    v_fma_f32 v88, v81, v81, v88
    v_sub_f32 v81, v40, v72
    v_fma_f32 v88, v81, v81, v88
    v_sub_f32 v81, v48, v72
    v_fma_f32 v88, v81, v81, v88
    v_sub_f32 v81, v56, v72
    v_fma_f32 v88, v81, v81, v88
    v_sub_f32 v81, v64, v72
    v_fma_f32 v88, v81, v81, v88
    v_add_f32 v80, v9, v17
    v_add_f32 v81, v25, v33
    v_add_f32 v82, v41, v49
    v_add_f32 v83, v57, v65
    v_add_f32 v80, v80, v81
    v_add_f32 v82, v82, v83
    v_add_f32 v80, v80, v82
    v_mul_f32 v73, 0.125, v80
    v_sub_f32 v81, v9, v73
    v_mul_f32 v89, v81, v81
    v_sub_f32 v81, v17, v73
    v_fma_f32 v89, v81, v81, v89
    v_sub_f32 v81, v25, v73
    v_fma_f32 v89, v81, v81, v89
    v_sub_f32 v81, v33, v73
    v_fma_f32 v89, v81, v81, v89
    v_sub_f32 v81, v41, v73
    v_fma_f32 v89, v81, v81, v89
    v_sub_f32 v81, v49, v73
    v_fma_f32 v89, v81, v81, v89
    v_sub_f32 v81, v57, v73
    v_fma_f32 v89, v81, v81, v89
    v_sub_f32 v81, v65, v73
    v_fma_f32 v89, v81, v81, v89
    v_add_f32 v80, v10, v18
    v_add_f32 v81, v26, v34
    v_add_f32 v82, v42, v50
    v_add_f32 v83, v58, v66
    v_add_f32 v80, v80, v81
    v_add_f32 v82, v82, v83
    v_add_f32 v80, v80, v82
    v_mul_f32 v74, 0.125, v80
    v_sub_f32 v81, v10, v74
    v_mul_f32 v90, v81, v81
    v_sub_f32 v81, v18, v74
    v_fma_f32 v90, v81, v81, v90
    v_sub_f32 v81, v26, v74
    v_fma_f32 v90, v81, v81, v90
    v_sub_f32 v81, v34, v74
    v_fma_f32 v90, v81, v81, v90
    v_sub_f32 v81, v42, v74
    v_fma_f32 v90, v81, v81, v90
    v_sub_f32 v81, v50, v74
    v_fma_f32 v90, v81, v81, v90
    v_sub_f32 v81, v58, v74
    v_fma_f32 v90, v81, v81, v90
    v_sub_f32 v81, v66, v74
    v_fma_f32 v90, v81, v81, v90
    v_add_f32 v80, v11, v19
    v_add_f32 v81, v27, v35
    v_add_f32 v82, v43, v51
    v_add_f32 v83, v59, v67
    v_add_f32 v80, v80, v81
    v_add_f32 v82, v82, v83
    v_add_f32 v80, v80, v82
    v_mul_f32 v75, 0.125, v80
    v_sub_f32 v81, v11, v75
    v_mul_f32 v91, v81, v81
    v_sub_f32 v81, v19, v75
    v_fma_f32 v91, v81, v81, v91
    v_sub_f32 v81, v27, v75
    v_fma_f32 v91, v81, v81, v91
    v_sub_f32 v81, v35, v75
    v_fma_f32 v91, v81, v81, v91
    v_sub_f32 v81, v43, v75
    v_fma_f32 v91, v81, v81, v91
    v_sub_f32 v81, v51, v75
    v_fma_f32 v91, v81, v81, v91
    v_sub_f32 v81, v59, v75
    v_fma_f32 v91, v81, v81, v91
    v_sub_f32 v81, v67, v75
    v_fma_f32 v91, v81, v81, v91
    v_add_f32 v80, v12, v20
    v_add_f32 v81, v28, v36
    v_add_f32 v82, v44, v52
    v_add_f32 v83, v60, v68
    v_add_f32 v80, v80, v81
    v_add_f32 v82, v82, v83
    v_add_f32 v80, v80, v82
    v_mul_f32 v76, 0.125, v80
    v_sub_f32 v81, v12, v76
    v_mul_f32 v92, v81, v81
    v_sub_f32 v81, v20, v76
    v_fma_f32 v92, v81, v81, v92
    v_sub_f32 v81, v28, v76
    v_fma_f32 v92, v81, v81, v92
    v_sub_f32 v81, v36, v76
    v_fma_f32 v92, v81, v81, v92
    v_sub_f32 v81, v44, v76
    v_fma_f32 v92, v81, v81, v92
    v_sub_f32 v81, v52, v76
    v_fma_f32 v92, v81, v81, v92
    v_sub_f32 v81, v60, v76
    v_fma_f32 v92, v81, v81, v92
    v_sub_f32 v81, v68, v76
    v_fma_f32 v92, v81, v81, v92
    v_add_f32 v80, v13, v21
    v_add_f32 v81, v29, v37
    v_add_f32 v82, v45, v53
    v_add_f32 v83, v61, v69
    v_add_f32 v80, v80, v81
    v_add_f32 v82, v82, v83
    v_add_f32 v80, v80, v82
    v_mul_f32 v77, 0.125, v80
    v_sub_f32 v81, v13, v77
    v_mul_f32 v93, v81, v81
    v_sub_f32 v81, v21, v77
    v_fma_f32 v93, v81, v81, v93
    v_sub_f32 v81, v29, v77
    v_fma_f32 v93, v81, v81, v93
    v_sub_f32 v81, v37, v77
    v_fma_f32 v93, v81, v81, v93
    v_sub_f32 v81, v45, v77
    v_fma_f32 v93, v81, v81, v93
    v_sub_f32 v81, v53, v77
    v_fma_f32 v93, v81, v81, v93
    v_sub_f32 v81, v61, v77
    v_fma_f32 v93, v81, v81, v93
    v_sub_f32 v81, v69, v77
    v_fma_f32 v93, v81, v81, v93
    v_add_f32 v80, v14, v22
    v_add_f32 v81, v30, v38
    v_add_f32 v82, v46, v54
    v_add_f32 v83, v62, v70
    v_add_f32 v80, v80, v81
    v_add_f32 v82, v82, v83
    v_add_f32 v80, v80, v82
    v_mul_f32 v78, 0.125, v80
    v_sub_f32 v81, v14, v78
    v_mul_f32 v94, v81, v81
    v_sub_f32 v81, v22, v78
    v_fma_f32 v94, v81, v81, v94
    v_sub_f32 v81, v30, v78
    v_fma_f32 v94, v81, v81, v94
    v_sub_f32 v81, v38, v78
    v_fma_f32 v94, v81, v81, v94
    v_sub_f32 v81, v46, v78
    v_fma_f32 v94, v81, v81, v94
    v_sub_f32 v81, v54, v78
    v_fma_f32 v94, v81, v81, v94
    v_sub_f32 v81, v62, v78
    v_fma_f32 v94, v81, v81, v94
    v_sub_f32 v81, v70, v78
    v_fma_f32 v94, v81, v81, v94
    v_add_f32 v80, v15, v23
    v_add_f32 v81, v31, v39
    v_add_f32 v82, v47, v55
    v_add_f32 v83, v63, v71
    v_add_f32 v80, v80, v81
    v_add_f32 v82, v82, v83
    v_add_f32 v80, v80, v82
    v_mul_f32 v79, 0.125, v80
    v_sub_f32 v81, v15, v79
    v_mul_f32 v95, v81, v81
    v_sub_f32 v81, v23, v79
    v_fma_f32 v95, v81, v81, v95
    v_sub_f32 v81, v31, v79
    v_fma_f32 v95, v81, v81, v95
    v_sub_f32 v81, v39, v79
    v_fma_f32 v95, v81, v81, v95
    v_sub_f32 v81, v47, v79
    v_fma_f32 v95, v81, v81, v95
    v_sub_f32 v81, v55, v79
    v_fma_f32 v95, v81, v81, v95
    v_sub_f32 v81, v63, v79
    v_fma_f32 v95, v81, v81, v95
    v_sub_f32 v81, v71, v79
    v_fma_f32 v95, v81, v81, v95
    ds_write_b128 v85, v[128:131] offset:0
    ds_write_b128 v85, v[132:135] offset:2048
    ds_write_b128 v85, v[136:139] offset:4608
    ds_write_b128 v85, v[140:143] offset:6656
    v_lshlrev_b32 v160, 16, v144
    v_and_b32 v161, 0xffff0000, v144
    v_lshlrev_b32 v162, 16, v145
    v_and_b32 v163, 0xffff0000, v145
    v_lshlrev_b32 v164, 16, v146
    v_and_b32 v165, 0xffff0000, v146
    v_lshlrev_b32 v166, 16, v147
    v_and_b32 v167, 0xffff0000, v147
    v_lshlrev_b32 v168, 16, v148
    v_and_b32 v169, 0xffff0000, v148
    v_lshlrev_b32 v170, 16, v149
    v_and_b32 v171, 0xffff0000, v149
    v_lshlrev_b32 v172, 16, v150
    v_and_b32 v173, 0xffff0000, v150
    v_lshlrev_b32 v174, 16, v151
    v_and_b32 v175, 0xffff0000, v151
    v_lshlrev_b32 v176, 16, v152
    v_and_b32 v177, 0xffff0000, v152
    v_lshlrev_b32 v178, 16, v153
    v_and_b32 v179, 0xffff0000, v153
    v_lshlrev_b32 v180, 16, v154
    v_and_b32 v181, 0xffff0000, v154
    v_lshlrev_b32 v182, 16, v155
    v_and_b32 v183, 0xffff0000, v155
    s_waitcnt vmcnt(0)
    v_add_f32 v80, v184, v192
    v_add_f32 v81, v200, v208
    v_add_f32 v82, v216, v224
    v_add_f32 v83, v232, v240
    v_add_f32 v80, v80, v81
    v_add_f32 v82, v82, v83
    v_add_f32 v80, v80, v82
    v_mov_b32 v81, 0x42800000
    v_fma_f32 v80, v88, v81, v80
    v_mul_f32 v80, 0x3b000000, v80
    v_cvt_pk_bf16_f32 v82, v72, v80
    v_lshlrev_b32 v96, 16, v82
    v_and_b32 v80, 0xffff0000, v82
    v_add_f32 v80, 0x3727c5ac, v80
    v_cvt_pk_bf16_f32 v80, v80, v80
    v_lshlrev_b32 v80, 16, v80
    v_sqrt_f32 v80, v80
    s_nop 0
    v_cvt_pk_bf16_f32 v80, v80, v80
    v_lshlrev_b32 v80, 16, v80
    v_rcp_f32 v104, v80
    v_add_f32 v80, v185, v193
    v_add_f32 v81, v201, v209
    v_add_f32 v82, v217, v225
    v_add_f32 v83, v233, v241
    v_add_f32 v80, v80, v81
    v_add_f32 v82, v82, v83
    v_add_f32 v80, v80, v82
    v_mov_b32 v81, 0x42800000
    v_fma_f32 v80, v89, v81, v80
    v_mul_f32 v80, 0x3b000000, v80
    v_cvt_pk_bf16_f32 v82, v73, v80
    v_lshlrev_b32 v97, 16, v82
    v_and_b32 v80, 0xffff0000, v82
    v_add_f32 v80, 0x3727c5ac, v80
    v_cvt_pk_bf16_f32 v80, v80, v80
    v_lshlrev_b32 v80, 16, v80
    v_sqrt_f32 v80, v80
    s_nop 0
    v_cvt_pk_bf16_f32 v80, v80, v80
    v_lshlrev_b32 v80, 16, v80
    v_rcp_f32 v105, v80
    v_add_f32 v80, v186, v194
    v_add_f32 v81, v202, v210
    v_add_f32 v82, v218, v226
    v_add_f32 v83, v234, v242
    v_add_f32 v80, v80, v81
    v_add_f32 v82, v82, v83
    v_add_f32 v80, v80, v82
    v_mov_b32 v81, 0x42800000
    v_fma_f32 v80, v90, v81, v80
    v_mul_f32 v80, 0x3b000000, v80
    v_cvt_pk_bf16_f32 v82, v74, v80
    v_lshlrev_b32 v98, 16, v82
    v_and_b32 v80, 0xffff0000, v82
    v_add_f32 v80, 0x3727c5ac, v80
    v_cvt_pk_bf16_f32 v80, v80, v80
    v_lshlrev_b32 v80, 16, v80
    v_sqrt_f32 v80, v80
    s_nop 0
    v_cvt_pk_bf16_f32 v80, v80, v80
    v_lshlrev_b32 v80, 16, v80
    v_rcp_f32 v106, v80
    v_add_f32 v80, v187, v195
    v_add_f32 v81, v203, v211
    v_add_f32 v82, v219, v227
    v_add_f32 v83, v235, v243
    v_add_f32 v80, v80, v81
    v_add_f32 v82, v82, v83
    v_add_f32 v80, v80, v82
    v_mov_b32 v81, 0x42800000
    v_fma_f32 v80, v91, v81, v80
    v_mul_f32 v80, 0x3b000000, v80
    v_cvt_pk_bf16_f32 v82, v75, v80
    v_lshlrev_b32 v99, 16, v82
    v_and_b32 v80, 0xffff0000, v82
    v_add_f32 v80, 0x3727c5ac, v80
    v_cvt_pk_bf16_f32 v80, v80, v80
    v_lshlrev_b32 v80, 16, v80
    v_sqrt_f32 v80, v80
    s_nop 0
    v_cvt_pk_bf16_f32 v80, v80, v80
    v_lshlrev_b32 v80, 16, v80
    v_rcp_f32 v107, v80
    v_add_f32 v80, v188, v196
    v_add_f32 v81, v204, v212
    v_add_f32 v82, v220, v228
    v_add_f32 v83, v236, v244
    v_add_f32 v80, v80, v81
    v_add_f32 v82, v82, v83
    v_add_f32 v80, v80, v82
    v_mov_b32 v81, 0x42800000
    v_fma_f32 v80, v92, v81, v80
    v_mul_f32 v80, 0x3b000000, v80
    v_cvt_pk_bf16_f32 v82, v76, v80
    v_lshlrev_b32 v100, 16, v82
    v_and_b32 v80, 0xffff0000, v82
    v_add_f32 v80, 0x3727c5ac, v80
    v_cvt_pk_bf16_f32 v80, v80, v80
    v_lshlrev_b32 v80, 16, v80
    v_sqrt_f32 v80, v80
    s_nop 0
    v_cvt_pk_bf16_f32 v80, v80, v80
    v_lshlrev_b32 v80, 16, v80
    v_rcp_f32 v108, v80
    v_add_f32 v80, v189, v197
    v_add_f32 v81, v205, v213
    v_add_f32 v82, v221, v229
    v_add_f32 v83, v237, v245
    v_add_f32 v80, v80, v81
    v_add_f32 v82, v82, v83
    v_add_f32 v80, v80, v82
    v_mov_b32 v81, 0x42800000
    v_fma_f32 v80, v93, v81, v80
    v_mul_f32 v80, 0x3b000000, v80
    v_cvt_pk_bf16_f32 v82, v77, v80
    v_lshlrev_b32 v101, 16, v82
    v_and_b32 v80, 0xffff0000, v82
    v_add_f32 v80, 0x3727c5ac, v80
    v_cvt_pk_bf16_f32 v80, v80, v80
    v_lshlrev_b32 v80, 16, v80
    v_sqrt_f32 v80, v80
    s_nop 0
    v_cvt_pk_bf16_f32 v80, v80, v80
    v_lshlrev_b32 v80, 16, v80
    v_rcp_f32 v109, v80
    v_add_f32 v80, v190, v198
    v_add_f32 v81, v206, v214
    v_add_f32 v82, v222, v230
    v_add_f32 v83, v238, v246
    v_add_f32 v80, v80, v81
    v_add_f32 v82, v82, v83
    v_add_f32 v80, v80, v82
    v_mov_b32 v81, 0x42800000
    v_fma_f32 v80, v94, v81, v80
    v_mul_f32 v80, 0x3b000000, v80
    v_cvt_pk_bf16_f32 v82, v78, v80
    v_lshlrev_b32 v102, 16, v82
    v_and_b32 v80, 0xffff0000, v82
    v_add_f32 v80, 0x3727c5ac, v80
    v_cvt_pk_bf16_f32 v80, v80, v80
    v_lshlrev_b32 v80, 16, v80
    v_sqrt_f32 v80, v80
    s_nop 0
    v_cvt_pk_bf16_f32 v80, v80, v80
    v_lshlrev_b32 v80, 16, v80
    v_rcp_f32 v110, v80
    v_add_f32 v80, v191, v199
    v_add_f32 v81, v207, v215
    v_add_f32 v82, v223, v231
    v_add_f32 v83, v239, v247
    v_add_f32 v80, v80, v81
    v_add_f32 v82, v82, v83
    v_add_f32 v80, v80, v82
    v_mov_b32 v81, 0x42800000
    v_fma_f32 v80, v95, v81, v80
    v_mul_f32 v80, 0x3b000000, v80
    v_cvt_pk_bf16_f32 v82, v79, v80
    v_lshlrev_b32 v103, 16, v82
    v_and_b32 v80, 0xffff0000, v82
    v_add_f32 v80, 0x3727c5ac, v80
    v_cvt_pk_bf16_f32 v80, v80, v80
    v_lshlrev_b32 v80, 16, v80
    v_sqrt_f32 v80, v80
    s_nop 0
    v_cvt_pk_bf16_f32 v80, v80, v80
    v_lshlrev_b32 v80, 16, v80
    v_rcp_f32 v111, v80
    v_lshlrev_b32 v12, 5, v0
    s_nop 0
    ds_write_b128 v12, v[96:99] offset:64
    ds_write_b128 v12, v[100:103] offset:80
    ds_write_b128 v12, v[104:107] offset:8320
    ds_write_b128 v12, v[108:111] offset:8336
    s_waitcnt lgkmcnt(0)
    s_barrier
    v_lshlrev_b32 v12, 6, v2
    ds_read_b128 v[64:67], v12 offset:32
    ds_read_b128 v[68:71], v12 offset:48
    ds_read_b128 v[72:75], v12 offset:64
    ds_read_b128 v[76:79], v12 offset:80
    ds_read_b128 v[80:83], v12 offset:96
    ds_read_b128 v[84:87], v12 offset:112
    ds_read_b128 v[88:91], v12 offset:8288
    ds_read_b128 v[92:95], v12 offset:8304
    ds_read_b128 v[96:99], v12 offset:8320
    ds_read_b128 v[100:103], v12 offset:8336
    ds_read_b128 v[104:107], v12 offset:8352
    ds_read_b128 v[108:111], v12 offset:8368
    s_waitcnt lgkmcnt(0)
    v_sub_f32 v13, v160, v64
    v_sub_f32 v14, v161, v65
    v_cvt_pk_bf16_f32 v13, v13, v14
    v_lshlrev_b32 v14, 16, v13
    v_mul_f32 v112, v14, v88
    v_and_b32 v14, 0xffff0000, v13
    v_mul_f32 v113, v14, v89
    v_sub_f32 v13, v162, v66
    v_sub_f32 v14, v163, v67
    v_cvt_pk_bf16_f32 v13, v13, v14
    v_lshlrev_b32 v14, 16, v13
    v_mul_f32 v114, v14, v90
    v_and_b32 v14, 0xffff0000, v13
    v_mul_f32 v115, v14, v91
    v_sub_f32 v13, v164, v68
    v_sub_f32 v14, v165, v69
    v_cvt_pk_bf16_f32 v13, v13, v14
    v_lshlrev_b32 v14, 16, v13
    v_mul_f32 v116, v14, v92
    v_and_b32 v14, 0xffff0000, v13
    v_mul_f32 v117, v14, v93
    v_sub_f32 v13, v166, v70
    v_sub_f32 v14, v167, v71
    v_cvt_pk_bf16_f32 v13, v13, v14
    v_lshlrev_b32 v14, 16, v13
    v_mul_f32 v118, v14, v94
    v_and_b32 v14, 0xffff0000, v13
    v_mul_f32 v119, v14, v95
    v_sub_f32 v13, v168, v72
    v_sub_f32 v14, v169, v73
    v_cvt_pk_bf16_f32 v13, v13, v14
    v_lshlrev_b32 v14, 16, v13
    v_mul_f32 v120, v14, v96
    v_and_b32 v14, 0xffff0000, v13
    v_mul_f32 v121, v14, v97
    v_sub_f32 v13, v170, v74
    v_sub_f32 v14, v171, v75
    v_cvt_pk_bf16_f32 v13, v13, v14
    v_lshlrev_b32 v14, 16, v13
    v_mul_f32 v122, v14, v98
    v_and_b32 v14, 0xffff0000, v13
    v_mul_f32 v123, v14, v99
    v_sub_f32 v13, v172, v76
    v_sub_f32 v14, v173, v77
    v_cvt_pk_bf16_f32 v13, v13, v14
    v_lshlrev_b32 v14, 16, v13
    v_mul_f32 v124, v14, v100
    v_and_b32 v14, 0xffff0000, v13
    v_mul_f32 v125, v14, v101
    v_sub_f32 v13, v174, v78
    v_sub_f32 v14, v175, v79
    v_cvt_pk_bf16_f32 v13, v13, v14
    v_lshlrev_b32 v14, 16, v13
    v_mul_f32 v126, v14, v102
    v_and_b32 v14, 0xffff0000, v13
    v_mul_f32 v127, v14, v103
    v_sub_f32 v13, v176, v80
    v_sub_f32 v14, v177, v81
    v_cvt_pk_bf16_f32 v13, v13, v14
    v_lshlrev_b32 v14, 16, v13
    v_mul_f32 v128, v14, v104
    v_and_b32 v14, 0xffff0000, v13
    v_mul_f32 v129, v14, v105
    v_sub_f32 v13, v178, v82
    v_sub_f32 v14, v179, v83
    v_cvt_pk_bf16_f32 v13, v13, v14
    v_lshlrev_b32 v14, 16, v13
    v_mul_f32 v130, v14, v106
    v_and_b32 v14, 0xffff0000, v13
    v_mul_f32 v131, v14, v107
    v_sub_f32 v13, v180, v84
    v_sub_f32 v14, v181, v85
    v_cvt_pk_bf16_f32 v13, v13, v14
    v_lshlrev_b32 v14, 16, v13
    v_mul_f32 v132, v14, v108
    v_and_b32 v14, 0xffff0000, v13
    v_mul_f32 v133, v14, v109
    v_sub_f32 v13, v182, v86
    v_sub_f32 v14, v183, v87
    v_cvt_pk_bf16_f32 v13, v13, v14
    v_lshlrev_b32 v14, 16, v13
    v_mul_f32 v134, v14, v110
    v_and_b32 v14, 0xffff0000, v13
    v_mul_f32 v135, v14, v111
    v_cmp_ne_u32 vcc, 0, v2
    s_nop 1
    v_cndmask_b32 v113, 0, v113, vcc
    v_cndmask_b32 v114, 0, v114, vcc
    v_cndmask_b32 v115, 0, v115, vcc
    v_cndmask_b32 v116, 0, v116, vcc
    v_cndmask_b32 v117, 0, v117, vcc
    v_cndmask_b32 v118, 0, v118, vcc
    v_cndmask_b32 v119, 0, v119, vcc
    v_cvt_pk_bf16_f32 v186, v116, v117
    v_cvt_pk_bf16_f32 v187, v118, v119
    v_cvt_pk_bf16_f32 v188, v120, v121
    v_cvt_pk_bf16_f32 v189, v122, v123
    v_cvt_pk_bf16_f32 v190, v124, v125
    v_cvt_pk_bf16_f32 v191, v126, v127
    v_cvt_pk_bf16_f32 v192, v128, v129
    v_cvt_pk_bf16_f32 v193, v130, v131
    v_cvt_pk_bf16_f32 v194, v132, v133
    v_cvt_pk_bf16_f32 v195, v134, v135
    v_cvt_pk_bf16_f32 v198, v114, v115
    v_cvt_pk_bf16_f32 v199, v116, v117
    v_cvt_pk_bf16_f32 v200, v118, v119
    v_cvt_pk_bf16_f32 v201, v120, v121
    v_cvt_pk_bf16_f32 v202, v122, v123
    v_cvt_pk_bf16_f32 v203, v124, v125
    v_cvt_pk_bf16_f32 v204, v126, v127
    v_cvt_pk_bf16_f32 v205, v128, v129
    v_cvt_pk_bf16_f32 v206, v130, v131
    v_cvt_pk_bf16_f32 v207, v132, v133
    v_cvt_pk_bf16_f32 v212, v113, v114
    v_cvt_pk_bf16_f32 v213, v115, v116
    v_cvt_pk_bf16_f32 v214, v117, v118
    v_cvt_pk_bf16_f32 v215, v119, v120
    v_cvt_pk_bf16_f32 v216, v121, v122
    v_cvt_pk_bf16_f32 v217, v123, v124
    v_cvt_pk_bf16_f32 v218, v125, v126
    v_cvt_pk_bf16_f32 v219, v127, v128
    v_cvt_pk_bf16_f32 v220, v129, v130
    v_cvt_pk_bf16_f32 v221, v131, v132
    v_cvt_pk_bf16_f32 v226, v115, v116
    v_cvt_pk_bf16_f32 v227, v117, v118
    v_cvt_pk_bf16_f32 v228, v119, v120
    v_cvt_pk_bf16_f32 v229, v121, v122
    v_cvt_pk_bf16_f32 v230, v123, v124
    v_cvt_pk_bf16_f32 v231, v125, v126
    v_cvt_pk_bf16_f32 v232, v127, v128
    v_cvt_pk_bf16_f32 v233, v129, v130
    v_cvt_pk_bf16_f32 v234, v131, v132
    v_cvt_pk_bf16_f32 v235, v133, v134
    v_lshrrev_b32 v12, 4, v2
    v_mul_u32_u24 v12, 640, v12
    v_and_b32 v13, 15, v2
    v_lshl_add_u32 v12, v13, 5, v12
    v_add_u32 v12, v7, v12
    ds_write_b128 v12, v[212:215] offset:9216
    ds_write_b128 v12, v[216:219] offset:9232
    ds_write_b128 v12, v[198:201] offset:14352
    ds_write_b128 v12, v[202:205] offset:14368
    ds_write_b128 v12, v[226:229] offset:19488
    ds_write_b128 v12, v[230:233] offset:19504
    ds_write_b128 v12, v[186:189] offset:24624
    ds_write_b128 v12, v[190:193] offset:24640
    ds_write_b128 v12, v[214:217] offset:29760
    ds_write_b128 v12, v[218:221] offset:29776
    ds_write_b128 v12, v[200:203] offset:34896
    ds_write_b128 v12, v[204:207] offset:34912
    ds_write_b128 v12, v[228:231] offset:40032
    ds_write_b128 v12, v[232:235] offset:40048
    ds_write_b128 v12, v[188:191] offset:45168
    ds_write_b128 v12, v[192:195] offset:45184
    s_waitcnt lgkmcnt(0)
    s_barrier
    v_and_b32 v12, 31, v0
    v_bfe_u32 v13, v0, 5, 1
    v_lshlrev_b32 v14, 4, v13
    v_lshlrev_b32 v15, 4, v12
    v_sub_u32 v15, v14, v15
    v_add_u32 v15, v7, v15
    v_add_u32 v112, 496, v15
    v_and_b32 v16, 7, v0
    v_bfe_u32 v17, v0, 3, 2
    v_mul_u32_u24 v16, 5136, v16
    v_add_u32 v16, v7, v16
    v_add_u32 v16, v14, v16
    v_add_u32 v18, v7, v14
    v_add_u32 v18, 41088, v18
    v_bfe_u32 v21, v0, 6, 1
    s_nop 0
    v_readfirstlane_b32 s41, v21
    v_mov_b32 v128, 0
    v_mov_b32 v129, 0
    v_mov_b32 v130, 0
    v_mov_b32 v131, 0
    v_mov_b32 v132, 0
    v_mov_b32 v133, 0
    v_mov_b32 v134, 0
    v_mov_b32 v135, 0
    v_mov_b32 v136, 0
    v_mov_b32 v137, 0
    v_mov_b32 v138, 0
    v_mov_b32 v139, 0
    v_mov_b32 v140, 0
    v_mov_b32 v141, 0
    v_mov_b32 v142, 0
    v_mov_b32 v143, 0
    v_mov_b32 v144, 0
    v_mov_b32 v145, 0
    v_mov_b32 v146, 0
    v_mov_b32 v147, 0
    v_mov_b32 v148, 0
    v_mov_b32 v149, 0
    v_mov_b32 v150, 0
    v_mov_b32 v151, 0
    v_mov_b32 v152, 0
    v_mov_b32 v153, 0
    v_mov_b32 v154, 0
    v_mov_b32 v155, 0
    v_mov_b32 v156, 0
    v_mov_b32 v157, 0
    v_mov_b32 v158, 0
    v_mov_b32 v159, 0
    s_cmp_eq_u32 s41, 1
    s_cbranch_scc1 conv_waveB
    v_add_u32 v19, 0, v17
    v_mul_i32_i24 v20, 640, v19
    v_add_u32 v20, v16, v20
    v_cmp_gt_i32 vcc, 0, v19
    s_nop 1
    v_cndmask_b32 v114, v20, v18, vcc
    v_add_u32 v19, -1, v17
    v_mul_i32_i24 v20, 640, v19
    v_add_u32 v20, v16, v20
    v_cmp_gt_i32 vcc, 0, v19
    s_nop 1
    v_cndmask_b32 v115, v20, v18, vcc
    v_add_u32 v19, -2, v17
    v_mul_i32_i24 v20, 640, v19
    v_add_u32 v20, v16, v20
    v_cmp_gt_i32 vcc, 0, v19
    s_nop 1
    v_cndmask_b32 v116, v20, v18, vcc
    v_add_u32 v19, -3, v17
    v_mul_i32_i24 v20, 640, v19
    v_add_u32 v20, v16, v20
    v_cmp_gt_i32 vcc, 0, v19
    s_nop 1
    v_cndmask_b32 v117, v20, v18, vcc
    v_add_u32 v19, 4, v17
    v_mul_i32_i24 v20, 640, v19
    v_add_u32 v20, v16, v20
    v_cmp_gt_i32 vcc, 0, v19
    s_nop 1
    v_cndmask_b32 v118, v20, v18, vcc
    v_add_u32 v19, 3, v17
    v_mul_i32_i24 v20, 640, v19
    v_add_u32 v20, v16, v20
    v_cmp_gt_i32 vcc, 0, v19
    s_nop 1
    v_cndmask_b32 v119, v20, v18, vcc
    ds_read_b128 v[64:67], v112 offset:3584
    ds_read_b128 v[68:71], v112 offset:8192
    ds_read_b128 v[72:75], v114 offset:9216
    ds_read_b128 v[76:79], v118 offset:9216
    ds_read_b128 v[80:83], v112 offset:3616
    ds_read_b128 v[84:87], v112 offset:8224
    ds_read_b128 v[88:91], v114 offset:9248
    ds_read_b128 v[92:95], v118 offset:9248
    ds_read_b128 v[96:99], v112 offset:3648
    ds_read_b128 v[100:103], v112 offset:8256
    ds_read_b128 v[104:107], v114 offset:9280
    ds_read_b128 v[108:111], v118 offset:9280
    s_waitcnt lgkmcnt(8)
    v_mfma_f32_32x32x16_bf16 v[128:143], v[64:67], v[72:75], v[128:143]
    v_mfma_f32_32x32x16_bf16 v[128:143], v[68:71], v[72:75], v[128:143]
    v_mfma_f32_32x32x16_bf16 v[144:159], v[64:67], v[76:79], v[144:159]
    v_mfma_f32_32x32x16_bf16 v[144:159], v[68:71], v[76:79], v[144:159]
    ds_read_b128 v[64:67], v112 offset:3680
    ds_read_b128 v[68:71], v112 offset:8288
    ds_read_b128 v[72:75], v114 offset:9312
    ds_read_b128 v[76:79], v118 offset:9312
    s_waitcnt lgkmcnt(8)
    v_mfma_f32_32x32x16_bf16 v[128:143], v[80:83], v[88:91], v[128:143]
    v_mfma_f32_32x32x16_bf16 v[128:143], v[84:87], v[88:91], v[128:143]
    v_mfma_f32_32x32x16_bf16 v[144:159], v[80:83], v[92:95], v[144:159]
    v_mfma_f32_32x32x16_bf16 v[144:159], v[84:87], v[92:95], v[144:159]
    ds_read_b128 v[80:83], v112 offset:3712
    ds_read_b128 v[84:87], v112 offset:8320
    ds_read_b128 v[88:91], v114 offset:9344
    ds_read_b128 v[92:95], v118 offset:9344
    s_waitcnt lgkmcnt(8)
    v_mfma_f32_32x32x16_bf16 v[128:143], v[96:99], v[104:107], v[128:143]
    v_mfma_f32_32x32x16_bf16 v[128:143], v[100:103], v[104:107], v[128:143]
    v_mfma_f32_32x32x16_bf16 v[144:159], v[96:99], v[108:111], v[144:159]
    v_mfma_f32_32x32x16_bf16 v[144:159], v[100:103], v[108:111], v[144:159]
    ds_read_b128 v[96:99], v112 offset:3744
    ds_read_b128 v[100:103], v112 offset:8352
    ds_read_b128 v[104:107], v114 offset:9376
    ds_read_b128 v[108:111], v118 offset:9376
    s_waitcnt lgkmcnt(8)
    v_mfma_f32_32x32x16_bf16 v[128:143], v[64:67], v[72:75], v[128:143]
    v_mfma_f32_32x32x16_bf16 v[128:143], v[68:71], v[72:75], v[128:143]
    v_mfma_f32_32x32x16_bf16 v[144:159], v[64:67], v[76:79], v[144:159]
    v_mfma_f32_32x32x16_bf16 v[144:159], v[68:71], v[76:79], v[144:159]
    ds_read_b128 v[64:67], v112 offset:3776
    ds_read_b128 v[68:71], v112 offset:8384
    ds_read_b128 v[72:75], v114 offset:9408
    ds_read_b128 v[76:79], v118 offset:9408
    s_waitcnt lgkmcnt(8)
    v_mfma_f32_32x32x16_bf16 v[128:143], v[80:83], v[88:91], v[128:143]
    v_mfma_f32_32x32x16_bf16 v[128:143], v[84:87], v[88:91], v[128:143]
    v_mfma_f32_32x32x16_bf16 v[144:159], v[80:83], v[92:95], v[144:159]
    v_mfma_f32_32x32x16_bf16 v[144:159], v[84:87], v[92:95], v[144:159]
    ds_read_b128 v[80:83], v112 offset:3808
    ds_read_b128 v[84:87], v112 offset:8416
    ds_read_b128 v[88:91], v114 offset:9440
    ds_read_b128 v[92:95], v118 offset:9440
    s_waitcnt lgkmcnt(8)
    v_mfma_f32_32x32x16_bf16 v[128:143], v[96:99], v[104:107], v[128:143]
    v_mfma_f32_32x32x16_bf16 v[128:143], v[100:103], v[104:107], v[128:143]
    v_mfma_f32_32x32x16_bf16 v[144:159], v[96:99], v[108:111], v[144:159]
    v_mfma_f32_32x32x16_bf16 v[144:159], v[100:103], v[108:111], v[144:159]
    ds_read_b128 v[96:99], v112 offset:3840
    ds_read_b128 v[100:103], v112 offset:8448
    ds_read_b128 v[104:107], v114 offset:9472
    ds_read_b128 v[108:111], v118 offset:9472
    s_waitcnt lgkmcnt(8)
    v_mfma_f32_32x32x16_bf16 v[128:143], v[64:67], v[72:75], v[128:143]
    v_mfma_f32_32x32x16_bf16 v[128:143], v[68:71], v[72:75], v[128:143]
    v_mfma_f32_32x32x16_bf16 v[144:159], v[64:67], v[76:79], v[144:159]
    v_mfma_f32_32x32x16_bf16 v[144:159], v[68:71], v[76:79], v[144:159]
    ds_read_b128 v[64:67], v112 offset:3872
    ds_read_b128 v[68:71], v112 offset:8480
    ds_read_b128 v[72:75], v114 offset:9504
    ds_read_b128 v[76:79], v118 offset:9504
    s_waitcnt lgkmcnt(8)
    v_mfma_f32_32x32x16_bf16 v[128:143], v[80:83], v[88:91], v[128:143]
    v_mfma_f32_32x32x16_bf16 v[128:143], v[84:87], v[88:91], v[128:143]
    v_mfma_f32_32x32x16_bf16 v[144:159], v[80:83], v[92:95], v[144:159]
    v_mfma_f32_32x32x16_bf16 v[144:159], v[84:87], v[92:95], v[144:159]
    ds_read_b128 v[80:83], v112 offset:3904
    ds_read_b128 v[84:87], v112 offset:8512
    ds_read_b128 v[88:91], v114 offset:9536
    ds_read_b128 v[92:95], v118 offset:9536
    s_waitcnt lgkmcnt(8)
    v_mfma_f32_32x32x16_bf16 v[128:143], v[96:99], v[104:107], v[128:143]
    v_mfma_f32_32x32x16_bf16 v[128:143], v[100:103], v[104:107], v[128:143]
    v_mfma_f32_32x32x16_bf16 v[144:159], v[96:99], v[108:111], v[144:159]
    v_mfma_f32_32x32x16_bf16 v[144:159], v[100:103], v[108:111], v[144:159]
    ds_read_b128 v[96:99], v112 offset:3936
    ds_read_b128 v[100:103], v112 offset:8544
    ds_read_b128 v[104:107], v114 offset:9568
    ds_read_b128 v[108:111], v118 offset:9568
    s_waitcnt lgkmcnt(8)
    v_mfma_f32_32x32x16_bf16 v[128:143], v[64:67], v[72:75], v[128:143]
    v_mfma_f32_32x32x16_bf16 v[128:143], v[68:71], v[72:75], v[128:143]
    v_mfma_f32_32x32x16_bf16 v[144:159], v[64:67], v[76:79], v[144:159]
    v_mfma_f32_32x32x16_bf16 v[144:159], v[68:71], v[76:79], v[144:159]
    ds_read_b128 v[64:67], v112 offset:3968
    ds_read_b128 v[68:71], v112 offset:8576
    ds_read_b128 v[72:75], v114 offset:9600
    ds_read_b128 v[76:79], v118 offset:9600
    s_waitcnt lgkmcnt(8)
    v_mfma_f32_32x32x16_bf16 v[128:143], v[80:83], v[88:91], v[128:143]
    v_mfma_f32_32x32x16_bf16 v[128:143], v[84:87], v[88:91], v[128:143]
    v_mfma_f32_32x32x16_bf16 v[144:159], v[80:83], v[92:95], v[144:159]
    v_mfma_f32_32x32x16_bf16 v[144:159], v[84:87], v[92:95], v[144:159]
    ds_read_b128 v[80:83], v112 offset:4000
    ds_read_b128 v[84:87], v112 offset:8608
    ds_read_b128 v[88:91], v114 offset:9632
    ds_read_b128 v[92:95], v118 offset:9632
    s_waitcnt lgkmcnt(8)
    v_mfma_f32_32x32x16_bf16 v[128:143], v[96:99], v[104:107], v[128:143]
    v_mfma_f32_32x32x16_bf16 v[128:143], v[100:103], v[104:107], v[128:143]
    v_mfma_f32_32x32x16_bf16 v[144:159], v[96:99], v[108:111], v[144:159]
    v_mfma_f32_32x32x16_bf16 v[144:159], v[100:103], v[108:111], v[144:159]
    ds_read_b128 v[96:99], v112 offset:4032
    ds_read_b128 v[100:103], v112 offset:8640
    ds_read_b128 v[104:107], v114 offset:9664
    ds_read_b128 v[108:111], v118 offset:9664
    s_waitcnt lgkmcnt(8)
    v_mfma_f32_32x32x16_bf16 v[128:143], v[64:67], v[72:75], v[128:143]
    v_mfma_f32_32x32x16_bf16 v[128:143], v[68:71], v[72:75], v[128:143]
    v_mfma_f32_32x32x16_bf16 v[144:159], v[64:67], v[76:79], v[144:159]
    v_mfma_f32_32x32x16_bf16 v[144:159], v[68:71], v[76:79], v[144:159]
    ds_read_b128 v[64:67], v112 offset:4064
    ds_read_b128 v[68:71], v112 offset:8672
    ds_read_b128 v[72:75], v114 offset:9696
    ds_read_b128 v[76:79], v118 offset:9696
    s_waitcnt lgkmcnt(8)
    v_mfma_f32_32x32x16_bf16 v[128:143], v[80:83], v[88:91], v[128:143]
    v_mfma_f32_32x32x16_bf16 v[128:143], v[84:87], v[88:91], v[128:143]
    v_mfma_f32_32x32x16_bf16 v[144:159], v[80:83], v[92:95], v[144:159]
    v_mfma_f32_32x32x16_bf16 v[144:159], v[84:87], v[92:95], v[144:159]
    ds_read_b128 v[80:83], v112 offset:3072
    ds_read_b128 v[84:87], v112 offset:7680
    ds_read_b128 v[88:91], v115 offset:9216
    ds_read_b128 v[92:95], v119 offset:9216
    s_waitcnt lgkmcnt(8)
    v_mfma_f32_32x32x16_bf16 v[128:143], v[96:99], v[104:107], v[128:143]
    v_mfma_f32_32x32x16_bf16 v[128:143], v[100:103], v[104:107], v[128:143]
    v_mfma_f32_32x32x16_bf16 v[144:159], v[96:99], v[108:111], v[144:159]
    v_mfma_f32_32x32x16_bf16 v[144:159], v[100:103], v[108:111], v[144:159]
    ds_read_b128 v[96:99], v112 offset:3104
    ds_read_b128 v[100:103], v112 offset:7712
    ds_read_b128 v[104:107], v115 offset:9248
    ds_read_b128 v[108:111], v119 offset:9248
    s_waitcnt lgkmcnt(8)
    v_mfma_f32_32x32x16_bf16 v[128:143], v[64:67], v[72:75], v[128:143]
    v_mfma_f32_32x32x16_bf16 v[128:143], v[68:71], v[72:75], v[128:143]
    v_mfma_f32_32x32x16_bf16 v[144:159], v[64:67], v[76:79], v[144:159]
    v_mfma_f32_32x32x16_bf16 v[144:159], v[68:71], v[76:79], v[144:159]
    ds_read_b128 v[64:67], v112 offset:3136
    ds_read_b128 v[68:71], v112 offset:7744
    ds_read_b128 v[72:75], v115 offset:9280
    ds_read_b128 v[76:79], v119 offset:9280
    s_waitcnt lgkmcnt(8)
    v_mfma_f32_32x32x16_bf16 v[128:143], v[80:83], v[88:91], v[128:143]
    v_mfma_f32_32x32x16_bf16 v[128:143], v[84:87], v[88:91], v[128:143]
    v_mfma_f32_32x32x16_bf16 v[144:159], v[80:83], v[92:95], v[144:159]
    v_mfma_f32_32x32x16_bf16 v[144:159], v[84:87], v[92:95], v[144:159]
    ds_read_b128 v[80:83], v112 offset:3168
    ds_read_b128 v[84:87], v112 offset:7776
    ds_read_b128 v[88:91], v115 offset:9312
    ds_read_b128 v[92:95], v119 offset:9312
    s_waitcnt lgkmcnt(8)
    v_mfma_f32_32x32x16_bf16 v[128:143], v[96:99], v[104:107], v[128:143]
    v_mfma_f32_32x32x16_bf16 v[128:143], v[100:103], v[104:107], v[128:143]
    v_mfma_f32_32x32x16_bf16 v[144:159], v[96:99], v[108:111], v[144:159]
    v_mfma_f32_32x32x16_bf16 v[144:159], v[100:103], v[108:111], v[144:159]
    ds_read_b128 v[96:99], v112 offset:3200
    ds_read_b128 v[100:103], v112 offset:7808
    ds_read_b128 v[104:107], v115 offset:9344
    ds_read_b128 v[108:111], v119 offset:9344
    s_waitcnt lgkmcnt(8)
    v_mfma_f32_32x32x16_bf16 v[128:143], v[64:67], v[72:75], v[128:143]
    v_mfma_f32_32x32x16_bf16 v[128:143], v[68:71], v[72:75], v[128:143]
    v_mfma_f32_32x32x16_bf16 v[144:159], v[64:67], v[76:79], v[144:159]
    v_mfma_f32_32x32x16_bf16 v[144:159], v[68:71], v[76:79], v[144:159]
    ds_read_b128 v[64:67], v112 offset:3232
    ds_read_b128 v[68:71], v112 offset:7840
    ds_read_b128 v[72:75], v115 offset:9376
    ds_read_b128 v[76:79], v119 offset:9376
    s_waitcnt lgkmcnt(8)
    v_mfma_f32_32x32x16_bf16 v[128:143], v[80:83], v[88:91], v[128:143]
    v_mfma_f32_32x32x16_bf16 v[128:143], v[84:87], v[88:91], v[128:143]
    v_mfma_f32_32x32x16_bf16 v[144:159], v[80:83], v[92:95], v[144:159]
    v_mfma_f32_32x32x16_bf16 v[144:159], v[84:87], v[92:95], v[144:159]
    ds_read_b128 v[80:83], v112 offset:3264
    ds_read_b128 v[84:87], v112 offset:7872
    ds_read_b128 v[88:91], v115 offset:9408
    ds_read_b128 v[92:95], v119 offset:9408
    s_waitcnt lgkmcnt(8)
    v_mfma_f32_32x32x16_bf16 v[128:143], v[96:99], v[104:107], v[128:143]
    v_mfma_f32_32x32x16_bf16 v[128:143], v[100:103], v[104:107], v[128:143]
    v_mfma_f32_32x32x16_bf16 v[144:159], v[96:99], v[108:111], v[144:159]
    v_mfma_f32_32x32x16_bf16 v[144:159], v[100:103], v[108:111], v[144:159]
    ds_read_b128 v[96:99], v112 offset:3296
    ds_read_b128 v[100:103], v112 offset:7904
    ds_read_b128 v[104:107], v115 offset:9440
    ds_read_b128 v[108:111], v119 offset:9440
    s_waitcnt lgkmcnt(8)
    v_mfma_f32_32x32x16_bf16 v[128:143], v[64:67], v[72:75], v[128:143]
    v_mfma_f32_32x32x16_bf16 v[128:143], v[68:71], v[72:75], v[128:143]
    v_mfma_f32_32x32x16_bf16 v[144:159], v[64:67], v[76:79], v[144:159]
    v_mfma_f32_32x32x16_bf16 v[144:159], v[68:71], v[76:79], v[144:159]
    ds_read_b128 v[64:67], v112 offset:3328
    ds_read_b128 v[68:71], v112 offset:7936
    ds_read_b128 v[72:75], v115 offset:9472
    ds_read_b128 v[76:79], v119 offset:9472
    s_waitcnt lgkmcnt(8)
    v_mfma_f32_32x32x16_bf16 v[128:143], v[80:83], v[88:91], v[128:143]
    v_mfma_f32_32x32x16_bf16 v[128:143], v[84:87], v[88:91], v[128:143]
    v_mfma_f32_32x32x16_bf16 v[144:159], v[80:83], v[92:95], v[144:159]
    v_mfma_f32_32x32x16_bf16 v[144:159], v[84:87], v[92:95], v[144:159]
    ds_read_b128 v[80:83], v112 offset:3360
    ds_read_b128 v[84:87], v112 offset:7968
    ds_read_b128 v[88:91], v115 offset:9504
    ds_read_b128 v[92:95], v119 offset:9504
    s_waitcnt lgkmcnt(8)
    v_mfma_f32_32x32x16_bf16 v[128:143], v[96:99], v[104:107], v[128:143]
    v_mfma_f32_32x32x16_bf16 v[128:143], v[100:103], v[104:107], v[128:143]
    v_mfma_f32_32x32x16_bf16 v[144:159], v[96:99], v[108:111], v[144:159]
    v_mfma_f32_32x32x16_bf16 v[144:159], v[100:103], v[108:111], v[144:159]
    ds_read_b128 v[96:99], v112 offset:3392
    ds_read_b128 v[100:103], v112 offset:8000
    ds_read_b128 v[104:107], v115 offset:9536
    ds_read_b128 v[108:111], v119 offset:9536
    s_waitcnt lgkmcnt(8)
    v_mfma_f32_32x32x16_bf16 v[128:143], v[64:67], v[72:75], v[128:143]
    v_mfma_f32_32x32x16_bf16 v[128:143], v[68:71], v[72:75], v[128:143]
    v_mfma_f32_32x32x16_bf16 v[144:159], v[64:67], v[76:79], v[144:159]
    v_mfma_f32_32x32x16_bf16 v[144:159], v[68:71], v[76:79], v[144:159]
    ds_read_b128 v[64:67], v112 offset:3424
    ds_read_b128 v[68:71], v112 offset:8032
    ds_read_b128 v[72:75], v115 offset:9568
    ds_read_b128 v[76:79], v119 offset:9568
    s_waitcnt lgkmcnt(8)
    v_mfma_f32_32x32x16_bf16 v[128:143], v[80:83], v[88:91], v[128:143]
    v_mfma_f32_32x32x16_bf16 v[128:143], v[84:87], v[88:91], v[128:143]
    v_mfma_f32_32x32x16_bf16 v[144:159], v[80:83], v[92:95], v[144:159]
    v_mfma_f32_32x32x16_bf16 v[144:159], v[84:87], v[92:95], v[144:159]
    ds_read_b128 v[80:83], v112 offset:3456
    ds_read_b128 v[84:87], v112 offset:8064
    ds_read_b128 v[88:91], v115 offset:9600
    ds_read_b128 v[92:95], v119 offset:9600
    s_waitcnt lgkmcnt(8)
    v_mfma_f32_32x32x16_bf16 v[128:143], v[96:99], v[104:107], v[128:143]
    v_mfma_f32_32x32x16_bf16 v[128:143], v[100:103], v[104:107], v[128:143]
    v_mfma_f32_32x32x16_bf16 v[144:159], v[96:99], v[108:111], v[144:159]
    v_mfma_f32_32x32x16_bf16 v[144:159], v[100:103], v[108:111], v[144:159]
    ds_read_b128 v[96:99], v112 offset:3488
    ds_read_b128 v[100:103], v112 offset:8096
    ds_read_b128 v[104:107], v115 offset:9632
    ds_read_b128 v[108:111], v119 offset:9632
    s_waitcnt lgkmcnt(8)
    v_mfma_f32_32x32x16_bf16 v[128:143], v[64:67], v[72:75], v[128:143]
    v_mfma_f32_32x32x16_bf16 v[128:143], v[68:71], v[72:75], v[128:143]
    v_mfma_f32_32x32x16_bf16 v[144:159], v[64:67], v[76:79], v[144:159]
    v_mfma_f32_32x32x16_bf16 v[144:159], v[68:71], v[76:79], v[144:159]
    ds_read_b128 v[64:67], v112 offset:3520
    ds_read_b128 v[68:71], v112 offset:8128
    ds_read_b128 v[72:75], v115 offset:9664
    ds_read_b128 v[76:79], v119 offset:9664
    s_waitcnt lgkmcnt(8)
    v_mfma_f32_32x32x16_bf16 v[128:143], v[80:83], v[88:91], v[128:143]
    v_mfma_f32_32x32x16_bf16 v[128:143], v[84:87], v[88:91], v[128:143]
    v_mfma_f32_32x32x16_bf16 v[144:159], v[80:83], v[92:95], v[144:159]
    v_mfma_f32_32x32x16_bf16 v[144:159], v[84:87], v[92:95], v[144:159]
    ds_read_b128 v[80:83], v112 offset:3552
    ds_read_b128 v[84:87], v112 offset:8160
    ds_read_b128 v[88:91], v115 offset:9696
    ds_read_b128 v[92:95], v119 offset:9696
    s_waitcnt lgkmcnt(8)
    v_mfma_f32_32x32x16_bf16 v[128:143], v[96:99], v[104:107], v[128:143]
    v_mfma_f32_32x32x16_bf16 v[128:143], v[100:103], v[104:107], v[128:143]
    v_mfma_f32_32x32x16_bf16 v[144:159], v[96:99], v[108:111], v[144:159]
    v_mfma_f32_32x32x16_bf16 v[144:159], v[100:103], v[108:111], v[144:159]
    ds_read_b128 v[96:99], v112 offset:2560
    ds_read_b128 v[100:103], v112 offset:7168
    ds_read_b128 v[104:107], v116 offset:9216
    s_waitcnt lgkmcnt(7)
    v_mfma_f32_32x32x16_bf16 v[128:143], v[64:67], v[72:75], v[128:143]
    v_mfma_f32_32x32x16_bf16 v[128:143], v[68:71], v[72:75], v[128:143]
    v_mfma_f32_32x32x16_bf16 v[144:159], v[64:67], v[76:79], v[144:159]
    v_mfma_f32_32x32x16_bf16 v[144:159], v[68:71], v[76:79], v[144:159]
    ds_read_b128 v[64:67], v112 offset:2592
    ds_read_b128 v[68:71], v112 offset:7200
    ds_read_b128 v[72:75], v116 offset:9248
    s_waitcnt lgkmcnt(6)
    v_mfma_f32_32x32x16_bf16 v[128:143], v[80:83], v[88:91], v[128:143]
    v_mfma_f32_32x32x16_bf16 v[128:143], v[84:87], v[88:91], v[128:143]
    v_mfma_f32_32x32x16_bf16 v[144:159], v[80:83], v[92:95], v[144:159]
    v_mfma_f32_32x32x16_bf16 v[144:159], v[84:87], v[92:95], v[144:159]
    ds_read_b128 v[80:83], v112 offset:2624
    ds_read_b128 v[84:87], v112 offset:7232
    ds_read_b128 v[88:91], v116 offset:9280
    s_waitcnt lgkmcnt(6)
    v_mfma_f32_32x32x16_bf16 v[128:143], v[96:99], v[104:107], v[128:143]
    v_mfma_f32_32x32x16_bf16 v[128:143], v[100:103], v[104:107], v[128:143]
    ds_read_b128 v[96:99], v112 offset:2656
    ds_read_b128 v[100:103], v112 offset:7264
    ds_read_b128 v[104:107], v116 offset:9312
    s_waitcnt lgkmcnt(6)
    v_mfma_f32_32x32x16_bf16 v[128:143], v[64:67], v[72:75], v[128:143]
    v_mfma_f32_32x32x16_bf16 v[128:143], v[68:71], v[72:75], v[128:143]
    ds_read_b128 v[64:67], v112 offset:2688
    ds_read_b128 v[68:71], v112 offset:7296
    ds_read_b128 v[72:75], v116 offset:9344
    s_waitcnt lgkmcnt(6)
    v_mfma_f32_32x32x16_bf16 v[128:143], v[80:83], v[88:91], v[128:143]
    v_mfma_f32_32x32x16_bf16 v[128:143], v[84:87], v[88:91], v[128:143]
    ds_read_b128 v[80:83], v112 offset:2720
    ds_read_b128 v[84:87], v112 offset:7328
    ds_read_b128 v[88:91], v116 offset:9376
    s_waitcnt lgkmcnt(6)
    v_mfma_f32_32x32x16_bf16 v[128:143], v[96:99], v[104:107], v[128:143]
    v_mfma_f32_32x32x16_bf16 v[128:143], v[100:103], v[104:107], v[128:143]
    ds_read_b128 v[96:99], v112 offset:2752
    ds_read_b128 v[100:103], v112 offset:7360
    ds_read_b128 v[104:107], v116 offset:9408
    s_waitcnt lgkmcnt(6)
    v_mfma_f32_32x32x16_bf16 v[128:143], v[64:67], v[72:75], v[128:143]
    v_mfma_f32_32x32x16_bf16 v[128:143], v[68:71], v[72:75], v[128:143]
    ds_read_b128 v[64:67], v112 offset:2784
    ds_read_b128 v[68:71], v112 offset:7392
    ds_read_b128 v[72:75], v116 offset:9440
    s_waitcnt lgkmcnt(6)
    v_mfma_f32_32x32x16_bf16 v[128:143], v[80:83], v[88:91], v[128:143]
    v_mfma_f32_32x32x16_bf16 v[128:143], v[84:87], v[88:91], v[128:143]
    ds_read_b128 v[80:83], v112 offset:2816
    ds_read_b128 v[84:87], v112 offset:7424
    ds_read_b128 v[88:91], v116 offset:9472
    s_waitcnt lgkmcnt(6)
    v_mfma_f32_32x32x16_bf16 v[128:143], v[96:99], v[104:107], v[128:143]
    v_mfma_f32_32x32x16_bf16 v[128:143], v[100:103], v[104:107], v[128:143]
    ds_read_b128 v[96:99], v112 offset:2848
    ds_read_b128 v[100:103], v112 offset:7456
    ds_read_b128 v[104:107], v116 offset:9504
    s_waitcnt lgkmcnt(6)
    v_mfma_f32_32x32x16_bf16 v[128:143], v[64:67], v[72:75], v[128:143]
    v_mfma_f32_32x32x16_bf16 v[128:143], v[68:71], v[72:75], v[128:143]
    ds_read_b128 v[64:67], v112 offset:2880
    ds_read_b128 v[68:71], v112 offset:7488
    ds_read_b128 v[72:75], v116 offset:9536
    s_waitcnt lgkmcnt(6)
    v_mfma_f32_32x32x16_bf16 v[128:143], v[80:83], v[88:91], v[128:143]
    v_mfma_f32_32x32x16_bf16 v[128:143], v[84:87], v[88:91], v[128:143]
    ds_read_b128 v[80:83], v112 offset:2912
    ds_read_b128 v[84:87], v112 offset:7520
    ds_read_b128 v[88:91], v116 offset:9568
    s_waitcnt lgkmcnt(6)
    v_mfma_f32_32x32x16_bf16 v[128:143], v[96:99], v[104:107], v[128:143]
    v_mfma_f32_32x32x16_bf16 v[128:143], v[100:103], v[104:107], v[128:143]
    ds_read_b128 v[96:99], v112 offset:2944
    ds_read_b128 v[100:103], v112 offset:7552
    ds_read_b128 v[104:107], v116 offset:9600
    s_waitcnt lgkmcnt(6)
    v_mfma_f32_32x32x16_bf16 v[128:143], v[64:67], v[72:75], v[128:143]
    v_mfma_f32_32x32x16_bf16 v[128:143], v[68:71], v[72:75], v[128:143]
    ds_read_b128 v[64:67], v112 offset:2976
    ds_read_b128 v[68:71], v112 offset:7584
    ds_read_b128 v[72:75], v116 offset:9632
    s_waitcnt lgkmcnt(6)
    v_mfma_f32_32x32x16_bf16 v[128:143], v[80:83], v[88:91], v[128:143]
    v_mfma_f32_32x32x16_bf16 v[128:143], v[84:87], v[88:91], v[128:143]
    ds_read_b128 v[80:83], v112 offset:3008
    ds_read_b128 v[84:87], v112 offset:7616
    ds_read_b128 v[88:91], v116 offset:9664
    s_waitcnt lgkmcnt(6)
    v_mfma_f32_32x32x16_bf16 v[128:143], v[96:99], v[104:107], v[128:143]
    v_mfma_f32_32x32x16_bf16 v[128:143], v[100:103], v[104:107], v[128:143]
    ds_read_b128 v[96:99], v112 offset:3040
    ds_read_b128 v[100:103], v112 offset:7648
    ds_read_b128 v[104:107], v116 offset:9696
    s_waitcnt lgkmcnt(6)
    v_mfma_f32_32x32x16_bf16 v[128:143], v[64:67], v[72:75], v[128:143]
    v_mfma_f32_32x32x16_bf16 v[128:143], v[68:71], v[72:75], v[128:143]
    ds_read_b128 v[64:67], v112 offset:2048
    ds_read_b128 v[68:71], v112 offset:6656
    ds_read_b128 v[72:75], v117 offset:9216
    s_waitcnt lgkmcnt(6)
    v_mfma_f32_32x32x16_bf16 v[128:143], v[80:83], v[88:91], v[128:143]
    v_mfma_f32_32x32x16_bf16 v[128:143], v[84:87], v[88:91], v[128:143]
    ds_read_b128 v[80:83], v112 offset:2080
    ds_read_b128 v[84:87], v112 offset:6688
    ds_read_b128 v[88:91], v117 offset:9248
    s_waitcnt lgkmcnt(6)
    v_mfma_f32_32x32x16_bf16 v[128:143], v[96:99], v[104:107], v[128:143]
    v_mfma_f32_32x32x16_bf16 v[128:143], v[100:103], v[104:107], v[128:143]
    ds_read_b128 v[96:99], v112 offset:2112
    ds_read_b128 v[100:103], v112 offset:6720
    ds_read_b128 v[104:107], v117 offset:9280
    s_waitcnt lgkmcnt(6)
    v_mfma_f32_32x32x16_bf16 v[128:143], v[64:67], v[72:75], v[128:143]
    v_mfma_f32_32x32x16_bf16 v[128:143], v[68:71], v[72:75], v[128:143]
    ds_read_b128 v[64:67], v112 offset:2144
    ds_read_b128 v[68:71], v112 offset:6752
    ds_read_b128 v[72:75], v117 offset:9312
    s_waitcnt lgkmcnt(6)
    v_mfma_f32_32x32x16_bf16 v[128:143], v[80:83], v[88:91], v[128:143]
    v_mfma_f32_32x32x16_bf16 v[128:143], v[84:87], v[88:91], v[128:143]
    ds_read_b128 v[80:83], v112 offset:2176
    ds_read_b128 v[84:87], v112 offset:6784
    ds_read_b128 v[88:91], v117 offset:9344
    s_waitcnt lgkmcnt(6)
    v_mfma_f32_32x32x16_bf16 v[128:143], v[96:99], v[104:107], v[128:143]
    v_mfma_f32_32x32x16_bf16 v[128:143], v[100:103], v[104:107], v[128:143]
    ds_read_b128 v[96:99], v112 offset:2208
    ds_read_b128 v[100:103], v112 offset:6816
    ds_read_b128 v[104:107], v117 offset:9376
    s_waitcnt lgkmcnt(6)
    v_mfma_f32_32x32x16_bf16 v[128:143], v[64:67], v[72:75], v[128:143]
    v_mfma_f32_32x32x16_bf16 v[128:143], v[68:71], v[72:75], v[128:143]
    ds_read_b128 v[64:67], v112 offset:2240
    ds_read_b128 v[68:71], v112 offset:6848
    ds_read_b128 v[72:75], v117 offset:9408
    s_waitcnt lgkmcnt(6)
    v_mfma_f32_32x32x16_bf16 v[128:143], v[80:83], v[88:91], v[128:143]
    v_mfma_f32_32x32x16_bf16 v[128:143], v[84:87], v[88:91], v[128:143]
    ds_read_b128 v[80:83], v112 offset:2272
    ds_read_b128 v[84:87], v112 offset:6880
    ds_read_b128 v[88:91], v117 offset:9440
    s_waitcnt lgkmcnt(6)
    v_mfma_f32_32x32x16_bf16 v[128:143], v[96:99], v[104:107], v[128:143]
    v_mfma_f32_32x32x16_bf16 v[128:143], v[100:103], v[104:107], v[128:143]
    ds_read_b128 v[96:99], v112 offset:2304
    ds_read_b128 v[100:103], v112 offset:6912
    ds_read_b128 v[104:107], v117 offset:9472
    s_waitcnt lgkmcnt(6)
    v_mfma_f32_32x32x16_bf16 v[128:143], v[64:67], v[72:75], v[128:143]
    v_mfma_f32_32x32x16_bf16 v[128:143], v[68:71], v[72:75], v[128:143]
    ds_read_b128 v[64:67], v112 offset:2336
    ds_read_b128 v[68:71], v112 offset:6944
    ds_read_b128 v[72:75], v117 offset:9504
    s_waitcnt lgkmcnt(6)
    v_mfma_f32_32x32x16_bf16 v[128:143], v[80:83], v[88:91], v[128:143]
    v_mfma_f32_32x32x16_bf16 v[128:143], v[84:87], v[88:91], v[128:143]
    ds_read_b128 v[80:83], v112 offset:2368
    ds_read_b128 v[84:87], v112 offset:6976
    ds_read_b128 v[88:91], v117 offset:9536
    s_waitcnt lgkmcnt(6)
    v_mfma_f32_32x32x16_bf16 v[128:143], v[96:99], v[104:107], v[128:143]
    v_mfma_f32_32x32x16_bf16 v[128:143], v[100:103], v[104:107], v[128:143]
    ds_read_b128 v[96:99], v112 offset:2400
    ds_read_b128 v[100:103], v112 offset:7008
    ds_read_b128 v[104:107], v117 offset:9568
    s_waitcnt lgkmcnt(6)
    v_mfma_f32_32x32x16_bf16 v[128:143], v[64:67], v[72:75], v[128:143]
    v_mfma_f32_32x32x16_bf16 v[128:143], v[68:71], v[72:75], v[128:143]
    ds_read_b128 v[64:67], v112 offset:2432
    ds_read_b128 v[68:71], v112 offset:7040
    ds_read_b128 v[72:75], v117 offset:9600
    s_waitcnt lgkmcnt(6)
    v_mfma_f32_32x32x16_bf16 v[128:143], v[80:83], v[88:91], v[128:143]
    v_mfma_f32_32x32x16_bf16 v[128:143], v[84:87], v[88:91], v[128:143]
    ds_read_b128 v[80:83], v112 offset:2464
    ds_read_b128 v[84:87], v112 offset:7072
    ds_read_b128 v[88:91], v117 offset:9632
    s_waitcnt lgkmcnt(6)
    v_mfma_f32_32x32x16_bf16 v[128:143], v[96:99], v[104:107], v[128:143]
    v_mfma_f32_32x32x16_bf16 v[128:143], v[100:103], v[104:107], v[128:143]
    ds_read_b128 v[96:99], v112 offset:2496
    ds_read_b128 v[100:103], v112 offset:7104
    ds_read_b128 v[104:107], v117 offset:9664
    s_waitcnt lgkmcnt(6)
    v_mfma_f32_32x32x16_bf16 v[128:143], v[64:67], v[72:75], v[128:143]
    v_mfma_f32_32x32x16_bf16 v[128:143], v[68:71], v[72:75], v[128:143]
    ds_read_b128 v[64:67], v112 offset:2528
    ds_read_b128 v[68:71], v112 offset:7136
    ds_read_b128 v[72:75], v117 offset:9696
    s_waitcnt lgkmcnt(6)
    v_mfma_f32_32x32x16_bf16 v[128:143], v[80:83], v[88:91], v[128:143]
    v_mfma_f32_32x32x16_bf16 v[128:143], v[84:87], v[88:91], v[128:143]
    s_waitcnt lgkmcnt(3)
    v_mfma_f32_32x32x16_bf16 v[128:143], v[96:99], v[104:107], v[128:143]
    v_mfma_f32_32x32x16_bf16 v[128:143], v[100:103], v[104:107], v[128:143]
    s_waitcnt lgkmcnt(0)
    v_mfma_f32_32x32x16_bf16 v[128:143], v[64:67], v[72:75], v[128:143]
    v_mfma_f32_32x32x16_bf16 v[128:143], v[68:71], v[72:75], v[128:143]
    s_branch conv_loopdone
conv_waveB:
    v_add_u32 v19, 2, v17
    v_mul_i32_i24 v20, 640, v19
    v_add_u32 v20, v16, v20
    v_cmp_gt_i32 vcc, 0, v19
    s_nop 1
    v_cndmask_b32 v114, v20, v18, vcc
    v_add_u32 v19, 1, v17
    v_mul_i32_i24 v20, 640, v19
    v_add_u32 v20, v16, v20
    v_cmp_gt_i32 vcc, 0, v19
    s_nop 1
    v_cndmask_b32 v115, v20, v18, vcc
    v_add_u32 v19, 0, v17
    v_mul_i32_i24 v20, 640, v19
    v_add_u32 v20, v16, v20
    v_cmp_gt_i32 vcc, 0, v19
    s_nop 1
    v_cndmask_b32 v116, v20, v18, vcc
    v_add_u32 v19, -1, v17
    v_mul_i32_i24 v20, 640, v19
    v_add_u32 v20, v16, v20
    v_cmp_gt_i32 vcc, 0, v19
    s_nop 1
    v_cndmask_b32 v117, v20, v18, vcc
    v_add_u32 v19, -2, v17
    v_mul_i32_i24 v20, 640, v19
    v_add_u32 v20, v16, v20
    v_cmp_gt_i32 vcc, 0, v19
    s_nop 1
    v_cndmask_b32 v118, v20, v18, vcc
    v_add_u32 v19, -3, v17
    v_mul_i32_i24 v20, 640, v19
    v_add_u32 v20, v16, v20
    v_cmp_gt_i32 vcc, 0, v19
    s_nop 1
    v_cndmask_b32 v119, v20, v18, vcc
    ds_read_b128 v[64:67], v112 offset:2560
    ds_read_b128 v[68:71], v112 offset:7168
    ds_read_b128 v[72:75], v114 offset:9216
    ds_read_b128 v[80:83], v112 offset:2592
    ds_read_b128 v[84:87], v112 offset:7200
    ds_read_b128 v[88:91], v114 offset:9248
    ds_read_b128 v[96:99], v112 offset:2624
    ds_read_b128 v[100:103], v112 offset:7232
    ds_read_b128 v[104:107], v114 offset:9280
    s_waitcnt lgkmcnt(6)
    v_mfma_f32_32x32x16_bf16 v[144:159], v[64:67], v[72:75], v[144:159]
    v_mfma_f32_32x32x16_bf16 v[144:159], v[68:71], v[72:75], v[144:159]
    ds_read_b128 v[64:67], v112 offset:2656
    ds_read_b128 v[68:71], v112 offset:7264
    ds_read_b128 v[72:75], v114 offset:9312
    s_waitcnt lgkmcnt(6)
    v_mfma_f32_32x32x16_bf16 v[144:159], v[80:83], v[88:91], v[144:159]
    v_mfma_f32_32x32x16_bf16 v[144:159], v[84:87], v[88:91], v[144:159]
    ds_read_b128 v[80:83], v112 offset:2688
    ds_read_b128 v[84:87], v112 offset:7296
    ds_read_b128 v[88:91], v114 offset:9344
    s_waitcnt lgkmcnt(6)
    v_mfma_f32_32x32x16_bf16 v[144:159], v[96:99], v[104:107], v[144:159]
    v_mfma_f32_32x32x16_bf16 v[144:159], v[100:103], v[104:107], v[144:159]
    ds_read_b128 v[96:99], v112 offset:2720
    ds_read_b128 v[100:103], v112 offset:7328
    ds_read_b128 v[104:107], v114 offset:9376
    s_waitcnt lgkmcnt(6)
    v_mfma_f32_32x32x16_bf16 v[144:159], v[64:67], v[72:75], v[144:159]
    v_mfma_f32_32x32x16_bf16 v[144:159], v[68:71], v[72:75], v[144:159]
    ds_read_b128 v[64:67], v112 offset:2752
    ds_read_b128 v[68:71], v112 offset:7360
    ds_read_b128 v[72:75], v114 offset:9408
    s_waitcnt lgkmcnt(6)
    v_mfma_f32_32x32x16_bf16 v[144:159], v[80:83], v[88:91], v[144:159]
    v_mfma_f32_32x32x16_bf16 v[144:159], v[84:87], v[88:91], v[144:159]
    ds_read_b128 v[80:83], v112 offset:2784
    ds_read_b128 v[84:87], v112 offset:7392
    ds_read_b128 v[88:91], v114 offset:9440
    s_waitcnt lgkmcnt(6)
    v_mfma_f32_32x32x16_bf16 v[144:159], v[96:99], v[104:107], v[144:159]
    v_mfma_f32_32x32x16_bf16 v[144:159], v[100:103], v[104:107], v[144:159]
    ds_read_b128 v[96:99], v112 offset:2816
    ds_read_b128 v[100:103], v112 offset:7424
    ds_read_b128 v[104:107], v114 offset:9472
    s_waitcnt lgkmcnt(6)
    v_mfma_f32_32x32x16_bf16 v[144:159], v[64:67], v[72:75], v[144:159]
    v_mfma_f32_32x32x16_bf16 v[144:159], v[68:71], v[72:75], v[144:159]
    ds_read_b128 v[64:67], v112 offset:2848
    ds_read_b128 v[68:71], v112 offset:7456
    ds_read_b128 v[72:75], v114 offset:9504
    s_waitcnt lgkmcnt(6)
    v_mfma_f32_32x32x16_bf16 v[144:159], v[80:83], v[88:91], v[144:159]
    v_mfma_f32_32x32x16_bf16 v[144:159], v[84:87], v[88:91], v[144:159]
    ds_read_b128 v[80:83], v112 offset:2880
    ds_read_b128 v[84:87], v112 offset:7488
    ds_read_b128 v[88:91], v114 offset:9536
    s_waitcnt lgkmcnt(6)
    v_mfma_f32_32x32x16_bf16 v[144:159], v[96:99], v[104:107], v[144:159]
    v_mfma_f32_32x32x16_bf16 v[144:159], v[100:103], v[104:107], v[144:159]
    ds_read_b128 v[96:99], v112 offset:2912
    ds_read_b128 v[100:103], v112 offset:7520
    ds_read_b128 v[104:107], v114 offset:9568
    s_waitcnt lgkmcnt(6)
    v_mfma_f32_32x32x16_bf16 v[144:159], v[64:67], v[72:75], v[144:159]
    v_mfma_f32_32x32x16_bf16 v[144:159], v[68:71], v[72:75], v[144:159]
    ds_read_b128 v[64:67], v112 offset:2944
    ds_read_b128 v[68:71], v112 offset:7552
    ds_read_b128 v[72:75], v114 offset:9600
    s_waitcnt lgkmcnt(6)
    v_mfma_f32_32x32x16_bf16 v[144:159], v[80:83], v[88:91], v[144:159]
    v_mfma_f32_32x32x16_bf16 v[144:159], v[84:87], v[88:91], v[144:159]
    ds_read_b128 v[80:83], v112 offset:2976
    ds_read_b128 v[84:87], v112 offset:7584
    ds_read_b128 v[88:91], v114 offset:9632
    s_waitcnt lgkmcnt(6)
    v_mfma_f32_32x32x16_bf16 v[144:159], v[96:99], v[104:107], v[144:159]
    v_mfma_f32_32x32x16_bf16 v[144:159], v[100:103], v[104:107], v[144:159]
    ds_read_b128 v[96:99], v112 offset:3008
    ds_read_b128 v[100:103], v112 offset:7616
    ds_read_b128 v[104:107], v114 offset:9664
    s_waitcnt lgkmcnt(6)
    v_mfma_f32_32x32x16_bf16 v[144:159], v[64:67], v[72:75], v[144:159]
    v_mfma_f32_32x32x16_bf16 v[144:159], v[68:71], v[72:75], v[144:159]
    ds_read_b128 v[64:67], v112 offset:3040
    ds_read_b128 v[68:71], v112 offset:7648
    ds_read_b128 v[72:75], v114 offset:9696
    s_waitcnt lgkmcnt(6)
    v_mfma_f32_32x32x16_bf16 v[144:159], v[80:83], v[88:91], v[144:159]
    v_mfma_f32_32x32x16_bf16 v[144:159], v[84:87], v[88:91], v[144:159]
    ds_read_b128 v[80:83], v112 offset:2048
    ds_read_b128 v[84:87], v112 offset:6656
    ds_read_b128 v[88:91], v115 offset:9216
    s_waitcnt lgkmcnt(6)
    v_mfma_f32_32x32x16_bf16 v[144:159], v[96:99], v[104:107], v[144:159]
    v_mfma_f32_32x32x16_bf16 v[144:159], v[100:103], v[104:107], v[144:159]
    ds_read_b128 v[96:99], v112 offset:2080
    ds_read_b128 v[100:103], v112 offset:6688
    ds_read_b128 v[104:107], v115 offset:9248
    s_waitcnt lgkmcnt(6)
    v_mfma_f32_32x32x16_bf16 v[144:159], v[64:67], v[72:75], v[144:159]
    v_mfma_f32_32x32x16_bf16 v[144:159], v[68:71], v[72:75], v[144:159]
    ds_read_b128 v[64:67], v112 offset:2112
    ds_read_b128 v[68:71], v112 offset:6720
    ds_read_b128 v[72:75], v115 offset:9280
    s_waitcnt lgkmcnt(6)
    v_mfma_f32_32x32x16_bf16 v[144:159], v[80:83], v[88:91], v[144:159]
    v_mfma_f32_32x32x16_bf16 v[144:159], v[84:87], v[88:91], v[144:159]
    ds_read_b128 v[80:83], v112 offset:2144
    ds_read_b128 v[84:87], v112 offset:6752
    ds_read_b128 v[88:91], v115 offset:9312
    s_waitcnt lgkmcnt(6)
    v_mfma_f32_32x32x16_bf16 v[144:159], v[96:99], v[104:107], v[144:159]
    v_mfma_f32_32x32x16_bf16 v[144:159], v[100:103], v[104:107], v[144:159]
    ds_read_b128 v[96:99], v112 offset:2176
    ds_read_b128 v[100:103], v112 offset:6784
    ds_read_b128 v[104:107], v115 offset:9344
    s_waitcnt lgkmcnt(6)
    v_mfma_f32_32x32x16_bf16 v[144:159], v[64:67], v[72:75], v[144:159]
    v_mfma_f32_32x32x16_bf16 v[144:159], v[68:71], v[72:75], v[144:159]
    ds_read_b128 v[64:67], v112 offset:2208
    ds_read_b128 v[68:71], v112 offset:6816
    ds_read_b128 v[72:75], v115 offset:9376
    s_waitcnt lgkmcnt(6)
    v_mfma_f32_32x32x16_bf16 v[144:159], v[80:83], v[88:91], v[144:159]
    v_mfma_f32_32x32x16_bf16 v[144:159], v[84:87], v[88:91], v[144:159]
    ds_read_b128 v[80:83], v112 offset:2240
    ds_read_b128 v[84:87], v112 offset:6848
    ds_read_b128 v[88:91], v115 offset:9408
    s_waitcnt lgkmcnt(6)
    v_mfma_f32_32x32x16_bf16 v[144:159], v[96:99], v[104:107], v[144:159]
    v_mfma_f32_32x32x16_bf16 v[144:159], v[100:103], v[104:107], v[144:159]
    ds_read_b128 v[96:99], v112 offset:2272
    ds_read_b128 v[100:103], v112 offset:6880
    ds_read_b128 v[104:107], v115 offset:9440
    s_waitcnt lgkmcnt(6)
    v_mfma_f32_32x32x16_bf16 v[144:159], v[64:67], v[72:75], v[144:159]
    v_mfma_f32_32x32x16_bf16 v[144:159], v[68:71], v[72:75], v[144:159]
    ds_read_b128 v[64:67], v112 offset:2304
    ds_read_b128 v[68:71], v112 offset:6912
    ds_read_b128 v[72:75], v115 offset:9472
    s_waitcnt lgkmcnt(6)
    v_mfma_f32_32x32x16_bf16 v[144:159], v[80:83], v[88:91], v[144:159]
    v_mfma_f32_32x32x16_bf16 v[144:159], v[84:87], v[88:91], v[144:159]
    ds_read_b128 v[80:83], v112 offset:2336
    ds_read_b128 v[84:87], v112 offset:6944
    ds_read_b128 v[88:91], v115 offset:9504
    s_waitcnt lgkmcnt(6)
    v_mfma_f32_32x32x16_bf16 v[144:159], v[96:99], v[104:107], v[144:159]
    v_mfma_f32_32x32x16_bf16 v[144:159], v[100:103], v[104:107], v[144:159]
    ds_read_b128 v[96:99], v112 offset:2368
    ds_read_b128 v[100:103], v112 offset:6976
    ds_read_b128 v[104:107], v115 offset:9536
    s_waitcnt lgkmcnt(6)
    v_mfma_f32_32x32x16_bf16 v[144:159], v[64:67], v[72:75], v[144:159]
    v_mfma_f32_32x32x16_bf16 v[144:159], v[68:71], v[72:75], v[144:159]
    ds_read_b128 v[64:67], v112 offset:2400
    ds_read_b128 v[68:71], v112 offset:7008
    ds_read_b128 v[72:75], v115 offset:9568
    s_waitcnt lgkmcnt(6)
    v_mfma_f32_32x32x16_bf16 v[144:159], v[80:83], v[88:91], v[144:159]
    v_mfma_f32_32x32x16_bf16 v[144:159], v[84:87], v[88:91], v[144:159]
    ds_read_b128 v[80:83], v112 offset:2432
    ds_read_b128 v[84:87], v112 offset:7040
    ds_read_b128 v[88:91], v115 offset:9600
    s_waitcnt lgkmcnt(6)
    v_mfma_f32_32x32x16_bf16 v[144:159], v[96:99], v[104:107], v[144:159]
    v_mfma_f32_32x32x16_bf16 v[144:159], v[100:103], v[104:107], v[144:159]
    ds_read_b128 v[96:99], v112 offset:2464
    ds_read_b128 v[100:103], v112 offset:7072
    ds_read_b128 v[104:107], v115 offset:9632
    s_waitcnt lgkmcnt(6)
    v_mfma_f32_32x32x16_bf16 v[144:159], v[64:67], v[72:75], v[144:159]
    v_mfma_f32_32x32x16_bf16 v[144:159], v[68:71], v[72:75], v[144:159]
    ds_read_b128 v[64:67], v112 offset:2496
    ds_read_b128 v[68:71], v112 offset:7104
    ds_read_b128 v[72:75], v115 offset:9664
    s_waitcnt lgkmcnt(6)
    v_mfma_f32_32x32x16_bf16 v[144:159], v[80:83], v[88:91], v[144:159]
    v_mfma_f32_32x32x16_bf16 v[144:159], v[84:87], v[88:91], v[144:159]
    ds_read_b128 v[80:83], v112 offset:2528
    ds_read_b128 v[84:87], v112 offset:7136
    ds_read_b128 v[88:91], v115 offset:9696
    s_waitcnt lgkmcnt(6)
    v_mfma_f32_32x32x16_bf16 v[144:159], v[96:99], v[104:107], v[144:159]
    v_mfma_f32_32x32x16_bf16 v[144:159], v[100:103], v[104:107], v[144:159]
    ds_read_b128 v[96:99], v112 offset:1536
    ds_read_b128 v[100:103], v112 offset:6144
    ds_read_b128 v[104:107], v116 offset:9216
    s_waitcnt lgkmcnt(6)
    v_mfma_f32_32x32x16_bf16 v[144:159], v[64:67], v[72:75], v[144:159]
    v_mfma_f32_32x32x16_bf16 v[144:159], v[68:71], v[72:75], v[144:159]
    ds_read_b128 v[64:67], v112 offset:1568
    ds_read_b128 v[68:71], v112 offset:6176
    ds_read_b128 v[72:75], v116 offset:9248
    s_waitcnt lgkmcnt(6)
    v_mfma_f32_32x32x16_bf16 v[144:159], v[80:83], v[88:91], v[144:159]
    v_mfma_f32_32x32x16_bf16 v[144:159], v[84:87], v[88:91], v[144:159]
    ds_read_b128 v[80:83], v112 offset:1600
    ds_read_b128 v[84:87], v112 offset:6208
    ds_read_b128 v[88:91], v116 offset:9280
    s_waitcnt lgkmcnt(6)
    v_mfma_f32_32x32x16_bf16 v[144:159], v[96:99], v[104:107], v[144:159]
    v_mfma_f32_32x32x16_bf16 v[144:159], v[100:103], v[104:107], v[144:159]
    ds_read_b128 v[96:99], v112 offset:1632
    ds_read_b128 v[100:103], v112 offset:6240
    ds_read_b128 v[104:107], v116 offset:9312
    s_waitcnt lgkmcnt(6)
    v_mfma_f32_32x32x16_bf16 v[144:159], v[64:67], v[72:75], v[144:159]
    v_mfma_f32_32x32x16_bf16 v[144:159], v[68:71], v[72:75], v[144:159]
    ds_read_b128 v[64:67], v112 offset:1664
    ds_read_b128 v[68:71], v112 offset:6272
    ds_read_b128 v[72:75], v116 offset:9344
    s_waitcnt lgkmcnt(6)
    v_mfma_f32_32x32x16_bf16 v[144:159], v[80:83], v[88:91], v[144:159]
    v_mfma_f32_32x32x16_bf16 v[144:159], v[84:87], v[88:91], v[144:159]
    ds_read_b128 v[80:83], v112 offset:1696
    ds_read_b128 v[84:87], v112 offset:6304
    ds_read_b128 v[88:91], v116 offset:9376
    s_waitcnt lgkmcnt(6)
    v_mfma_f32_32x32x16_bf16 v[144:159], v[96:99], v[104:107], v[144:159]
    v_mfma_f32_32x32x16_bf16 v[144:159], v[100:103], v[104:107], v[144:159]
    ds_read_b128 v[96:99], v112 offset:1728
    ds_read_b128 v[100:103], v112 offset:6336
    ds_read_b128 v[104:107], v116 offset:9408
    s_waitcnt lgkmcnt(6)
    v_mfma_f32_32x32x16_bf16 v[144:159], v[64:67], v[72:75], v[144:159]
    v_mfma_f32_32x32x16_bf16 v[144:159], v[68:71], v[72:75], v[144:159]
    ds_read_b128 v[64:67], v112 offset:1760
    ds_read_b128 v[68:71], v112 offset:6368
    ds_read_b128 v[72:75], v116 offset:9440
    s_waitcnt lgkmcnt(6)
    v_mfma_f32_32x32x16_bf16 v[144:159], v[80:83], v[88:91], v[144:159]
    v_mfma_f32_32x32x16_bf16 v[144:159], v[84:87], v[88:91], v[144:159]
    ds_read_b128 v[80:83], v112 offset:1792
    ds_read_b128 v[84:87], v112 offset:6400
    ds_read_b128 v[88:91], v116 offset:9472
    s_waitcnt lgkmcnt(6)
    v_mfma_f32_32x32x16_bf16 v[144:159], v[96:99], v[104:107], v[144:159]
    v_mfma_f32_32x32x16_bf16 v[144:159], v[100:103], v[104:107], v[144:159]
    ds_read_b128 v[96:99], v112 offset:1824
    ds_read_b128 v[100:103], v112 offset:6432
    ds_read_b128 v[104:107], v116 offset:9504
    s_waitcnt lgkmcnt(6)
    v_mfma_f32_32x32x16_bf16 v[144:159], v[64:67], v[72:75], v[144:159]
    v_mfma_f32_32x32x16_bf16 v[144:159], v[68:71], v[72:75], v[144:159]
    ds_read_b128 v[64:67], v112 offset:1856
    ds_read_b128 v[68:71], v112 offset:6464
    ds_read_b128 v[72:75], v116 offset:9536
    s_waitcnt lgkmcnt(6)
    v_mfma_f32_32x32x16_bf16 v[144:159], v[80:83], v[88:91], v[144:159]
    v_mfma_f32_32x32x16_bf16 v[144:159], v[84:87], v[88:91], v[144:159]
    ds_read_b128 v[80:83], v112 offset:1888
    ds_read_b128 v[84:87], v112 offset:6496
    ds_read_b128 v[88:91], v116 offset:9568
    s_waitcnt lgkmcnt(6)
    v_mfma_f32_32x32x16_bf16 v[144:159], v[96:99], v[104:107], v[144:159]
    v_mfma_f32_32x32x16_bf16 v[144:159], v[100:103], v[104:107], v[144:159]
    ds_read_b128 v[96:99], v112 offset:1920
    ds_read_b128 v[100:103], v112 offset:6528
    ds_read_b128 v[104:107], v116 offset:9600
    s_waitcnt lgkmcnt(6)
    v_mfma_f32_32x32x16_bf16 v[144:159], v[64:67], v[72:75], v[144:159]
    v_mfma_f32_32x32x16_bf16 v[144:159], v[68:71], v[72:75], v[144:159]
    ds_read_b128 v[64:67], v112 offset:1952
    ds_read_b128 v[68:71], v112 offset:6560
    ds_read_b128 v[72:75], v116 offset:9632
    s_waitcnt lgkmcnt(6)
    v_mfma_f32_32x32x16_bf16 v[144:159], v[80:83], v[88:91], v[144:159]
    v_mfma_f32_32x32x16_bf16 v[144:159], v[84:87], v[88:91], v[144:159]
    ds_read_b128 v[80:83], v112 offset:1984
    ds_read_b128 v[84:87], v112 offset:6592
    ds_read_b128 v[88:91], v116 offset:9664
    s_waitcnt lgkmcnt(6)
    v_mfma_f32_32x32x16_bf16 v[144:159], v[96:99], v[104:107], v[144:159]
    v_mfma_f32_32x32x16_bf16 v[144:159], v[100:103], v[104:107], v[144:159]
    ds_read_b128 v[96:99], v112 offset:2016
    ds_read_b128 v[100:103], v112 offset:6624
    ds_read_b128 v[104:107], v116 offset:9696
    s_waitcnt lgkmcnt(6)
    v_mfma_f32_32x32x16_bf16 v[144:159], v[64:67], v[72:75], v[144:159]
    v_mfma_f32_32x32x16_bf16 v[144:159], v[68:71], v[72:75], v[144:159]
    ds_read_b128 v[64:67], v112 offset:1024
    ds_read_b128 v[68:71], v112 offset:5632
    ds_read_b128 v[72:75], v117 offset:9216
    s_waitcnt lgkmcnt(6)
    v_mfma_f32_32x32x16_bf16 v[144:159], v[80:83], v[88:91], v[144:159]
    v_mfma_f32_32x32x16_bf16 v[144:159], v[84:87], v[88:91], v[144:159]
    ds_read_b128 v[80:83], v112 offset:1056
    ds_read_b128 v[84:87], v112 offset:5664
    ds_read_b128 v[88:91], v117 offset:9248
    s_waitcnt lgkmcnt(6)
    v_mfma_f32_32x32x16_bf16 v[144:159], v[96:99], v[104:107], v[144:159]
    v_mfma_f32_32x32x16_bf16 v[144:159], v[100:103], v[104:107], v[144:159]
    ds_read_b128 v[96:99], v112 offset:1088
    ds_read_b128 v[100:103], v112 offset:5696
    ds_read_b128 v[104:107], v117 offset:9280
    s_waitcnt lgkmcnt(6)
    v_mfma_f32_32x32x16_bf16 v[144:159], v[64:67], v[72:75], v[144:159]
    v_mfma_f32_32x32x16_bf16 v[144:159], v[68:71], v[72:75], v[144:159]
    ds_read_b128 v[64:67], v112 offset:1120
    ds_read_b128 v[68:71], v112 offset:5728
    ds_read_b128 v[72:75], v117 offset:9312
    s_waitcnt lgkmcnt(6)
    v_mfma_f32_32x32x16_bf16 v[144:159], v[80:83], v[88:91], v[144:159]
    v_mfma_f32_32x32x16_bf16 v[144:159], v[84:87], v[88:91], v[144:159]
    ds_read_b128 v[80:83], v112 offset:1152
    ds_read_b128 v[84:87], v112 offset:5760
    ds_read_b128 v[88:91], v117 offset:9344
    s_waitcnt lgkmcnt(6)
    v_mfma_f32_32x32x16_bf16 v[144:159], v[96:99], v[104:107], v[144:159]
    v_mfma_f32_32x32x16_bf16 v[144:159], v[100:103], v[104:107], v[144:159]
    ds_read_b128 v[96:99], v112 offset:1184
    ds_read_b128 v[100:103], v112 offset:5792
    ds_read_b128 v[104:107], v117 offset:9376
    s_waitcnt lgkmcnt(6)
    v_mfma_f32_32x32x16_bf16 v[144:159], v[64:67], v[72:75], v[144:159]
    v_mfma_f32_32x32x16_bf16 v[144:159], v[68:71], v[72:75], v[144:159]
    ds_read_b128 v[64:67], v112 offset:1216
    ds_read_b128 v[68:71], v112 offset:5824
    ds_read_b128 v[72:75], v117 offset:9408
    s_waitcnt lgkmcnt(6)
    v_mfma_f32_32x32x16_bf16 v[144:159], v[80:83], v[88:91], v[144:159]
    v_mfma_f32_32x32x16_bf16 v[144:159], v[84:87], v[88:91], v[144:159]
    ds_read_b128 v[80:83], v112 offset:1248
    ds_read_b128 v[84:87], v112 offset:5856
    ds_read_b128 v[88:91], v117 offset:9440
    s_waitcnt lgkmcnt(6)
    v_mfma_f32_32x32x16_bf16 v[144:159], v[96:99], v[104:107], v[144:159]
    v_mfma_f32_32x32x16_bf16 v[144:159], v[100:103], v[104:107], v[144:159]
    ds_read_b128 v[96:99], v112 offset:1280
    ds_read_b128 v[100:103], v112 offset:5888
    ds_read_b128 v[104:107], v117 offset:9472
    s_waitcnt lgkmcnt(6)
    v_mfma_f32_32x32x16_bf16 v[144:159], v[64:67], v[72:75], v[144:159]
    v_mfma_f32_32x32x16_bf16 v[144:159], v[68:71], v[72:75], v[144:159]
    ds_read_b128 v[64:67], v112 offset:1312
    ds_read_b128 v[68:71], v112 offset:5920
    ds_read_b128 v[72:75], v117 offset:9504
    s_waitcnt lgkmcnt(6)
    v_mfma_f32_32x32x16_bf16 v[144:159], v[80:83], v[88:91], v[144:159]
    v_mfma_f32_32x32x16_bf16 v[144:159], v[84:87], v[88:91], v[144:159]
    ds_read_b128 v[80:83], v112 offset:1344
    ds_read_b128 v[84:87], v112 offset:5952
    ds_read_b128 v[88:91], v117 offset:9536
    s_waitcnt lgkmcnt(6)
    v_mfma_f32_32x32x16_bf16 v[144:159], v[96:99], v[104:107], v[144:159]
    v_mfma_f32_32x32x16_bf16 v[144:159], v[100:103], v[104:107], v[144:159]
    ds_read_b128 v[96:99], v112 offset:1376
    ds_read_b128 v[100:103], v112 offset:5984
    ds_read_b128 v[104:107], v117 offset:9568
    s_waitcnt lgkmcnt(6)
    v_mfma_f32_32x32x16_bf16 v[144:159], v[64:67], v[72:75], v[144:159]
    v_mfma_f32_32x32x16_bf16 v[144:159], v[68:71], v[72:75], v[144:159]
    ds_read_b128 v[64:67], v112 offset:1408
    ds_read_b128 v[68:71], v112 offset:6016
    ds_read_b128 v[72:75], v117 offset:9600
    s_waitcnt lgkmcnt(6)
    v_mfma_f32_32x32x16_bf16 v[144:159], v[80:83], v[88:91], v[144:159]
    v_mfma_f32_32x32x16_bf16 v[144:159], v[84:87], v[88:91], v[144:159]
    ds_read_b128 v[80:83], v112 offset:1440
    ds_read_b128 v[84:87], v112 offset:6048
    ds_read_b128 v[88:91], v117 offset:9632
    s_waitcnt lgkmcnt(6)
    v_mfma_f32_32x32x16_bf16 v[144:159], v[96:99], v[104:107], v[144:159]
    v_mfma_f32_32x32x16_bf16 v[144:159], v[100:103], v[104:107], v[144:159]
    ds_read_b128 v[96:99], v112 offset:1472
    ds_read_b128 v[100:103], v112 offset:6080
    ds_read_b128 v[104:107], v117 offset:9664
    s_waitcnt lgkmcnt(6)
    v_mfma_f32_32x32x16_bf16 v[144:159], v[64:67], v[72:75], v[144:159]
    v_mfma_f32_32x32x16_bf16 v[144:159], v[68:71], v[72:75], v[144:159]
    ds_read_b128 v[64:67], v112 offset:1504
    ds_read_b128 v[68:71], v112 offset:6112
    ds_read_b128 v[72:75], v117 offset:9696
    s_waitcnt lgkmcnt(6)
    v_mfma_f32_32x32x16_bf16 v[144:159], v[80:83], v[88:91], v[144:159]
    v_mfma_f32_32x32x16_bf16 v[144:159], v[84:87], v[88:91], v[144:159]
    ds_read_b128 v[80:83], v112 offset:512
    ds_read_b128 v[84:87], v112 offset:5120
    ds_read_b128 v[88:91], v118 offset:9216
    s_waitcnt lgkmcnt(6)
    v_mfma_f32_32x32x16_bf16 v[144:159], v[96:99], v[104:107], v[144:159]
    v_mfma_f32_32x32x16_bf16 v[144:159], v[100:103], v[104:107], v[144:159]
    ds_read_b128 v[96:99], v112 offset:544
    ds_read_b128 v[100:103], v112 offset:5152
    ds_read_b128 v[104:107], v118 offset:9248
    s_waitcnt lgkmcnt(6)
    v_mfma_f32_32x32x16_bf16 v[144:159], v[64:67], v[72:75], v[144:159]
    v_mfma_f32_32x32x16_bf16 v[144:159], v[68:71], v[72:75], v[144:159]
    ds_read_b128 v[64:67], v112 offset:576
    ds_read_b128 v[68:71], v112 offset:5184
    ds_read_b128 v[72:75], v118 offset:9280
    s_waitcnt lgkmcnt(6)
    v_mfma_f32_32x32x16_bf16 v[144:159], v[80:83], v[88:91], v[144:159]
    v_mfma_f32_32x32x16_bf16 v[144:159], v[84:87], v[88:91], v[144:159]
    ds_read_b128 v[80:83], v112 offset:608
    ds_read_b128 v[84:87], v112 offset:5216
    ds_read_b128 v[88:91], v118 offset:9312
    s_waitcnt lgkmcnt(6)
    v_mfma_f32_32x32x16_bf16 v[144:159], v[96:99], v[104:107], v[144:159]
    v_mfma_f32_32x32x16_bf16 v[144:159], v[100:103], v[104:107], v[144:159]
    ds_read_b128 v[96:99], v112 offset:640
    ds_read_b128 v[100:103], v112 offset:5248
    ds_read_b128 v[104:107], v118 offset:9344
    s_waitcnt lgkmcnt(6)
    v_mfma_f32_32x32x16_bf16 v[144:159], v[64:67], v[72:75], v[144:159]
    v_mfma_f32_32x32x16_bf16 v[144:159], v[68:71], v[72:75], v[144:159]
    ds_read_b128 v[64:67], v112 offset:672
    ds_read_b128 v[68:71], v112 offset:5280
    ds_read_b128 v[72:75], v118 offset:9376
    s_waitcnt lgkmcnt(6)
    v_mfma_f32_32x32x16_bf16 v[144:159], v[80:83], v[88:91], v[144:159]
    v_mfma_f32_32x32x16_bf16 v[144:159], v[84:87], v[88:91], v[144:159]
    ds_read_b128 v[80:83], v112 offset:704
    ds_read_b128 v[84:87], v112 offset:5312
    ds_read_b128 v[88:91], v118 offset:9408
    s_waitcnt lgkmcnt(6)
    v_mfma_f32_32x32x16_bf16 v[144:159], v[96:99], v[104:107], v[144:159]
    v_mfma_f32_32x32x16_bf16 v[144:159], v[100:103], v[104:107], v[144:159]
    ds_read_b128 v[96:99], v112 offset:736
    ds_read_b128 v[100:103], v112 offset:5344
    ds_read_b128 v[104:107], v118 offset:9440
    s_waitcnt lgkmcnt(6)
    v_mfma_f32_32x32x16_bf16 v[144:159], v[64:67], v[72:75], v[144:159]
    v_mfma_f32_32x32x16_bf16 v[144:159], v[68:71], v[72:75], v[144:159]
    ds_read_b128 v[64:67], v112 offset:768
    ds_read_b128 v[68:71], v112 offset:5376
    ds_read_b128 v[72:75], v118 offset:9472
    s_waitcnt lgkmcnt(6)
    v_mfma_f32_32x32x16_bf16 v[144:159], v[80:83], v[88:91], v[144:159]
    v_mfma_f32_32x32x16_bf16 v[144:159], v[84:87], v[88:91], v[144:159]
    ds_read_b128 v[80:83], v112 offset:800
    ds_read_b128 v[84:87], v112 offset:5408
    ds_read_b128 v[88:91], v118 offset:9504
    s_waitcnt lgkmcnt(6)
    v_mfma_f32_32x32x16_bf16 v[144:159], v[96:99], v[104:107], v[144:159]
    v_mfma_f32_32x32x16_bf16 v[144:159], v[100:103], v[104:107], v[144:159]
    ds_read_b128 v[96:99], v112 offset:832
    ds_read_b128 v[100:103], v112 offset:5440
    ds_read_b128 v[104:107], v118 offset:9536
    s_waitcnt lgkmcnt(6)
    v_mfma_f32_32x32x16_bf16 v[144:159], v[64:67], v[72:75], v[144:159]
    v_mfma_f32_32x32x16_bf16 v[144:159], v[68:71], v[72:75], v[144:159]
    ds_read_b128 v[64:67], v112 offset:864
    ds_read_b128 v[68:71], v112 offset:5472
    ds_read_b128 v[72:75], v118 offset:9568
    s_waitcnt lgkmcnt(6)
    v_mfma_f32_32x32x16_bf16 v[144:159], v[80:83], v[88:91], v[144:159]
    v_mfma_f32_32x32x16_bf16 v[144:159], v[84:87], v[88:91], v[144:159]
    ds_read_b128 v[80:83], v112 offset:896
    ds_read_b128 v[84:87], v112 offset:5504
    ds_read_b128 v[88:91], v118 offset:9600
    s_waitcnt lgkmcnt(6)
    v_mfma_f32_32x32x16_bf16 v[144:159], v[96:99], v[104:107], v[144:159]
    v_mfma_f32_32x32x16_bf16 v[144:159], v[100:103], v[104:107], v[144:159]
    ds_read_b128 v[96:99], v112 offset:928
    ds_read_b128 v[100:103], v112 offset:5536
    ds_read_b128 v[104:107], v118 offset:9632
    s_waitcnt lgkmcnt(6)
    v_mfma_f32_32x32x16_bf16 v[144:159], v[64:67], v[72:75], v[144:159]
    v_mfma_f32_32x32x16_bf16 v[144:159], v[68:71], v[72:75], v[144:159]
    ds_read_b128 v[64:67], v112 offset:960
    ds_read_b128 v[68:71], v112 offset:5568
    ds_read_b128 v[72:75], v118 offset:9664
    s_waitcnt lgkmcnt(6)
    v_mfma_f32_32x32x16_bf16 v[144:159], v[80:83], v[88:91], v[144:159]
    v_mfma_f32_32x32x16_bf16 v[144:159], v[84:87], v[88:91], v[144:159]
    ds_read_b128 v[80:83], v112 offset:992
    ds_read_b128 v[84:87], v112 offset:5600
    ds_read_b128 v[88:91], v118 offset:9696
    s_waitcnt lgkmcnt(6)
    v_mfma_f32_32x32x16_bf16 v[144:159], v[96:99], v[104:107], v[144:159]
    v_mfma_f32_32x32x16_bf16 v[144:159], v[100:103], v[104:107], v[144:159]
    ds_read_b128 v[96:99], v112 offset:0
    ds_read_b128 v[100:103], v112 offset:4608
    ds_read_b128 v[104:107], v119 offset:9216
    s_waitcnt lgkmcnt(6)
    v_mfma_f32_32x32x16_bf16 v[144:159], v[64:67], v[72:75], v[144:159]
    v_mfma_f32_32x32x16_bf16 v[144:159], v[68:71], v[72:75], v[144:159]
    ds_read_b128 v[64:67], v112 offset:32
    ds_read_b128 v[68:71], v112 offset:4640
    ds_read_b128 v[72:75], v119 offset:9248
    s_waitcnt lgkmcnt(6)
    v_mfma_f32_32x32x16_bf16 v[144:159], v[80:83], v[88:91], v[144:159]
    v_mfma_f32_32x32x16_bf16 v[144:159], v[84:87], v[88:91], v[144:159]
    ds_read_b128 v[80:83], v112 offset:64
    ds_read_b128 v[84:87], v112 offset:4672
    ds_read_b128 v[88:91], v119 offset:9280
    s_waitcnt lgkmcnt(6)
    v_mfma_f32_32x32x16_bf16 v[144:159], v[96:99], v[104:107], v[144:159]
    v_mfma_f32_32x32x16_bf16 v[144:159], v[100:103], v[104:107], v[144:159]
    ds_read_b128 v[96:99], v112 offset:96
    ds_read_b128 v[100:103], v112 offset:4704
    ds_read_b128 v[104:107], v119 offset:9312
    s_waitcnt lgkmcnt(6)
    v_mfma_f32_32x32x16_bf16 v[144:159], v[64:67], v[72:75], v[144:159]
    v_mfma_f32_32x32x16_bf16 v[144:159], v[68:71], v[72:75], v[144:159]
    ds_read_b128 v[64:67], v112 offset:128
    ds_read_b128 v[68:71], v112 offset:4736
    ds_read_b128 v[72:75], v119 offset:9344
    s_waitcnt lgkmcnt(6)
    v_mfma_f32_32x32x16_bf16 v[144:159], v[80:83], v[88:91], v[144:159]
    v_mfma_f32_32x32x16_bf16 v[144:159], v[84:87], v[88:91], v[144:159]
    ds_read_b128 v[80:83], v112 offset:160
    ds_read_b128 v[84:87], v112 offset:4768
    ds_read_b128 v[88:91], v119 offset:9376
    s_waitcnt lgkmcnt(6)
    v_mfma_f32_32x32x16_bf16 v[144:159], v[96:99], v[104:107], v[144:159]
    v_mfma_f32_32x32x16_bf16 v[144:159], v[100:103], v[104:107], v[144:159]
    ds_read_b128 v[96:99], v112 offset:192
    ds_read_b128 v[100:103], v112 offset:4800
    ds_read_b128 v[104:107], v119 offset:9408
    s_waitcnt lgkmcnt(6)
    v_mfma_f32_32x32x16_bf16 v[144:159], v[64:67], v[72:75], v[144:159]
    v_mfma_f32_32x32x16_bf16 v[144:159], v[68:71], v[72:75], v[144:159]
    ds_read_b128 v[64:67], v112 offset:224
    ds_read_b128 v[68:71], v112 offset:4832
    ds_read_b128 v[72:75], v119 offset:9440
    s_waitcnt lgkmcnt(6)
    v_mfma_f32_32x32x16_bf16 v[144:159], v[80:83], v[88:91], v[144:159]
    v_mfma_f32_32x32x16_bf16 v[144:159], v[84:87], v[88:91], v[144:159]
    ds_read_b128 v[80:83], v112 offset:256
    ds_read_b128 v[84:87], v112 offset:4864
    ds_read_b128 v[88:91], v119 offset:9472
    s_waitcnt lgkmcnt(6)
    v_mfma_f32_32x32x16_bf16 v[144:159], v[96:99], v[104:107], v[144:159]
    v_mfma_f32_32x32x16_bf16 v[144:159], v[100:103], v[104:107], v[144:159]
    ds_read_b128 v[96:99], v112 offset:288
    ds_read_b128 v[100:103], v112 offset:4896
    ds_read_b128 v[104:107], v119 offset:9504
    s_waitcnt lgkmcnt(6)
    v_mfma_f32_32x32x16_bf16 v[144:159], v[64:67], v[72:75], v[144:159]
    v_mfma_f32_32x32x16_bf16 v[144:159], v[68:71], v[72:75], v[144:159]
    ds_read_b128 v[64:67], v112 offset:320
    ds_read_b128 v[68:71], v112 offset:4928
    ds_read_b128 v[72:75], v119 offset:9536
    s_waitcnt lgkmcnt(6)
    v_mfma_f32_32x32x16_bf16 v[144:159], v[80:83], v[88:91], v[144:159]
    v_mfma_f32_32x32x16_bf16 v[144:159], v[84:87], v[88:91], v[144:159]
    ds_read_b128 v[80:83], v112 offset:352
    ds_read_b128 v[84:87], v112 offset:4960
    ds_read_b128 v[88:91], v119 offset:9568
    s_waitcnt lgkmcnt(6)
    v_mfma_f32_32x32x16_bf16 v[144:159], v[96:99], v[104:107], v[144:159]
    v_mfma_f32_32x32x16_bf16 v[144:159], v[100:103], v[104:107], v[144:159]
    ds_read_b128 v[96:99], v112 offset:384
    ds_read_b128 v[100:103], v112 offset:4992
    ds_read_b128 v[104:107], v119 offset:9600
    s_waitcnt lgkmcnt(6)
    v_mfma_f32_32x32x16_bf16 v[144:159], v[64:67], v[72:75], v[144:159]
    v_mfma_f32_32x32x16_bf16 v[144:159], v[68:71], v[72:75], v[144:159]
    ds_read_b128 v[64:67], v112 offset:416
    ds_read_b128 v[68:71], v112 offset:5024
    ds_read_b128 v[72:75], v119 offset:9632
    s_waitcnt lgkmcnt(6)
    v_mfma_f32_32x32x16_bf16 v[144:159], v[80:83], v[88:91], v[144:159]
    v_mfma_f32_32x32x16_bf16 v[144:159], v[84:87], v[88:91], v[144:159]
    ds_read_b128 v[80:83], v112 offset:448
    ds_read_b128 v[84:87], v112 offset:5056
    ds_read_b128 v[88:91], v119 offset:9664
    s_waitcnt lgkmcnt(6)
    v_mfma_f32_32x32x16_bf16 v[144:159], v[96:99], v[104:107], v[144:159]
    v_mfma_f32_32x32x16_bf16 v[144:159], v[100:103], v[104:107], v[144:159]
    ds_read_b128 v[96:99], v112 offset:480
    ds_read_b128 v[100:103], v112 offset:5088
    ds_read_b128 v[104:107], v119 offset:9696
    s_waitcnt lgkmcnt(6)
    v_mfma_f32_32x32x16_bf16 v[144:159], v[64:67], v[72:75], v[144:159]
    v_mfma_f32_32x32x16_bf16 v[144:159], v[68:71], v[72:75], v[144:159]
    s_waitcnt lgkmcnt(3)
    v_mfma_f32_32x32x16_bf16 v[144:159], v[80:83], v[88:91], v[144:159]
    v_mfma_f32_32x32x16_bf16 v[144:159], v[84:87], v[88:91], v[144:159]
    s_waitcnt lgkmcnt(0)
    v_mfma_f32_32x32x16_bf16 v[144:159], v[96:99], v[104:107], v[144:159]
    v_mfma_f32_32x32x16_bf16 v[144:159], v[100:103], v[104:107], v[144:159]
conv_loopdone:
    s_nop 7
    s_nop 7
    s_barrier
    v_and_b32 v12, 7, v0
    v_bfe_u32 v13, v0, 3, 2
    v_bfe_u32 v14, v0, 5, 1
    v_mul_u32_u24 v13, 1056, v13
    v_lshl_add_u32 v12, v12, 2, v13
    v_lshl_add_u32 v12, v14, 7, v12
    v_add_u32 v12, v7, v12
    s_cmp_eq_u32 s41, 1
    s_cbranch_scc1 conv_ywB
    ds_write_b32 v12, v128 offset:0
    ds_write_b32 v12, v129 offset:32
    ds_write_b32 v12, v130 offset:64
    ds_write_b32 v12, v131 offset:96
    ds_write_b32 v12, v132 offset:256
    ds_write_b32 v12, v133 offset:288
    ds_write_b32 v12, v134 offset:320
    ds_write_b32 v12, v135 offset:352
    ds_write_b32 v12, v136 offset:512
    ds_write_b32 v12, v137 offset:544
    ds_write_b32 v12, v138 offset:576
    ds_write_b32 v12, v139 offset:608
    ds_write_b32 v12, v140 offset:768
    ds_write_b32 v12, v141 offset:800
    ds_write_b32 v12, v142 offset:832
    ds_write_b32 v12, v143 offset:864
    ds_write_b32 v12, v144 offset:4224
    ds_write_b32 v12, v145 offset:4256
    ds_write_b32 v12, v146 offset:4288
    ds_write_b32 v12, v147 offset:4320
    ds_write_b32 v12, v148 offset:4480
    ds_write_b32 v12, v149 offset:4512
    ds_write_b32 v12, v150 offset:4544
    ds_write_b32 v12, v151 offset:4576
    ds_write_b32 v12, v152 offset:4736
    ds_write_b32 v12, v153 offset:4768
    ds_write_b32 v12, v154 offset:4800
    ds_write_b32 v12, v155 offset:4832
    ds_write_b32 v12, v156 offset:4992
    ds_write_b32 v12, v157 offset:5024
    ds_write_b32 v12, v158 offset:5056
    ds_write_b32 v12, v159 offset:5088
    s_branch conv_ywdone
conv_ywB:
    ds_write_b32 v12, v144 offset:8704
    ds_write_b32 v12, v145 offset:8736
    ds_write_b32 v12, v146 offset:8768
    ds_write_b32 v12, v147 offset:8800
    ds_write_b32 v12, v148 offset:8960
    ds_write_b32 v12, v149 offset:8992
    ds_write_b32 v12, v150 offset:9024
    ds_write_b32 v12, v151 offset:9056
    ds_write_b32 v12, v152 offset:9216
    ds_write_b32 v12, v153 offset:9248
    ds_write_b32 v12, v154 offset:9280
    ds_write_b32 v12, v155 offset:9312
    ds_write_b32 v12, v156 offset:9472
    ds_write_b32 v12, v157 offset:9504
    ds_write_b32 v12, v158 offset:9536
    ds_write_b32 v12, v159 offset:9568
conv_ywdone:
    s_waitcnt lgkmcnt(0)
    s_barrier
    v_lshrrev_b32 v13, 4, v2
    v_lshlrev_b32 v12, 6, v2
    v_lshl_add_u32 v12, v13, 5, v12
    v_add_u32 v12, v7, v12
    ds_read_b128 v[64:67], v12 offset:0
    ds_read_b128 v[68:71], v12 offset:16
    ds_read_b128 v[72:75], v12 offset:32
    ds_read_b128 v[76:79], v12 offset:48
    v_cmp_le_u32 vcc, 64, v2
    v_mov_b32 v80, 0
    v_mov_b32 v81, 0
    v_mov_b32 v82, 0
    v_mov_b32 v83, 0
    v_mov_b32 v84, 0
    v_mov_b32 v85, 0
    v_mov_b32 v86, 0
    v_mov_b32 v87, 0
    v_mov_b32 v88, 0
    v_mov_b32 v89, 0
    v_mov_b32 v90, 0
    v_mov_b32 v91, 0
    v_mov_b32 v92, 0
    v_mov_b32 v93, 0
    v_mov_b32 v94, 0
    v_mov_b32 v95, 0
    s_and_saveexec_b64 s[42:43], vcc
    s_cbranch_execz conv_noyb
    ds_read_b128 v[80:83], v12 offset:4480
    ds_read_b128 v[84:87], v12 offset:4496
    ds_read_b128 v[88:91], v12 offset:4512
    ds_read_b128 v[92:95], v12 offset:4528
conv_noyb:
    s_mov_b64 exec, s[42:43]
    s_waitcnt lgkmcnt(0)
    s_lshl_b32 s46, s21, 16
    s_and_b32 s47, s21, 0xffff0000
    v_mov_b32 v14, s46
    v_mov_b32 v15, s47
    v_cmp_eq_u32 vcc, 1, v1
    s_nop 1
    v_cndmask_b32 v96, v14, v15, vcc
    v_add_f32 v13, v64, v80
    v_add_f32 v14, v65, v81
    v_cvt_pk_bf16_f32 v13, v13, v14
    v_lshlrev_b32 v15, 16, v188
    v_and_b32 v16, 0xffff0000, v188
    v_mul_f32 v15, v15, v96
    v_mul_f32 v16, v16, v96
    v_cvt_pk_bf16_f32 v15, v15, v16
    v_lshlrev_b32 v16, 16, v13
    v_lshlrev_b32 v17, 16, v15
    v_add_f32 v16, v16, v17
    v_and_b32 v17, 0xffff0000, v13
    v_and_b32 v18, 0xffff0000, v15
    v_add_f32 v17, v17, v18
    v_cvt_pk_bf16_f32 v16, v16, v17
    v_lshlrev_b32 v17, 16, v16
    v_add_f32 v17, v17, v168
    v_and_b32 v18, 0xffff0000, v16
    v_add_f32 v18, v18, v169
    v_cvt_pk_bf16_f32 v100, v17, v18
    v_add_f32 v13, v66, v82
    v_add_f32 v14, v67, v83
    v_cvt_pk_bf16_f32 v13, v13, v14
    v_lshlrev_b32 v15, 16, v189
    v_and_b32 v16, 0xffff0000, v189
    v_mul_f32 v15, v15, v96
    v_mul_f32 v16, v16, v96
    v_cvt_pk_bf16_f32 v15, v15, v16
    v_lshlrev_b32 v16, 16, v13
    v_lshlrev_b32 v17, 16, v15
    v_add_f32 v16, v16, v17
    v_and_b32 v17, 0xffff0000, v13
    v_and_b32 v18, 0xffff0000, v15
    v_add_f32 v17, v17, v18
    v_cvt_pk_bf16_f32 v16, v16, v17
    v_lshlrev_b32 v17, 16, v16
    v_add_f32 v17, v17, v170
    v_and_b32 v18, 0xffff0000, v16
    v_add_f32 v18, v18, v171
    v_cvt_pk_bf16_f32 v101, v17, v18
    v_add_f32 v13, v68, v84
    v_add_f32 v14, v69, v85
    v_cvt_pk_bf16_f32 v13, v13, v14
    v_lshlrev_b32 v15, 16, v190
    v_and_b32 v16, 0xffff0000, v190
    v_mul_f32 v15, v15, v96
    v_mul_f32 v16, v16, v96
    v_cvt_pk_bf16_f32 v15, v15, v16
    v_lshlrev_b32 v16, 16, v13
    v_lshlrev_b32 v17, 16, v15
    v_add_f32 v16, v16, v17
    v_and_b32 v17, 0xffff0000, v13
    v_and_b32 v18, 0xffff0000, v15
    v_add_f32 v17, v17, v18
    v_cvt_pk_bf16_f32 v16, v16, v17
    v_lshlrev_b32 v17, 16, v16
    v_add_f32 v17, v17, v172
    v_and_b32 v18, 0xffff0000, v16
    v_add_f32 v18, v18, v173
    v_cvt_pk_bf16_f32 v102, v17, v18
    v_add_f32 v13, v70, v86
    v_add_f32 v14, v71, v87
    v_cvt_pk_bf16_f32 v13, v13, v14
    v_lshlrev_b32 v15, 16, v191
    v_and_b32 v16, 0xffff0000, v191
    v_mul_f32 v15, v15, v96
    v_mul_f32 v16, v16, v96
    v_cvt_pk_bf16_f32 v15, v15, v16
    v_lshlrev_b32 v16, 16, v13
    v_lshlrev_b32 v17, 16, v15
    v_add_f32 v16, v16, v17
    v_and_b32 v17, 0xffff0000, v13
    v_and_b32 v18, 0xffff0000, v15
    v_add_f32 v17, v17, v18
    v_cvt_pk_bf16_f32 v16, v16, v17
    v_lshlrev_b32 v17, 16, v16
    v_add_f32 v17, v17, v174
    v_and_b32 v18, 0xffff0000, v16
    v_add_f32 v18, v18, v175
    v_cvt_pk_bf16_f32 v103, v17, v18
    v_add_f32 v13, v72, v88
    v_add_f32 v14, v73, v89
    v_cvt_pk_bf16_f32 v13, v13, v14
    v_lshlrev_b32 v15, 16, v192
    v_and_b32 v16, 0xffff0000, v192
    v_mul_f32 v15, v15, v96
    v_mul_f32 v16, v16, v96
    v_cvt_pk_bf16_f32 v15, v15, v16
    v_lshlrev_b32 v16, 16, v13
    v_lshlrev_b32 v17, 16, v15
    v_add_f32 v16, v16, v17
    v_and_b32 v17, 0xffff0000, v13
    v_and_b32 v18, 0xffff0000, v15
    v_add_f32 v17, v17, v18
    v_cvt_pk_bf16_f32 v16, v16, v17
    v_lshlrev_b32 v17, 16, v16
    v_add_f32 v17, v17, v176
    v_and_b32 v18, 0xffff0000, v16
    v_add_f32 v18, v18, v177
    v_cvt_pk_bf16_f32 v104, v17, v18
    v_add_f32 v13, v74, v90
    v_add_f32 v14, v75, v91
    v_cvt_pk_bf16_f32 v13, v13, v14
    v_lshlrev_b32 v15, 16, v193
    v_and_b32 v16, 0xffff0000, v193
    v_mul_f32 v15, v15, v96
    v_mul_f32 v16, v16, v96
    v_cvt_pk_bf16_f32 v15, v15, v16
    v_lshlrev_b32 v16, 16, v13
    v_lshlrev_b32 v17, 16, v15
    v_add_f32 v16, v16, v17
    v_and_b32 v17, 0xffff0000, v13
    v_and_b32 v18, 0xffff0000, v15
    v_add_f32 v17, v17, v18
    v_cvt_pk_bf16_f32 v16, v16, v17
    v_lshlrev_b32 v17, 16, v16
    v_add_f32 v17, v17, v178
    v_and_b32 v18, 0xffff0000, v16
    v_add_f32 v18, v18, v179
    v_cvt_pk_bf16_f32 v105, v17, v18
    v_add_f32 v13, v76, v92
    v_add_f32 v14, v77, v93
    v_cvt_pk_bf16_f32 v13, v13, v14
    v_lshlrev_b32 v15, 16, v194
    v_and_b32 v16, 0xffff0000, v194
    v_mul_f32 v15, v15, v96
    v_mul_f32 v16, v16, v96
    v_cvt_pk_bf16_f32 v15, v15, v16
    v_lshlrev_b32 v16, 16, v13
    v_lshlrev_b32 v17, 16, v15
    v_add_f32 v16, v16, v17
    v_and_b32 v17, 0xffff0000, v13
    v_and_b32 v18, 0xffff0000, v15
    v_add_f32 v17, v17, v18
    v_cvt_pk_bf16_f32 v16, v16, v17
    v_lshlrev_b32 v17, 16, v16
    v_add_f32 v17, v17, v180
    v_and_b32 v18, 0xffff0000, v16
    v_add_f32 v18, v18, v181
    v_cvt_pk_bf16_f32 v106, v17, v18
    v_add_f32 v13, v78, v94
    v_add_f32 v14, v79, v95
    v_cvt_pk_bf16_f32 v13, v13, v14
    v_lshlrev_b32 v15, 16, v195
    v_and_b32 v16, 0xffff0000, v195
    v_mul_f32 v15, v15, v96
    v_mul_f32 v16, v16, v96
    v_cvt_pk_bf16_f32 v15, v15, v16
    v_lshlrev_b32 v16, 16, v13
    v_lshlrev_b32 v17, 16, v15
    v_add_f32 v16, v16, v17
    v_and_b32 v17, 0xffff0000, v13
    v_and_b32 v18, 0xffff0000, v15
    v_add_f32 v17, v17, v18
    v_cvt_pk_bf16_f32 v16, v16, v17
    v_lshlrev_b32 v17, 16, v16
    v_add_f32 v17, v17, v182
    v_and_b32 v18, 0xffff0000, v16
    v_add_f32 v18, v18, v183
    v_cvt_pk_bf16_f32 v107, v17, v18
    v_lshlrev_b32 v12, 12, v3
    v_lshl_add_u32 v12, v2, 5, v12
    v_add_u32 v12, s23, v12
    buffer_store_dwordx4 v[100:103], v12, s[28:31], 0 offen
    buffer_store_dwordx4 v[104:107], v12, s[28:31], 0 offen offset:16
conv_done:
    s_endpgm
.globl gemm1a_kernel
.p2align 8
.type gemm1a_kernel,@function
gemm1a_kernel:
    s_mov_b32 s20, 0x0
    s_branch g1_common
.globl gemm1b_kernel
.p2align 8
.type gemm1b_kernel,@function
gemm1b_kernel:
    s_mov_b32 s20, 0x400000
g1_common:
    s_cmp_ge_u32 s2, 224
    s_cbranch_scc1 g1_done
    s_load_dwordx2 s[6:7], s[0:1], 120
    s_and_b32 s21, s2, 31
    s_lshr_b32 s22, s2, 5
    v_lshrrev_b32 v1, 3, v0
    v_and_b32 v2, 7, v0
    v_lshlrev_b32 v3, 12, v1
    v_lshl_add_u32 v3, v2, 4, v3
    s_lshl_b32 s3, s21, 7
    v_add_u32 v3, s3, v3
    v_and_b32 v4, 63, v0
    v_lshrrev_b32 v5, 6, v0
    s_lshl_b32 s3, s22, 3
    v_lshl_add_u32 v6, v5, 1, s3
    v_lshlrev_b32 v6, 15, v6
    v_lshl_add_u32 v6, v4, 4, v6
    s_waitcnt lgkmcnt(0)
    s_mov_b32 s28, s6
    s_mov_b32 s29, s7
    s_mov_b32 s30, 0x1c00000
    s_mov_b32 s31, 0x00020000
    s_add_u32 s24, s6, s20
    s_addc_u32 s25, s7, 0
    s_mov_b32 s26, 0x200000
    s_mov_b32 s27, 0x00020000
    s_mov_b32 s40, 0x0
    buffer_load_dwordx4 v[192:195], v3, s[24:27], s40 offen
    s_mov_b32 s40, 0x20000
    buffer_load_dwordx4 v[196:199], v3, s[24:27], s40 offen
    s_mov_b32 s40, 0x40000
    buffer_load_dwordx4 v[200:203], v3, s[24:27], s40 offen
    s_mov_b32 s40, 0x60000
    buffer_load_dwordx4 v[204:207], v3, s[24:27], s40 offen
    s_mov_b32 s40, 0x80000
    buffer_load_dwordx4 v[208:211], v3, s[24:27], s40 offen
    s_mov_b32 s40, 0xa0000
    buffer_load_dwordx4 v[212:215], v3, s[24:27], s40 offen
    s_mov_b32 s40, 0xc0000
    buffer_load_dwordx4 v[216:219], v3, s[24:27], s40 offen
    s_mov_b32 s40, 0xe0000
    buffer_load_dwordx4 v[220:223], v3, s[24:27], s40 offen
    s_mov_b32 s40, 0x100000
    buffer_load_dwordx4 v[224:227], v3, s[24:27], s40 offen
    s_mov_b32 s40, 0x120000
    buffer_load_dwordx4 v[228:231], v3, s[24:27], s40 offen
    s_mov_b32 s40, 0x140000
    buffer_load_dwordx4 v[232:235], v3, s[24:27], s40 offen
    s_mov_b32 s40, 0x160000
    buffer_load_dwordx4 v[236:239], v3, s[24:27], s40 offen
    s_mov_b32 s40, 0x180000
    buffer_load_dwordx4 v[240:243], v3, s[24:27], s40 offen
    s_mov_b32 s40, 0x1a0000
    buffer_load_dwordx4 v[244:247], v3, s[24:27], s40 offen
    s_mov_b32 s40, 0x1c0000
    buffer_load_dwordx4 v[248:251], v3, s[24:27], s40 offen
    s_mov_b32 s40, 0x1e0000
    buffer_load_dwordx4 v[252:255], v3, s[24:27], s40 offen
    s_mov_b32 s48, 0x1600000
    s_mov_b32 s49, 0x1608000
    s_mov_b32 s50, 0x1800000
    s_mov_b32 s51, 0x1808000
    buffer_load_dwordx4 v[64:67], v6, s[28:31], s48 offen
    buffer_load_dwordx4 v[68:71], v6, s[28:31], s50 offen
    s_add_u32 s48, s48, 1024
    s_add_u32 s50, s50, 1024
    buffer_load_dwordx4 v[72:75], v6, s[28:31], s48 offen
    buffer_load_dwordx4 v[76:79], v6, s[28:31], s50 offen
    s_add_u32 s48, s48, 1024
    s_add_u32 s50, s50, 1024
    buffer_load_dwordx4 v[80:83], v6, s[28:31], s48 offen
    buffer_load_dwordx4 v[84:87], v6, s[28:31], s50 offen
    s_add_u32 s48, s48, 1024
    s_add_u32 s50, s50, 1024
    buffer_load_dwordx4 v[88:91], v6, s[28:31], s48 offen
    buffer_load_dwordx4 v[92:95], v6, s[28:31], s50 offen
    s_add_u32 s48, s48, 1024
    s_add_u32 s50, s50, 1024
    buffer_load_dwordx4 v[96:99], v6, s[28:31], s48 offen
    buffer_load_dwordx4 v[100:103], v6, s[28:31], s50 offen
    s_add_u32 s48, s48, 1024
    s_add_u32 s50, s50, 1024
    buffer_load_dwordx4 v[104:107], v6, s[28:31], s48 offen
    buffer_load_dwordx4 v[108:111], v6, s[28:31], s50 offen
    s_add_u32 s48, s48, 1024
    s_add_u32 s50, s50, 1024
    buffer_load_dwordx4 v[112:115], v6, s[28:31], s48 offen
    buffer_load_dwordx4 v[116:119], v6, s[28:31], s50 offen
    s_add_u32 s48, s48, 1024
    s_add_u32 s50, s50, 1024
    buffer_load_dwordx4 v[120:123], v6, s[28:31], s48 offen
    buffer_load_dwordx4 v[124:127], v6, s[28:31], s50 offen
    s_add_u32 s48, s48, 1024
    s_add_u32 s50, s50, 1024
    s_waitcnt vmcnt(16)
    v_lshlrev_b32 v128, 16, v192
    v_and_b32 v129, 0xffff0000, v192
    v_lshlrev_b32 v130, 16, v193
    v_and_b32 v131, 0xffff0000, v193
    v_lshlrev_b32 v132, 16, v194
    v_and_b32 v133, 0xffff0000, v194
    v_lshlrev_b32 v134, 16, v195
    v_and_b32 v135, 0xffff0000, v195
    v_lshlrev_b32 v136, 16, v196
    v_and_b32 v137, 0xffff0000, v196
    v_lshlrev_b32 v138, 16, v197
    v_and_b32 v139, 0xffff0000, v197
    v_lshlrev_b32 v140, 16, v198
    v_and_b32 v141, 0xffff0000, v198
    v_lshlrev_b32 v142, 16, v199
    v_and_b32 v143, 0xffff0000, v199
    v_lshlrev_b32 v144, 16, v200
    v_and_b32 v145, 0xffff0000, v200
    v_lshlrev_b32 v146, 16, v201
    v_and_b32 v147, 0xffff0000, v201
    v_lshlrev_b32 v148, 16, v202
    v_and_b32 v149, 0xffff0000, v202
    v_lshlrev_b32 v150, 16, v203
    v_and_b32 v151, 0xffff0000, v203
    v_lshlrev_b32 v152, 16, v204
    v_and_b32 v153, 0xffff0000, v204
    v_lshlrev_b32 v154, 16, v205
    v_and_b32 v155, 0xffff0000, v205
    v_lshlrev_b32 v156, 16, v206
    v_and_b32 v157, 0xffff0000, v206
    v_lshlrev_b32 v158, 16, v207
    v_and_b32 v159, 0xffff0000, v207
    v_lshlrev_b32 v160, 16, v208
    v_and_b32 v161, 0xffff0000, v208
    v_lshlrev_b32 v162, 16, v209
    v_and_b32 v163, 0xffff0000, v209
    v_lshlrev_b32 v164, 16, v210
    v_and_b32 v165, 0xffff0000, v210
    v_lshlrev_b32 v166, 16, v211
    v_and_b32 v167, 0xffff0000, v211
    v_lshlrev_b32 v168, 16, v212
    v_and_b32 v169, 0xffff0000, v212
    v_lshlrev_b32 v170, 16, v213
    v_and_b32 v171, 0xffff0000, v213
    v_lshlrev_b32 v172, 16, v214
    v_and_b32 v173, 0xffff0000, v214
    v_lshlrev_b32 v174, 16, v215
    v_and_b32 v175, 0xffff0000, v215
    v_lshlrev_b32 v176, 16, v216
    v_and_b32 v177, 0xffff0000, v216
    v_lshlrev_b32 v178, 16, v217
    v_and_b32 v179, 0xffff0000, v217
    v_lshlrev_b32 v180, 16, v218
    v_and_b32 v181, 0xffff0000, v218
    v_lshlrev_b32 v182, 16, v219
    v_and_b32 v183, 0xffff0000, v219
    v_lshlrev_b32 v184, 16, v220
    v_and_b32 v185, 0xffff0000, v220
    v_lshlrev_b32 v186, 16, v221
    v_and_b32 v187, 0xffff0000, v221
    v_lshlrev_b32 v188, 16, v222
    v_and_b32 v189, 0xffff0000, v222
    v_lshlrev_b32 v190, 16, v223
    v_and_b32 v191, 0xffff0000, v223
    v_lshlrev_b32 v192, 16, v224
    v_and_b32 v193, 0xffff0000, v224
    v_lshlrev_b32 v194, 16, v225
    v_and_b32 v195, 0xffff0000, v225
    v_lshlrev_b32 v196, 16, v226
    v_and_b32 v197, 0xffff0000, v226
    v_lshlrev_b32 v198, 16, v227
    v_and_b32 v199, 0xffff0000, v227
    v_lshlrev_b32 v200, 16, v228
    v_and_b32 v201, 0xffff0000, v228
    v_lshlrev_b32 v202, 16, v229
    v_and_b32 v203, 0xffff0000, v229
    v_lshlrev_b32 v204, 16, v230
    v_and_b32 v205, 0xffff0000, v230
    v_lshlrev_b32 v206, 16, v231
    v_and_b32 v207, 0xffff0000, v231
    v_lshlrev_b32 v208, 16, v232
    v_and_b32 v209, 0xffff0000, v232
    v_lshlrev_b32 v210, 16, v233
    v_and_b32 v211, 0xffff0000, v233
    v_lshlrev_b32 v212, 16, v234
    v_and_b32 v213, 0xffff0000, v234
    v_lshlrev_b32 v214, 16, v235
    v_and_b32 v215, 0xffff0000, v235
    v_lshlrev_b32 v216, 16, v236
    v_and_b32 v217, 0xffff0000, v236
    v_lshlrev_b32 v218, 16, v237
    v_and_b32 v219, 0xffff0000, v237
    v_lshlrev_b32 v220, 16, v238
    v_and_b32 v221, 0xffff0000, v238
    v_lshlrev_b32 v222, 16, v239
    v_and_b32 v223, 0xffff0000, v239
    v_lshlrev_b32 v224, 16, v240
    v_and_b32 v225, 0xffff0000, v240
    v_lshlrev_b32 v226, 16, v241
    v_and_b32 v227, 0xffff0000, v241
    v_lshlrev_b32 v228, 16, v242
    v_and_b32 v229, 0xffff0000, v242
    v_lshlrev_b32 v230, 16, v243
    v_and_b32 v231, 0xffff0000, v243
    v_lshlrev_b32 v232, 16, v244
    v_and_b32 v233, 0xffff0000, v244
    v_lshlrev_b32 v234, 16, v245
    v_and_b32 v235, 0xffff0000, v245
    v_lshlrev_b32 v236, 16, v246
    v_and_b32 v237, 0xffff0000, v246
    v_lshlrev_b32 v238, 16, v247
    v_and_b32 v239, 0xffff0000, v247
    v_lshlrev_b32 v240, 16, v248
    v_and_b32 v241, 0xffff0000, v248
    v_lshlrev_b32 v242, 16, v249
    v_and_b32 v243, 0xffff0000, v249
    v_lshlrev_b32 v244, 16, v250
    v_and_b32 v245, 0xffff0000, v250
    v_lshlrev_b32 v246, 16, v251
    v_and_b32 v247, 0xffff0000, v251
    v_lshlrev_b32 v248, 16, v252
    v_and_b32 v249, 0xffff0000, v252
    v_lshlrev_b32 v250, 16, v253
    v_and_b32 v251, 0xffff0000, v253
    v_lshlrev_b32 v252, 16, v254
    v_and_b32 v253, 0xffff0000, v254
    v_lshlrev_b32 v254, 16, v255
    v_and_b32 v255, 0xffff0000, v255
    v_pk_add_f32 v[32:33], v[128:129], v[136:137]
    v_pk_add_f32 v[34:35], v[130:131], v[138:139]
    v_pk_add_f32 v[36:37], v[132:133], v[140:141]
    v_pk_add_f32 v[38:39], v[134:135], v[142:143]
    v_pk_add_f32 v[32:33], v[32:33], v[144:145]
    v_pk_add_f32 v[34:35], v[34:35], v[146:147]
    v_pk_add_f32 v[36:37], v[36:37], v[148:149]
    v_pk_add_f32 v[38:39], v[38:39], v[150:151]
    v_pk_add_f32 v[32:33], v[32:33], v[152:153]
    v_pk_add_f32 v[34:35], v[34:35], v[154:155]
    v_pk_add_f32 v[36:37], v[36:37], v[156:157]
    v_pk_add_f32 v[38:39], v[38:39], v[158:159]
    v_pk_add_f32 v[32:33], v[32:33], v[160:161]
    v_pk_add_f32 v[34:35], v[34:35], v[162:163]
    v_pk_add_f32 v[36:37], v[36:37], v[164:165]
    v_pk_add_f32 v[38:39], v[38:39], v[166:167]
    v_pk_add_f32 v[32:33], v[32:33], v[168:169]
    v_pk_add_f32 v[34:35], v[34:35], v[170:171]
    v_pk_add_f32 v[36:37], v[36:37], v[172:173]
    v_pk_add_f32 v[38:39], v[38:39], v[174:175]
    v_pk_add_f32 v[32:33], v[32:33], v[176:177]
    v_pk_add_f32 v[34:35], v[34:35], v[178:179]
    v_pk_add_f32 v[36:37], v[36:37], v[180:181]
    v_pk_add_f32 v[38:39], v[38:39], v[182:183]
    v_pk_add_f32 v[32:33], v[32:33], v[184:185]
    v_pk_add_f32 v[34:35], v[34:35], v[186:187]
    v_pk_add_f32 v[36:37], v[36:37], v[188:189]
    v_pk_add_f32 v[38:39], v[38:39], v[190:191]
    v_pk_add_f32 v[32:33], v[32:33], v[192:193]
    v_pk_add_f32 v[34:35], v[34:35], v[194:195]
    v_pk_add_f32 v[36:37], v[36:37], v[196:197]
    v_pk_add_f32 v[38:39], v[38:39], v[198:199]
    v_pk_add_f32 v[32:33], v[32:33], v[200:201]
    v_pk_add_f32 v[34:35], v[34:35], v[202:203]
    v_pk_add_f32 v[36:37], v[36:37], v[204:205]
    v_pk_add_f32 v[38:39], v[38:39], v[206:207]
    v_pk_add_f32 v[32:33], v[32:33], v[208:209]
    v_pk_add_f32 v[34:35], v[34:35], v[210:211]
    v_pk_add_f32 v[36:37], v[36:37], v[212:213]
    v_pk_add_f32 v[38:39], v[38:39], v[214:215]
    v_pk_add_f32 v[32:33], v[32:33], v[216:217]
    v_pk_add_f32 v[34:35], v[34:35], v[218:219]
    v_pk_add_f32 v[36:37], v[36:37], v[220:221]
    v_pk_add_f32 v[38:39], v[38:39], v[222:223]
    v_pk_add_f32 v[32:33], v[32:33], v[224:225]
    v_pk_add_f32 v[34:35], v[34:35], v[226:227]
    v_pk_add_f32 v[36:37], v[36:37], v[228:229]
    v_pk_add_f32 v[38:39], v[38:39], v[230:231]
    v_pk_add_f32 v[32:33], v[32:33], v[232:233]
    v_pk_add_f32 v[34:35], v[34:35], v[234:235]
    v_pk_add_f32 v[36:37], v[36:37], v[236:237]
    v_pk_add_f32 v[38:39], v[38:39], v[238:239]
    v_pk_add_f32 v[32:33], v[32:33], v[240:241]
    v_pk_add_f32 v[34:35], v[34:35], v[242:243]
    v_pk_add_f32 v[36:37], v[36:37], v[244:245]
    v_pk_add_f32 v[38:39], v[38:39], v[246:247]
    v_pk_add_f32 v[32:33], v[32:33], v[248:249]
    v_pk_add_f32 v[34:35], v[34:35], v[250:251]
    v_pk_add_f32 v[36:37], v[36:37], v[252:253]
    v_pk_add_f32 v[38:39], v[38:39], v[254:255]
    v_lshlrev_b32 v7, 5, v0
    ds_write_b128 v7, v[32:35] offset:0
    ds_write_b128 v7, v[36:39] offset:16
    s_waitcnt lgkmcnt(0)
    s_barrier
    v_lshlrev_b32 v8, 2, v0
    v_cmp_gt_u32 vcc, 64, v0
    s_and_saveexec_b64 s[42:43], vcc
    ds_read_b32 v40, v8 offset:0
    ds_read_b32 v41, v8 offset:256
    ds_read_b32 v42, v8 offset:512
    ds_read_b32 v43, v8 offset:768
    ds_read_b32 v44, v8 offset:1024
    ds_read_b32 v45, v8 offset:1280
    ds_read_b32 v46, v8 offset:1536
    ds_read_b32 v47, v8 offset:1792
    ds_read_b32 v48, v8 offset:2048
    ds_read_b32 v49, v8 offset:2304
    ds_read_b32 v50, v8 offset:2560
    ds_read_b32 v51, v8 offset:2816
    ds_read_b32 v52, v8 offset:3072
    ds_read_b32 v53, v8 offset:3328
    ds_read_b32 v54, v8 offset:3584
    ds_read_b32 v55, v8 offset:3840
    ds_read_b32 v56, v8 offset:4096
    ds_read_b32 v57, v8 offset:4352
    ds_read_b32 v58, v8 offset:4608
    ds_read_b32 v59, v8 offset:4864
    ds_read_b32 v60, v8 offset:5120
    ds_read_b32 v61, v8 offset:5376
    ds_read_b32 v62, v8 offset:5632
    ds_read_b32 v63, v8 offset:5888
    ds_read_b32 v32, v8 offset:6144
    ds_read_b32 v33, v8 offset:6400
    ds_read_b32 v34, v8 offset:6656
    ds_read_b32 v35, v8 offset:6912
    ds_read_b32 v36, v8 offset:7168
    ds_read_b32 v37, v8 offset:7424
    ds_read_b32 v38, v8 offset:7680
    ds_read_b32 v39, v8 offset:7936
    s_waitcnt lgkmcnt(0)
    v_add_f32 v40, v40, v56
    v_add_f32 v41, v41, v57
    v_add_f32 v42, v42, v58
    v_add_f32 v43, v43, v59
    v_add_f32 v44, v44, v60
    v_add_f32 v45, v45, v61
    v_add_f32 v46, v46, v62
    v_add_f32 v47, v47, v63
    v_add_f32 v48, v48, v32
    v_add_f32 v49, v49, v33
    v_add_f32 v50, v50, v34
    v_add_f32 v51, v51, v35
    v_add_f32 v52, v52, v36
    v_add_f32 v53, v53, v37
    v_add_f32 v54, v54, v38
    v_add_f32 v55, v55, v39
    v_add_f32 v40, v40, v48
    v_add_f32 v41, v41, v49
    v_add_f32 v42, v42, v50
    v_add_f32 v43, v43, v51
    v_add_f32 v44, v44, v52
    v_add_f32 v45, v45, v53
    v_add_f32 v46, v46, v54
    v_add_f32 v47, v47, v55
    v_add_f32 v40, v40, v44
    v_add_f32 v41, v41, v45
    v_add_f32 v42, v42, v46
    v_add_f32 v43, v43, v47
    v_add_f32 v40, v40, v42
    v_add_f32 v41, v41, v43
    v_add_f32 v40, v40, v41
    v_mul_f32 v40, 0x3b000000, v40
    ds_write_b32 v8, v40 offset:8192
    s_mov_b64 exec, s[42:43]
    s_waitcnt lgkmcnt(0)
    s_barrier
    v_lshlrev_b32 v9, 5, v2
    ds_read_b128 v[40:43], v9 offset:8192
    ds_read_b128 v[44:47], v9 offset:8208
    s_waitcnt lgkmcnt(0)
    v_mov_b32 v32, 0
    v_mov_b32 v33, 0
    v_mov_b32 v34, 0
    v_mov_b32 v35, 0
    v_mov_b32 v36, 0
    v_mov_b32 v37, 0
    v_mov_b32 v38, 0
    v_mov_b32 v39, 0
    v_pk_add_f32 v[48:49], v[128:129], v[40:41] neg_lo:[0,1] neg_hi:[0,1]
    v_pk_fma_f32 v[32:33], v[48:49], v[48:49], v[32:33]
    v_pk_add_f32 v[48:49], v[130:131], v[42:43] neg_lo:[0,1] neg_hi:[0,1]
    v_pk_fma_f32 v[34:35], v[48:49], v[48:49], v[34:35]
    v_pk_add_f32 v[48:49], v[132:133], v[44:45] neg_lo:[0,1] neg_hi:[0,1]
    v_pk_fma_f32 v[36:37], v[48:49], v[48:49], v[36:37]
    v_pk_add_f32 v[48:49], v[134:135], v[46:47] neg_lo:[0,1] neg_hi:[0,1]
    v_pk_fma_f32 v[38:39], v[48:49], v[48:49], v[38:39]
    v_pk_add_f32 v[48:49], v[136:137], v[40:41] neg_lo:[0,1] neg_hi:[0,1]
    v_pk_fma_f32 v[32:33], v[48:49], v[48:49], v[32:33]
    v_pk_add_f32 v[48:49], v[138:139], v[42:43] neg_lo:[0,1] neg_hi:[0,1]
    v_pk_fma_f32 v[34:35], v[48:49], v[48:49], v[34:35]
    v_pk_add_f32 v[48:49], v[140:141], v[44:45] neg_lo:[0,1] neg_hi:[0,1]
    v_pk_fma_f32 v[36:37], v[48:49], v[48:49], v[36:37]
    v_pk_add_f32 v[48:49], v[142:143], v[46:47] neg_lo:[0,1] neg_hi:[0,1]
    v_pk_fma_f32 v[38:39], v[48:49], v[48:49], v[38:39]
    v_pk_add_f32 v[48:49], v[144:145], v[40:41] neg_lo:[0,1] neg_hi:[0,1]
    v_pk_fma_f32 v[32:33], v[48:49], v[48:49], v[32:33]
    v_pk_add_f32 v[48:49], v[146:147], v[42:43] neg_lo:[0,1] neg_hi:[0,1]
    v_pk_fma_f32 v[34:35], v[48:49], v[48:49], v[34:35]
    v_pk_add_f32 v[48:49], v[148:149], v[44:45] neg_lo:[0,1] neg_hi:[0,1]
    v_pk_fma_f32 v[36:37], v[48:49], v[48:49], v[36:37]
    v_pk_add_f32 v[48:49], v[150:151], v[46:47] neg_lo:[0,1] neg_hi:[0,1]
    v_pk_fma_f32 v[38:39], v[48:49], v[48:49], v[38:39]
    v_pk_add_f32 v[48:49], v[152:153], v[40:41] neg_lo:[0,1] neg_hi:[0,1]
    v_pk_fma_f32 v[32:33], v[48:49], v[48:49], v[32:33]
    v_pk_add_f32 v[48:49], v[154:155], v[42:43] neg_lo:[0,1] neg_hi:[0,1]
    v_pk_fma_f32 v[34:35], v[48:49], v[48:49], v[34:35]
    v_pk_add_f32 v[48:49], v[156:157], v[44:45] neg_lo:[0,1] neg_hi:[0,1]
    v_pk_fma_f32 v[36:37], v[48:49], v[48:49], v[36:37]
    v_pk_add_f32 v[48:49], v[158:159], v[46:47] neg_lo:[0,1] neg_hi:[0,1]
    v_pk_fma_f32 v[38:39], v[48:49], v[48:49], v[38:39]
    v_pk_add_f32 v[48:49], v[160:161], v[40:41] neg_lo:[0,1] neg_hi:[0,1]
    v_pk_fma_f32 v[32:33], v[48:49], v[48:49], v[32:33]
    v_pk_add_f32 v[48:49], v[162:163], v[42:43] neg_lo:[0,1] neg_hi:[0,1]
    v_pk_fma_f32 v[34:35], v[48:49], v[48:49], v[34:35]
    v_pk_add_f32 v[48:49], v[164:165], v[44:45] neg_lo:[0,1] neg_hi:[0,1]
    v_pk_fma_f32 v[36:37], v[48:49], v[48:49], v[36:37]
    v_pk_add_f32 v[48:49], v[166:167], v[46:47] neg_lo:[0,1] neg_hi:[0,1]
    v_pk_fma_f32 v[38:39], v[48:49], v[48:49], v[38:39]
    v_pk_add_f32 v[48:49], v[168:169], v[40:41] neg_lo:[0,1] neg_hi:[0,1]
    v_pk_fma_f32 v[32:33], v[48:49], v[48:49], v[32:33]
    v_pk_add_f32 v[48:49], v[170:171], v[42:43] neg_lo:[0,1] neg_hi:[0,1]
    v_pk_fma_f32 v[34:35], v[48:49], v[48:49], v[34:35]
    v_pk_add_f32 v[48:49], v[172:173], v[44:45] neg_lo:[0,1] neg_hi:[0,1]
    v_pk_fma_f32 v[36:37], v[48:49], v[48:49], v[36:37]
    v_pk_add_f32 v[48:49], v[174:175], v[46:47] neg_lo:[0,1] neg_hi:[0,1]
    v_pk_fma_f32 v[38:39], v[48:49], v[48:49], v[38:39]
    v_pk_add_f32 v[48:49], v[176:177], v[40:41] neg_lo:[0,1] neg_hi:[0,1]
    v_pk_fma_f32 v[32:33], v[48:49], v[48:49], v[32:33]
    v_pk_add_f32 v[48:49], v[178:179], v[42:43] neg_lo:[0,1] neg_hi:[0,1]
    v_pk_fma_f32 v[34:35], v[48:49], v[48:49], v[34:35]
    v_pk_add_f32 v[48:49], v[180:181], v[44:45] neg_lo:[0,1] neg_hi:[0,1]
    v_pk_fma_f32 v[36:37], v[48:49], v[48:49], v[36:37]
    v_pk_add_f32 v[48:49], v[182:183], v[46:47] neg_lo:[0,1] neg_hi:[0,1]
    v_pk_fma_f32 v[38:39], v[48:49], v[48:49], v[38:39]
    v_pk_add_f32 v[48:49], v[184:185], v[40:41] neg_lo:[0,1] neg_hi:[0,1]
    v_pk_fma_f32 v[32:33], v[48:49], v[48:49], v[32:33]
    v_pk_add_f32 v[48:49], v[186:187], v[42:43] neg_lo:[0,1] neg_hi:[0,1]
    v_pk_fma_f32 v[34:35], v[48:49], v[48:49], v[34:35]
    v_pk_add_f32 v[48:49], v[188:189], v[44:45] neg_lo:[0,1] neg_hi:[0,1]
    v_pk_fma_f32 v[36:37], v[48:49], v[48:49], v[36:37]
    v_pk_add_f32 v[48:49], v[190:191], v[46:47] neg_lo:[0,1] neg_hi:[0,1]
    v_pk_fma_f32 v[38:39], v[48:49], v[48:49], v[38:39]
    v_pk_add_f32 v[48:49], v[192:193], v[40:41] neg_lo:[0,1] neg_hi:[0,1]
    v_pk_fma_f32 v[32:33], v[48:49], v[48:49], v[32:33]
    v_pk_add_f32 v[48:49], v[194:195], v[42:43] neg_lo:[0,1] neg_hi:[0,1]
    v_pk_fma_f32 v[34:35], v[48:49], v[48:49], v[34:35]
    v_pk_add_f32 v[48:49], v[196:197], v[44:45] neg_lo:[0,1] neg_hi:[0,1]
    v_pk_fma_f32 v[36:37], v[48:49], v[48:49], v[36:37]
    v_pk_add_f32 v[48:49], v[198:199], v[46:47] neg_lo:[0,1] neg_hi:[0,1]
    v_pk_fma_f32 v[38:39], v[48:49], v[48:49], v[38:39]
    v_pk_add_f32 v[48:49], v[200:201], v[40:41] neg_lo:[0,1] neg_hi:[0,1]
    v_pk_fma_f32 v[32:33], v[48:49], v[48:49], v[32:33]
    v_pk_add_f32 v[48:49], v[202:203], v[42:43] neg_lo:[0,1] neg_hi:[0,1]
    v_pk_fma_f32 v[34:35], v[48:49], v[48:49], v[34:35]
    v_pk_add_f32 v[48:49], v[204:205], v[44:45] neg_lo:[0,1] neg_hi:[0,1]
    v_pk_fma_f32 v[36:37], v[48:49], v[48:49], v[36:37]
    v_pk_add_f32 v[48:49], v[206:207], v[46:47] neg_lo:[0,1] neg_hi:[0,1]
    v_pk_fma_f32 v[38:39], v[48:49], v[48:49], v[38:39]
    v_pk_add_f32 v[48:49], v[208:209], v[40:41] neg_lo:[0,1] neg_hi:[0,1]
    v_pk_fma_f32 v[32:33], v[48:49], v[48:49], v[32:33]
    v_pk_add_f32 v[48:49], v[210:211], v[42:43] neg_lo:[0,1] neg_hi:[0,1]
    v_pk_fma_f32 v[34:35], v[48:49], v[48:49], v[34:35]
    v_pk_add_f32 v[48:49], v[212:213], v[44:45] neg_lo:[0,1] neg_hi:[0,1]
    v_pk_fma_f32 v[36:37], v[48:49], v[48:49], v[36:37]
    v_pk_add_f32 v[48:49], v[214:215], v[46:47] neg_lo:[0,1] neg_hi:[0,1]
    v_pk_fma_f32 v[38:39], v[48:49], v[48:49], v[38:39]
    v_pk_add_f32 v[48:49], v[216:217], v[40:41] neg_lo:[0,1] neg_hi:[0,1]
    v_pk_fma_f32 v[32:33], v[48:49], v[48:49], v[32:33]
    v_pk_add_f32 v[48:49], v[218:219], v[42:43] neg_lo:[0,1] neg_hi:[0,1]
    v_pk_fma_f32 v[34:35], v[48:49], v[48:49], v[34:35]
    v_pk_add_f32 v[48:49], v[220:221], v[44:45] neg_lo:[0,1] neg_hi:[0,1]
    v_pk_fma_f32 v[36:37], v[48:49], v[48:49], v[36:37]
    v_pk_add_f32 v[48:49], v[222:223], v[46:47] neg_lo:[0,1] neg_hi:[0,1]
    v_pk_fma_f32 v[38:39], v[48:49], v[48:49], v[38:39]
    v_pk_add_f32 v[48:49], v[224:225], v[40:41] neg_lo:[0,1] neg_hi:[0,1]
    v_pk_fma_f32 v[32:33], v[48:49], v[48:49], v[32:33]
    v_pk_add_f32 v[48:49], v[226:227], v[42:43] neg_lo:[0,1] neg_hi:[0,1]
    v_pk_fma_f32 v[34:35], v[48:49], v[48:49], v[34:35]
    v_pk_add_f32 v[48:49], v[228:229], v[44:45] neg_lo:[0,1] neg_hi:[0,1]
    v_pk_fma_f32 v[36:37], v[48:49], v[48:49], v[36:37]
    v_pk_add_f32 v[48:49], v[230:231], v[46:47] neg_lo:[0,1] neg_hi:[0,1]
    v_pk_fma_f32 v[38:39], v[48:49], v[48:49], v[38:39]
    v_pk_add_f32 v[48:49], v[232:233], v[40:41] neg_lo:[0,1] neg_hi:[0,1]
    v_pk_fma_f32 v[32:33], v[48:49], v[48:49], v[32:33]
    v_pk_add_f32 v[48:49], v[234:235], v[42:43] neg_lo:[0,1] neg_hi:[0,1]
    v_pk_fma_f32 v[34:35], v[48:49], v[48:49], v[34:35]
    v_pk_add_f32 v[48:49], v[236:237], v[44:45] neg_lo:[0,1] neg_hi:[0,1]
    v_pk_fma_f32 v[36:37], v[48:49], v[48:49], v[36:37]
    v_pk_add_f32 v[48:49], v[238:239], v[46:47] neg_lo:[0,1] neg_hi:[0,1]
    v_pk_fma_f32 v[38:39], v[48:49], v[48:49], v[38:39]
    v_pk_add_f32 v[48:49], v[240:241], v[40:41] neg_lo:[0,1] neg_hi:[0,1]
    v_pk_fma_f32 v[32:33], v[48:49], v[48:49], v[32:33]
    v_pk_add_f32 v[48:49], v[242:243], v[42:43] neg_lo:[0,1] neg_hi:[0,1]
    v_pk_fma_f32 v[34:35], v[48:49], v[48:49], v[34:35]
    v_pk_add_f32 v[48:49], v[244:245], v[44:45] neg_lo:[0,1] neg_hi:[0,1]
    v_pk_fma_f32 v[36:37], v[48:49], v[48:49], v[36:37]
    v_pk_add_f32 v[48:49], v[246:247], v[46:47] neg_lo:[0,1] neg_hi:[0,1]
    v_pk_fma_f32 v[38:39], v[48:49], v[48:49], v[38:39]
    v_pk_add_f32 v[48:49], v[248:249], v[40:41] neg_lo:[0,1] neg_hi:[0,1]
    v_pk_fma_f32 v[32:33], v[48:49], v[48:49], v[32:33]
    v_pk_add_f32 v[48:49], v[250:251], v[42:43] neg_lo:[0,1] neg_hi:[0,1]
    v_pk_fma_f32 v[34:35], v[48:49], v[48:49], v[34:35]
    v_pk_add_f32 v[48:49], v[252:253], v[44:45] neg_lo:[0,1] neg_hi:[0,1]
    v_pk_fma_f32 v[36:37], v[48:49], v[48:49], v[36:37]
    v_pk_add_f32 v[48:49], v[254:255], v[46:47] neg_lo:[0,1] neg_hi:[0,1]
    v_pk_fma_f32 v[38:39], v[48:49], v[48:49], v[38:39]
    ds_write_b128 v7, v[32:35] offset:0
    ds_write_b128 v7, v[36:39] offset:16
    s_waitcnt lgkmcnt(0)
    s_barrier
    s_and_saveexec_b64 s[42:43], vcc
    ds_read_b32 v40, v8 offset:0
    ds_read_b32 v41, v8 offset:256
    ds_read_b32 v42, v8 offset:512
    ds_read_b32 v43, v8 offset:768
    ds_read_b32 v44, v8 offset:1024
    ds_read_b32 v45, v8 offset:1280
    ds_read_b32 v46, v8 offset:1536
    ds_read_b32 v47, v8 offset:1792
    ds_read_b32 v48, v8 offset:2048
    ds_read_b32 v49, v8 offset:2304
    ds_read_b32 v50, v8 offset:2560
    ds_read_b32 v51, v8 offset:2816
    ds_read_b32 v52, v8 offset:3072
    ds_read_b32 v53, v8 offset:3328
    ds_read_b32 v54, v8 offset:3584
    ds_read_b32 v55, v8 offset:3840
    ds_read_b32 v56, v8 offset:4096
    ds_read_b32 v57, v8 offset:4352
    ds_read_b32 v58, v8 offset:4608
    ds_read_b32 v59, v8 offset:4864
    ds_read_b32 v60, v8 offset:5120
    ds_read_b32 v61, v8 offset:5376
    ds_read_b32 v62, v8 offset:5632
    ds_read_b32 v63, v8 offset:5888
    ds_read_b32 v32, v8 offset:6144
    ds_read_b32 v33, v8 offset:6400
    ds_read_b32 v34, v8 offset:6656
    ds_read_b32 v35, v8 offset:6912
    ds_read_b32 v36, v8 offset:7168
    ds_read_b32 v37, v8 offset:7424
    ds_read_b32 v38, v8 offset:7680
    ds_read_b32 v39, v8 offset:7936
    ds_read_b32 v10, v8 offset:8192
    s_waitcnt lgkmcnt(0)
    v_add_f32 v40, v40, v56
    v_add_f32 v41, v41, v57
    v_add_f32 v42, v42, v58
    v_add_f32 v43, v43, v59
    v_add_f32 v44, v44, v60
    v_add_f32 v45, v45, v61
    v_add_f32 v46, v46, v62
    v_add_f32 v47, v47, v63
    v_add_f32 v48, v48, v32
    v_add_f32 v49, v49, v33
    v_add_f32 v50, v50, v34
    v_add_f32 v51, v51, v35
    v_add_f32 v52, v52, v36
    v_add_f32 v53, v53, v37
    v_add_f32 v54, v54, v38
    v_add_f32 v55, v55, v39
    v_add_f32 v40, v40, v48
    v_add_f32 v41, v41, v49
    v_add_f32 v42, v42, v50
    v_add_f32 v43, v43, v51
    v_add_f32 v44, v44, v52
    v_add_f32 v45, v45, v53
    v_add_f32 v46, v46, v54
    v_add_f32 v47, v47, v55
    v_add_f32 v40, v40, v44
    v_add_f32 v41, v41, v45
    v_add_f32 v42, v42, v46
    v_add_f32 v43, v43, v47
    v_add_f32 v40, v40, v42
    v_add_f32 v41, v41, v43
    v_add_f32 v40, v40, v41
    v_mul_f32 v40, 0x3b000000, v40
    v_cvt_pk_bf16_f32 v41, v10, v40
    v_lshlrev_b32 v42, 16, v41
    v_and_b32 v40, 0xffff0000, v41
    v_add_f32 v40, 0x3727c5ac, v40
    v_cvt_pk_bf16_f32 v40, v40, v40
    v_lshlrev_b32 v40, 16, v40
    v_sqrt_f32 v40, v40
    s_nop 0
    v_cvt_pk_bf16_f32 v40, v40, v40
    v_lshlrev_b32 v40, 16, v40
    v_rcp_f32 v43, v40
    s_nop 0
    ds_write_b32 v8, v42 offset:8448
    ds_write_b32 v8, v43 offset:8704
    s_mov_b64 exec, s[42:43]
    s_waitcnt lgkmcnt(0)
    s_barrier
    ds_read_b128 v[32:35], v9 offset:8448
    ds_read_b128 v[36:39], v9 offset:8464
    ds_read_b128 v[40:43], v9 offset:8704
    ds_read_b128 v[44:47], v9 offset:8720
    v_mul_u32_u24 v10, 192, v1
    v_lshl_add_u32 v10, v2, 4, v10
    v_add_u32 v10, 9216, v10
    v_add_u32 v15, 49152, v10
    s_waitcnt lgkmcnt(0)
    v_pk_add_f32 v[48:49], v[128:129], v[32:33] neg_lo:[0,1] neg_hi:[0,1]
    v_cvt_pk_bf16_f32 v50, v48, v49
    v_lshlrev_b32 v48, 16, v50
    v_and_b32 v49, 0xffff0000, v50
    v_pk_mul_f32 v[48:49], v[48:49], v[40:41]
    v_cvt_pk_bf16_f32 v52, v48, v49
    v_pk_add_f32 v[48:49], v[130:131], v[34:35] neg_lo:[0,1] neg_hi:[0,1]
    v_cvt_pk_bf16_f32 v50, v48, v49
    v_lshlrev_b32 v48, 16, v50
    v_and_b32 v49, 0xffff0000, v50
    v_pk_mul_f32 v[48:49], v[48:49], v[42:43]
    v_cvt_pk_bf16_f32 v53, v48, v49
    v_pk_add_f32 v[48:49], v[132:133], v[36:37] neg_lo:[0,1] neg_hi:[0,1]
    v_cvt_pk_bf16_f32 v50, v48, v49
    v_lshlrev_b32 v48, 16, v50
    v_and_b32 v49, 0xffff0000, v50
    v_pk_mul_f32 v[48:49], v[48:49], v[44:45]
    v_cvt_pk_bf16_f32 v54, v48, v49
    v_pk_add_f32 v[48:49], v[134:135], v[38:39] neg_lo:[0,1] neg_hi:[0,1]
    v_cvt_pk_bf16_f32 v50, v48, v49
    v_lshlrev_b32 v48, 16, v50
    v_and_b32 v49, 0xffff0000, v50
    v_pk_mul_f32 v[48:49], v[48:49], v[46:47]
    v_cvt_pk_bf16_f32 v55, v48, v49
    ds_write_b128 v10, v[52:55] offset:0
    s_nop 0
    v_pk_add_f32 v[48:49], v[136:137], v[32:33] neg_lo:[0,1] neg_hi:[0,1]
    v_cvt_pk_bf16_f32 v50, v48, v49
    v_lshlrev_b32 v48, 16, v50
    v_and_b32 v49, 0xffff0000, v50
    v_pk_mul_f32 v[48:49], v[48:49], v[40:41]
    v_cvt_pk_bf16_f32 v52, v48, v49
    v_pk_add_f32 v[48:49], v[138:139], v[34:35] neg_lo:[0,1] neg_hi:[0,1]
    v_cvt_pk_bf16_f32 v50, v48, v49
    v_lshlrev_b32 v48, 16, v50
    v_and_b32 v49, 0xffff0000, v50
    v_pk_mul_f32 v[48:49], v[48:49], v[42:43]
    v_cvt_pk_bf16_f32 v53, v48, v49
    v_pk_add_f32 v[48:49], v[140:141], v[36:37] neg_lo:[0,1] neg_hi:[0,1]
    v_cvt_pk_bf16_f32 v50, v48, v49
    v_lshlrev_b32 v48, 16, v50
    v_and_b32 v49, 0xffff0000, v50
    v_pk_mul_f32 v[48:49], v[48:49], v[44:45]
    v_cvt_pk_bf16_f32 v54, v48, v49
    v_pk_add_f32 v[48:49], v[142:143], v[38:39] neg_lo:[0,1] neg_hi:[0,1]
    v_cvt_pk_bf16_f32 v50, v48, v49
    v_lshlrev_b32 v48, 16, v50
    v_and_b32 v49, 0xffff0000, v50
    v_pk_mul_f32 v[48:49], v[48:49], v[46:47]
    v_cvt_pk_bf16_f32 v55, v48, v49
    ds_write_b128 v10, v[52:55] offset:6144
    s_nop 0
    v_pk_add_f32 v[48:49], v[144:145], v[32:33] neg_lo:[0,1] neg_hi:[0,1]
    v_cvt_pk_bf16_f32 v50, v48, v49
    v_lshlrev_b32 v48, 16, v50
    v_and_b32 v49, 0xffff0000, v50
    v_pk_mul_f32 v[48:49], v[48:49], v[40:41]
    v_cvt_pk_bf16_f32 v52, v48, v49
    v_pk_add_f32 v[48:49], v[146:147], v[34:35] neg_lo:[0,1] neg_hi:[0,1]
    v_cvt_pk_bf16_f32 v50, v48, v49
    v_lshlrev_b32 v48, 16, v50
    v_and_b32 v49, 0xffff0000, v50
    v_pk_mul_f32 v[48:49], v[48:49], v[42:43]
    v_cvt_pk_bf16_f32 v53, v48, v49
    v_pk_add_f32 v[48:49], v[148:149], v[36:37] neg_lo:[0,1] neg_hi:[0,1]
    v_cvt_pk_bf16_f32 v50, v48, v49
    v_lshlrev_b32 v48, 16, v50
    v_and_b32 v49, 0xffff0000, v50
    v_pk_mul_f32 v[48:49], v[48:49], v[44:45]
    v_cvt_pk_bf16_f32 v54, v48, v49
    v_pk_add_f32 v[48:49], v[150:151], v[38:39] neg_lo:[0,1] neg_hi:[0,1]
    v_cvt_pk_bf16_f32 v50, v48, v49
    v_lshlrev_b32 v48, 16, v50
    v_and_b32 v49, 0xffff0000, v50
    v_pk_mul_f32 v[48:49], v[48:49], v[46:47]
    v_cvt_pk_bf16_f32 v55, v48, v49
    ds_write_b128 v10, v[52:55] offset:12288
    s_nop 0
    v_pk_add_f32 v[48:49], v[152:153], v[32:33] neg_lo:[0,1] neg_hi:[0,1]
    v_cvt_pk_bf16_f32 v50, v48, v49
    v_lshlrev_b32 v48, 16, v50
    v_and_b32 v49, 0xffff0000, v50
    v_pk_mul_f32 v[48:49], v[48:49], v[40:41]
    v_cvt_pk_bf16_f32 v52, v48, v49
    v_pk_add_f32 v[48:49], v[154:155], v[34:35] neg_lo:[0,1] neg_hi:[0,1]
    v_cvt_pk_bf16_f32 v50, v48, v49
    v_lshlrev_b32 v48, 16, v50
    v_and_b32 v49, 0xffff0000, v50
    v_pk_mul_f32 v[48:49], v[48:49], v[42:43]
    v_cvt_pk_bf16_f32 v53, v48, v49
    v_pk_add_f32 v[48:49], v[156:157], v[36:37] neg_lo:[0,1] neg_hi:[0,1]
    v_cvt_pk_bf16_f32 v50, v48, v49
    v_lshlrev_b32 v48, 16, v50
    v_and_b32 v49, 0xffff0000, v50
    v_pk_mul_f32 v[48:49], v[48:49], v[44:45]
    v_cvt_pk_bf16_f32 v54, v48, v49
    v_pk_add_f32 v[48:49], v[158:159], v[38:39] neg_lo:[0,1] neg_hi:[0,1]
    v_cvt_pk_bf16_f32 v50, v48, v49
    v_lshlrev_b32 v48, 16, v50
    v_and_b32 v49, 0xffff0000, v50
    v_pk_mul_f32 v[48:49], v[48:49], v[46:47]
    v_cvt_pk_bf16_f32 v55, v48, v49
    ds_write_b128 v10, v[52:55] offset:18432
    s_nop 0
    v_pk_add_f32 v[48:49], v[160:161], v[32:33] neg_lo:[0,1] neg_hi:[0,1]
    v_cvt_pk_bf16_f32 v50, v48, v49
    v_lshlrev_b32 v48, 16, v50
    v_and_b32 v49, 0xffff0000, v50
    v_pk_mul_f32 v[48:49], v[48:49], v[40:41]
    v_cvt_pk_bf16_f32 v52, v48, v49
    v_pk_add_f32 v[48:49], v[162:163], v[34:35] neg_lo:[0,1] neg_hi:[0,1]
    v_cvt_pk_bf16_f32 v50, v48, v49
    v_lshlrev_b32 v48, 16, v50
    v_and_b32 v49, 0xffff0000, v50
    v_pk_mul_f32 v[48:49], v[48:49], v[42:43]
    v_cvt_pk_bf16_f32 v53, v48, v49
    v_pk_add_f32 v[48:49], v[164:165], v[36:37] neg_lo:[0,1] neg_hi:[0,1]
    v_cvt_pk_bf16_f32 v50, v48, v49
    v_lshlrev_b32 v48, 16, v50
    v_and_b32 v49, 0xffff0000, v50
    v_pk_mul_f32 v[48:49], v[48:49], v[44:45]
    v_cvt_pk_bf16_f32 v54, v48, v49
    v_pk_add_f32 v[48:49], v[166:167], v[38:39] neg_lo:[0,1] neg_hi:[0,1]
    v_cvt_pk_bf16_f32 v50, v48, v49
    v_lshlrev_b32 v48, 16, v50
    v_and_b32 v49, 0xffff0000, v50
    v_pk_mul_f32 v[48:49], v[48:49], v[46:47]
    v_cvt_pk_bf16_f32 v55, v48, v49
    ds_write_b128 v10, v[52:55] offset:24576
    s_nop 0
    v_pk_add_f32 v[48:49], v[168:169], v[32:33] neg_lo:[0,1] neg_hi:[0,1]
    v_cvt_pk_bf16_f32 v50, v48, v49
    v_lshlrev_b32 v48, 16, v50
    v_and_b32 v49, 0xffff0000, v50
    v_pk_mul_f32 v[48:49], v[48:49], v[40:41]
    v_cvt_pk_bf16_f32 v52, v48, v49
    v_pk_add_f32 v[48:49], v[170:171], v[34:35] neg_lo:[0,1] neg_hi:[0,1]
    v_cvt_pk_bf16_f32 v50, v48, v49
    v_lshlrev_b32 v48, 16, v50
    v_and_b32 v49, 0xffff0000, v50
    v_pk_mul_f32 v[48:49], v[48:49], v[42:43]
    v_cvt_pk_bf16_f32 v53, v48, v49
    v_pk_add_f32 v[48:49], v[172:173], v[36:37] neg_lo:[0,1] neg_hi:[0,1]
    v_cvt_pk_bf16_f32 v50, v48, v49
    v_lshlrev_b32 v48, 16, v50
    v_and_b32 v49, 0xffff0000, v50
    v_pk_mul_f32 v[48:49], v[48:49], v[44:45]
    v_cvt_pk_bf16_f32 v54, v48, v49
    v_pk_add_f32 v[48:49], v[174:175], v[38:39] neg_lo:[0,1] neg_hi:[0,1]
    v_cvt_pk_bf16_f32 v50, v48, v49
    v_lshlrev_b32 v48, 16, v50
    v_and_b32 v49, 0xffff0000, v50
    v_pk_mul_f32 v[48:49], v[48:49], v[46:47]
    v_cvt_pk_bf16_f32 v55, v48, v49
    ds_write_b128 v10, v[52:55] offset:30720
    s_nop 0
    v_pk_add_f32 v[48:49], v[176:177], v[32:33] neg_lo:[0,1] neg_hi:[0,1]
    v_cvt_pk_bf16_f32 v50, v48, v49
    v_lshlrev_b32 v48, 16, v50
    v_and_b32 v49, 0xffff0000, v50
    v_pk_mul_f32 v[48:49], v[48:49], v[40:41]
    v_cvt_pk_bf16_f32 v52, v48, v49
    v_pk_add_f32 v[48:49], v[178:179], v[34:35] neg_lo:[0,1] neg_hi:[0,1]
    v_cvt_pk_bf16_f32 v50, v48, v49
    v_lshlrev_b32 v48, 16, v50
    v_and_b32 v49, 0xffff0000, v50
    v_pk_mul_f32 v[48:49], v[48:49], v[42:43]
    v_cvt_pk_bf16_f32 v53, v48, v49
    v_pk_add_f32 v[48:49], v[180:181], v[36:37] neg_lo:[0,1] neg_hi:[0,1]
    v_cvt_pk_bf16_f32 v50, v48, v49
    v_lshlrev_b32 v48, 16, v50
    v_and_b32 v49, 0xffff0000, v50
    v_pk_mul_f32 v[48:49], v[48:49], v[44:45]
    v_cvt_pk_bf16_f32 v54, v48, v49
    v_pk_add_f32 v[48:49], v[182:183], v[38:39] neg_lo:[0,1] neg_hi:[0,1]
    v_cvt_pk_bf16_f32 v50, v48, v49
    v_lshlrev_b32 v48, 16, v50
    v_and_b32 v49, 0xffff0000, v50
    v_pk_mul_f32 v[48:49], v[48:49], v[46:47]
    v_cvt_pk_bf16_f32 v55, v48, v49
    ds_write_b128 v10, v[52:55] offset:36864
    s_nop 0
    v_pk_add_f32 v[48:49], v[184:185], v[32:33] neg_lo:[0,1] neg_hi:[0,1]
    v_cvt_pk_bf16_f32 v50, v48, v49
    v_lshlrev_b32 v48, 16, v50
    v_and_b32 v49, 0xffff0000, v50
    v_pk_mul_f32 v[48:49], v[48:49], v[40:41]
    v_cvt_pk_bf16_f32 v52, v48, v49
    v_pk_add_f32 v[48:49], v[186:187], v[34:35] neg_lo:[0,1] neg_hi:[0,1]
    v_cvt_pk_bf16_f32 v50, v48, v49
    v_lshlrev_b32 v48, 16, v50
    v_and_b32 v49, 0xffff0000, v50
    v_pk_mul_f32 v[48:49], v[48:49], v[42:43]
    v_cvt_pk_bf16_f32 v53, v48, v49
    v_pk_add_f32 v[48:49], v[188:189], v[36:37] neg_lo:[0,1] neg_hi:[0,1]
    v_cvt_pk_bf16_f32 v50, v48, v49
    v_lshlrev_b32 v48, 16, v50
    v_and_b32 v49, 0xffff0000, v50
    v_pk_mul_f32 v[48:49], v[48:49], v[44:45]
    v_cvt_pk_bf16_f32 v54, v48, v49
    v_pk_add_f32 v[48:49], v[190:191], v[38:39] neg_lo:[0,1] neg_hi:[0,1]
    v_cvt_pk_bf16_f32 v50, v48, v49
    v_lshlrev_b32 v48, 16, v50
    v_and_b32 v49, 0xffff0000, v50
    v_pk_mul_f32 v[48:49], v[48:49], v[46:47]
    v_cvt_pk_bf16_f32 v55, v48, v49
    ds_write_b128 v10, v[52:55] offset:43008
    s_nop 0
    v_pk_add_f32 v[48:49], v[192:193], v[32:33] neg_lo:[0,1] neg_hi:[0,1]
    v_cvt_pk_bf16_f32 v50, v48, v49
    v_lshlrev_b32 v48, 16, v50
    v_and_b32 v49, 0xffff0000, v50
    v_pk_mul_f32 v[48:49], v[48:49], v[40:41]
    v_cvt_pk_bf16_f32 v52, v48, v49
    v_pk_add_f32 v[48:49], v[194:195], v[34:35] neg_lo:[0,1] neg_hi:[0,1]
    v_cvt_pk_bf16_f32 v50, v48, v49
    v_lshlrev_b32 v48, 16, v50
    v_and_b32 v49, 0xffff0000, v50
    v_pk_mul_f32 v[48:49], v[48:49], v[42:43]
    v_cvt_pk_bf16_f32 v53, v48, v49
    v_pk_add_f32 v[48:49], v[196:197], v[36:37] neg_lo:[0,1] neg_hi:[0,1]
    v_cvt_pk_bf16_f32 v50, v48, v49
    v_lshlrev_b32 v48, 16, v50
    v_and_b32 v49, 0xffff0000, v50
    v_pk_mul_f32 v[48:49], v[48:49], v[44:45]
    v_cvt_pk_bf16_f32 v54, v48, v49
    v_pk_add_f32 v[48:49], v[198:199], v[38:39] neg_lo:[0,1] neg_hi:[0,1]
    v_cvt_pk_bf16_f32 v50, v48, v49
    v_lshlrev_b32 v48, 16, v50
    v_and_b32 v49, 0xffff0000, v50
    v_pk_mul_f32 v[48:49], v[48:49], v[46:47]
    v_cvt_pk_bf16_f32 v55, v48, v49
    ds_write_b128 v15, v[52:55] offset:0
    s_nop 0
    v_pk_add_f32 v[48:49], v[200:201], v[32:33] neg_lo:[0,1] neg_hi:[0,1]
    v_cvt_pk_bf16_f32 v50, v48, v49
    v_lshlrev_b32 v48, 16, v50
    v_and_b32 v49, 0xffff0000, v50
    v_pk_mul_f32 v[48:49], v[48:49], v[40:41]
    v_cvt_pk_bf16_f32 v52, v48, v49
    v_pk_add_f32 v[48:49], v[202:203], v[34:35] neg_lo:[0,1] neg_hi:[0,1]
    v_cvt_pk_bf16_f32 v50, v48, v49
    v_lshlrev_b32 v48, 16, v50
    v_and_b32 v49, 0xffff0000, v50
    v_pk_mul_f32 v[48:49], v[48:49], v[42:43]
    v_cvt_pk_bf16_f32 v53, v48, v49
    v_pk_add_f32 v[48:49], v[204:205], v[36:37] neg_lo:[0,1] neg_hi:[0,1]
    v_cvt_pk_bf16_f32 v50, v48, v49
    v_lshlrev_b32 v48, 16, v50
    v_and_b32 v49, 0xffff0000, v50
    v_pk_mul_f32 v[48:49], v[48:49], v[44:45]
    v_cvt_pk_bf16_f32 v54, v48, v49
    v_pk_add_f32 v[48:49], v[206:207], v[38:39] neg_lo:[0,1] neg_hi:[0,1]
    v_cvt_pk_bf16_f32 v50, v48, v49
    v_lshlrev_b32 v48, 16, v50
    v_and_b32 v49, 0xffff0000, v50
    v_pk_mul_f32 v[48:49], v[48:49], v[46:47]
    v_cvt_pk_bf16_f32 v55, v48, v49
    ds_write_b128 v15, v[52:55] offset:6144
    s_nop 0
    v_pk_add_f32 v[48:49], v[208:209], v[32:33] neg_lo:[0,1] neg_hi:[0,1]
    v_cvt_pk_bf16_f32 v50, v48, v49
    v_lshlrev_b32 v48, 16, v50
    v_and_b32 v49, 0xffff0000, v50
    v_pk_mul_f32 v[48:49], v[48:49], v[40:41]
    v_cvt_pk_bf16_f32 v52, v48, v49
    v_pk_add_f32 v[48:49], v[210:211], v[34:35] neg_lo:[0,1] neg_hi:[0,1]
    v_cvt_pk_bf16_f32 v50, v48, v49
    v_lshlrev_b32 v48, 16, v50
    v_and_b32 v49, 0xffff0000, v50
    v_pk_mul_f32 v[48:49], v[48:49], v[42:43]
    v_cvt_pk_bf16_f32 v53, v48, v49
    v_pk_add_f32 v[48:49], v[212:213], v[36:37] neg_lo:[0,1] neg_hi:[0,1]
    v_cvt_pk_bf16_f32 v50, v48, v49
    v_lshlrev_b32 v48, 16, v50
    v_and_b32 v49, 0xffff0000, v50
    v_pk_mul_f32 v[48:49], v[48:49], v[44:45]
    v_cvt_pk_bf16_f32 v54, v48, v49
    v_pk_add_f32 v[48:49], v[214:215], v[38:39] neg_lo:[0,1] neg_hi:[0,1]
    v_cvt_pk_bf16_f32 v50, v48, v49
    v_lshlrev_b32 v48, 16, v50
    v_and_b32 v49, 0xffff0000, v50
    v_pk_mul_f32 v[48:49], v[48:49], v[46:47]
    v_cvt_pk_bf16_f32 v55, v48, v49
    ds_write_b128 v15, v[52:55] offset:12288
    s_nop 0
    v_pk_add_f32 v[48:49], v[216:217], v[32:33] neg_lo:[0,1] neg_hi:[0,1]
    v_cvt_pk_bf16_f32 v50, v48, v49
    v_lshlrev_b32 v48, 16, v50
    v_and_b32 v49, 0xffff0000, v50
    v_pk_mul_f32 v[48:49], v[48:49], v[40:41]
    v_cvt_pk_bf16_f32 v52, v48, v49
    v_pk_add_f32 v[48:49], v[218:219], v[34:35] neg_lo:[0,1] neg_hi:[0,1]
    v_cvt_pk_bf16_f32 v50, v48, v49
    v_lshlrev_b32 v48, 16, v50
    v_and_b32 v49, 0xffff0000, v50
    v_pk_mul_f32 v[48:49], v[48:49], v[42:43]
    v_cvt_pk_bf16_f32 v53, v48, v49
    v_pk_add_f32 v[48:49], v[220:221], v[36:37] neg_lo:[0,1] neg_hi:[0,1]
    v_cvt_pk_bf16_f32 v50, v48, v49
    v_lshlrev_b32 v48, 16, v50
    v_and_b32 v49, 0xffff0000, v50
    v_pk_mul_f32 v[48:49], v[48:49], v[44:45]
    v_cvt_pk_bf16_f32 v54, v48, v49
    v_pk_add_f32 v[48:49], v[222:223], v[38:39] neg_lo:[0,1] neg_hi:[0,1]
    v_cvt_pk_bf16_f32 v50, v48, v49
    v_lshlrev_b32 v48, 16, v50
    v_and_b32 v49, 0xffff0000, v50
    v_pk_mul_f32 v[48:49], v[48:49], v[46:47]
    v_cvt_pk_bf16_f32 v55, v48, v49
    ds_write_b128 v15, v[52:55] offset:18432
    s_nop 0
    v_pk_add_f32 v[48:49], v[224:225], v[32:33] neg_lo:[0,1] neg_hi:[0,1]
    v_cvt_pk_bf16_f32 v50, v48, v49
    v_lshlrev_b32 v48, 16, v50
    v_and_b32 v49, 0xffff0000, v50
    v_pk_mul_f32 v[48:49], v[48:49], v[40:41]
    v_cvt_pk_bf16_f32 v52, v48, v49
    v_pk_add_f32 v[48:49], v[226:227], v[34:35] neg_lo:[0,1] neg_hi:[0,1]
    v_cvt_pk_bf16_f32 v50, v48, v49
    v_lshlrev_b32 v48, 16, v50
    v_and_b32 v49, 0xffff0000, v50
    v_pk_mul_f32 v[48:49], v[48:49], v[42:43]
    v_cvt_pk_bf16_f32 v53, v48, v49
    v_pk_add_f32 v[48:49], v[228:229], v[36:37] neg_lo:[0,1] neg_hi:[0,1]
    v_cvt_pk_bf16_f32 v50, v48, v49
    v_lshlrev_b32 v48, 16, v50
    v_and_b32 v49, 0xffff0000, v50
    v_pk_mul_f32 v[48:49], v[48:49], v[44:45]
    v_cvt_pk_bf16_f32 v54, v48, v49
    v_pk_add_f32 v[48:49], v[230:231], v[38:39] neg_lo:[0,1] neg_hi:[0,1]
    v_cvt_pk_bf16_f32 v50, v48, v49
    v_lshlrev_b32 v48, 16, v50
    v_and_b32 v49, 0xffff0000, v50
    v_pk_mul_f32 v[48:49], v[48:49], v[46:47]
    v_cvt_pk_bf16_f32 v55, v48, v49
    ds_write_b128 v15, v[52:55] offset:24576
    s_nop 0
    v_pk_add_f32 v[48:49], v[232:233], v[32:33] neg_lo:[0,1] neg_hi:[0,1]
    v_cvt_pk_bf16_f32 v50, v48, v49
    v_lshlrev_b32 v48, 16, v50
    v_and_b32 v49, 0xffff0000, v50
    v_pk_mul_f32 v[48:49], v[48:49], v[40:41]
    v_cvt_pk_bf16_f32 v52, v48, v49
    v_pk_add_f32 v[48:49], v[234:235], v[34:35] neg_lo:[0,1] neg_hi:[0,1]
    v_cvt_pk_bf16_f32 v50, v48, v49
    v_lshlrev_b32 v48, 16, v50
    v_and_b32 v49, 0xffff0000, v50
    v_pk_mul_f32 v[48:49], v[48:49], v[42:43]
    v_cvt_pk_bf16_f32 v53, v48, v49
    v_pk_add_f32 v[48:49], v[236:237], v[36:37] neg_lo:[0,1] neg_hi:[0,1]
    v_cvt_pk_bf16_f32 v50, v48, v49
    v_lshlrev_b32 v48, 16, v50
    v_and_b32 v49, 0xffff0000, v50
    v_pk_mul_f32 v[48:49], v[48:49], v[44:45]
    v_cvt_pk_bf16_f32 v54, v48, v49
    v_pk_add_f32 v[48:49], v[238:239], v[38:39] neg_lo:[0,1] neg_hi:[0,1]
    v_cvt_pk_bf16_f32 v50, v48, v49
    v_lshlrev_b32 v48, 16, v50
    v_and_b32 v49, 0xffff0000, v50
    v_pk_mul_f32 v[48:49], v[48:49], v[46:47]
    v_cvt_pk_bf16_f32 v55, v48, v49
    ds_write_b128 v15, v[52:55] offset:30720
    s_nop 0
    v_pk_add_f32 v[48:49], v[240:241], v[32:33] neg_lo:[0,1] neg_hi:[0,1]
    v_cvt_pk_bf16_f32 v50, v48, v49
    v_lshlrev_b32 v48, 16, v50
    v_and_b32 v49, 0xffff0000, v50
    v_pk_mul_f32 v[48:49], v[48:49], v[40:41]
    v_cvt_pk_bf16_f32 v52, v48, v49
    v_pk_add_f32 v[48:49], v[242:243], v[34:35] neg_lo:[0,1] neg_hi:[0,1]
    v_cvt_pk_bf16_f32 v50, v48, v49
    v_lshlrev_b32 v48, 16, v50
    v_and_b32 v49, 0xffff0000, v50
    v_pk_mul_f32 v[48:49], v[48:49], v[42:43]
    v_cvt_pk_bf16_f32 v53, v48, v49
    v_pk_add_f32 v[48:49], v[244:245], v[36:37] neg_lo:[0,1] neg_hi:[0,1]
    v_cvt_pk_bf16_f32 v50, v48, v49
    v_lshlrev_b32 v48, 16, v50
    v_and_b32 v49, 0xffff0000, v50
    v_pk_mul_f32 v[48:49], v[48:49], v[44:45]
    v_cvt_pk_bf16_f32 v54, v48, v49
    v_pk_add_f32 v[48:49], v[246:247], v[38:39] neg_lo:[0,1] neg_hi:[0,1]
    v_cvt_pk_bf16_f32 v50, v48, v49
    v_lshlrev_b32 v48, 16, v50
    v_and_b32 v49, 0xffff0000, v50
    v_pk_mul_f32 v[48:49], v[48:49], v[46:47]
    v_cvt_pk_bf16_f32 v55, v48, v49
    ds_write_b128 v15, v[52:55] offset:36864
    s_nop 0
    v_pk_add_f32 v[48:49], v[248:249], v[32:33] neg_lo:[0,1] neg_hi:[0,1]
    v_cvt_pk_bf16_f32 v50, v48, v49
    v_lshlrev_b32 v48, 16, v50
    v_and_b32 v49, 0xffff0000, v50
    v_pk_mul_f32 v[48:49], v[48:49], v[40:41]
    v_cvt_pk_bf16_f32 v52, v48, v49
    v_pk_add_f32 v[48:49], v[250:251], v[34:35] neg_lo:[0,1] neg_hi:[0,1]
    v_cvt_pk_bf16_f32 v50, v48, v49
    v_lshlrev_b32 v48, 16, v50
    v_and_b32 v49, 0xffff0000, v50
    v_pk_mul_f32 v[48:49], v[48:49], v[42:43]
    v_cvt_pk_bf16_f32 v53, v48, v49
    v_pk_add_f32 v[48:49], v[252:253], v[36:37] neg_lo:[0,1] neg_hi:[0,1]
    v_cvt_pk_bf16_f32 v50, v48, v49
    v_lshlrev_b32 v48, 16, v50
    v_and_b32 v49, 0xffff0000, v50
    v_pk_mul_f32 v[48:49], v[48:49], v[44:45]
    v_cvt_pk_bf16_f32 v54, v48, v49
    v_pk_add_f32 v[48:49], v[254:255], v[38:39] neg_lo:[0,1] neg_hi:[0,1]
    v_cvt_pk_bf16_f32 v50, v48, v49
    v_lshlrev_b32 v48, 16, v50
    v_and_b32 v49, 0xffff0000, v50
    v_pk_mul_f32 v[48:49], v[48:49], v[46:47]
    v_cvt_pk_bf16_f32 v55, v48, v49
    ds_write_b128 v15, v[52:55] offset:43008
    v_mov_b32 v128, 0
    v_mov_b32 v129, 0
    v_mov_b32 v130, 0
    v_mov_b32 v131, 0
    v_mov_b32 v132, 0
    v_mov_b32 v133, 0
    v_mov_b32 v134, 0
    v_mov_b32 v135, 0
    v_mov_b32 v136, 0
    v_mov_b32 v137, 0
    v_mov_b32 v138, 0
    v_mov_b32 v139, 0
    v_mov_b32 v140, 0
    v_mov_b32 v141, 0
    v_mov_b32 v142, 0
    v_mov_b32 v143, 0
    v_mov_b32 v144, 0
    v_mov_b32 v145, 0
    v_mov_b32 v146, 0
    v_mov_b32 v147, 0
    v_mov_b32 v148, 0
    v_mov_b32 v149, 0
    v_mov_b32 v150, 0
    v_mov_b32 v151, 0
    v_mov_b32 v152, 0
    v_mov_b32 v153, 0
    v_mov_b32 v154, 0
    v_mov_b32 v155, 0
    v_mov_b32 v156, 0
    v_mov_b32 v157, 0
    v_mov_b32 v158, 0
    v_mov_b32 v159, 0
    v_mov_b32 v160, 0
    v_mov_b32 v161, 0
    v_mov_b32 v162, 0
    v_mov_b32 v163, 0
    v_mov_b32 v164, 0
    v_mov_b32 v165, 0
    v_mov_b32 v166, 0
    v_mov_b32 v167, 0
    v_mov_b32 v168, 0
    v_mov_b32 v169, 0
    v_mov_b32 v170, 0
    v_mov_b32 v171, 0
    v_mov_b32 v172, 0
    v_mov_b32 v173, 0
    v_mov_b32 v174, 0
    v_mov_b32 v175, 0
    v_mov_b32 v176, 0
    v_mov_b32 v177, 0
    v_mov_b32 v178, 0
    v_mov_b32 v179, 0
    v_mov_b32 v180, 0
    v_mov_b32 v181, 0
    v_mov_b32 v182, 0
    v_mov_b32 v183, 0
    v_mov_b32 v184, 0
    v_mov_b32 v185, 0
    v_mov_b32 v186, 0
    v_mov_b32 v187, 0
    v_mov_b32 v188, 0
    v_mov_b32 v189, 0
    v_mov_b32 v190, 0
    v_mov_b32 v191, 0
    v_mov_b32 v192, 0
    v_mov_b32 v193, 0
    v_mov_b32 v194, 0
    v_mov_b32 v195, 0
    v_mov_b32 v196, 0
    v_mov_b32 v197, 0
    v_mov_b32 v198, 0
    v_mov_b32 v199, 0
    v_mov_b32 v200, 0
    v_mov_b32 v201, 0
    v_mov_b32 v202, 0
    v_mov_b32 v203, 0
    v_mov_b32 v204, 0
    v_mov_b32 v205, 0
    v_mov_b32 v206, 0
    v_mov_b32 v207, 0
    v_mov_b32 v208, 0
    v_mov_b32 v209, 0
    v_mov_b32 v210, 0
    v_mov_b32 v211, 0
    v_mov_b32 v212, 0
    v_mov_b32 v213, 0
    v_mov_b32 v214, 0
    v_mov_b32 v215, 0
    v_mov_b32 v216, 0
    v_mov_b32 v217, 0
    v_mov_b32 v218, 0
    v_mov_b32 v219, 0
    v_mov_b32 v220, 0
    v_mov_b32 v221, 0
    v_mov_b32 v222, 0
    v_mov_b32 v223, 0
    v_mov_b32 v224, 0
    v_mov_b32 v225, 0
    v_mov_b32 v226, 0
    v_mov_b32 v227, 0
    v_mov_b32 v228, 0
    v_mov_b32 v229, 0
    v_mov_b32 v230, 0
    v_mov_b32 v231, 0
    v_mov_b32 v232, 0
    v_mov_b32 v233, 0
    v_mov_b32 v234, 0
    v_mov_b32 v235, 0
    v_mov_b32 v236, 0
    v_mov_b32 v237, 0
    v_mov_b32 v238, 0
    v_mov_b32 v239, 0
    v_mov_b32 v240, 0
    v_mov_b32 v241, 0
    v_mov_b32 v242, 0
    v_mov_b32 v243, 0
    v_mov_b32 v244, 0
    v_mov_b32 v245, 0
    v_mov_b32 v246, 0
    v_mov_b32 v247, 0
    v_mov_b32 v248, 0
    v_mov_b32 v249, 0
    v_mov_b32 v250, 0
    v_mov_b32 v251, 0
    v_mov_b32 v252, 0
    v_mov_b32 v253, 0
    v_mov_b32 v254, 0
    v_mov_b32 v255, 0
    v_lshrrev_b32 v11, 5, v4
    v_lshlrev_b32 v11, 3, v11
    v_bfe_u32 v12, v4, 2, 2
    v_add_u32 v11, v11, v12
    v_mul_u32_u24 v11, 192, v11
    v_bfe_u32 v12, v4, 4, 1
    v_lshl_add_u32 v11, v12, 5, v11
    v_and_b32 v12, 3, v4
    v_lshl_add_u32 v11, v12, 3, v11
    v_add_u32 v11, 9216, v11
    v_add_u32 v12, 49152, v11
    s_waitcnt lgkmcnt(0)
    s_barrier
    v_and_b32 v13, 31, v4
    v_lshlrev_b32 v13, 4, v13
    v_lshrrev_b32 v14, 5, v4
    v_lshl_add_u32 v13, v14, 3, v13
    s_mul_i32 s3, s21, 224
    s_lshl_b32 s4, s22, 4
    s_add_u32 s3, s3, s4
    v_lshlrev_b32 v14, 2, v5
    v_add_u32 v14, s3, v14
    v_lshl_add_u32 v13, v14, 10, v13
    v_add_u32 v13, 0x800000, v13
    v_mov_b32 v16, 0xc0135761
    s_mov_b32 s44, 0xbdd2d3e8
    s_mov_b32 s45, 0
    s_mov_b32 s46, 114688
    ds_read_b64_tr_b16 v[48:49], v11 offset:0
    ds_read_b64_tr_b16 v[50:51], v11 offset:768
    ds_read_b64_tr_b16 v[52:53], v11 offset:64
    ds_read_b64_tr_b16 v[54:55], v11 offset:832
    ds_read_b64_tr_b16 v[56:57], v11 offset:3072
    ds_read_b64_tr_b16 v[58:59], v11 offset:3840
    ds_read_b64_tr_b16 v[60:61], v11 offset:3136
    ds_read_b64_tr_b16 v[62:63], v11 offset:3904
    s_waitcnt vmcnt(14) lgkmcnt(4)
    v_mfma_f32_32x32x16_bf16 v[128:143], v[64:67], v[48:51], v[128:143]
    v_mfma_f32_32x32x16_bf16 v[144:159], v[64:67], v[52:55], v[144:159]
    v_mfma_f32_32x32x16_bf16 v[192:207], v[68:71], v[48:51], v[192:207]
    v_mfma_f32_32x32x16_bf16 v[208:223], v[68:71], v[52:55], v[208:223]
    buffer_load_dwordx4 v[64:67], v6, s[28:31], s48 offen
    buffer_load_dwordx4 v[68:71], v6, s[28:31], s50 offen
    s_add_u32 s48, s48, 1024
    s_add_u32 s50, s50, 1024
    ds_read_b64_tr_b16 v[48:49], v11 offset:6144
    ds_read_b64_tr_b16 v[50:51], v11 offset:6912
    ds_read_b64_tr_b16 v[52:53], v11 offset:6208
    ds_read_b64_tr_b16 v[54:55], v11 offset:6976
    s_waitcnt vmcnt(14) lgkmcnt(4)
    v_mfma_f32_32x32x16_bf16 v[128:143], v[72:75], v[56:59], v[128:143]
    v_mfma_f32_32x32x16_bf16 v[144:159], v[72:75], v[60:63], v[144:159]
    v_mfma_f32_32x32x16_bf16 v[192:207], v[76:79], v[56:59], v[192:207]
    v_mfma_f32_32x32x16_bf16 v[208:223], v[76:79], v[60:63], v[208:223]
    buffer_load_dwordx4 v[72:75], v6, s[28:31], s48 offen
    buffer_load_dwordx4 v[76:79], v6, s[28:31], s50 offen
    s_add_u32 s48, s48, 1024
    s_add_u32 s50, s50, 1024
    ds_read_b64_tr_b16 v[56:57], v11 offset:9216
    ds_read_b64_tr_b16 v[58:59], v11 offset:9984
    ds_read_b64_tr_b16 v[60:61], v11 offset:9280
    ds_read_b64_tr_b16 v[62:63], v11 offset:10048
    s_waitcnt vmcnt(14) lgkmcnt(4)
    v_mfma_f32_32x32x16_bf16 v[128:143], v[80:83], v[48:51], v[128:143]
    v_mfma_f32_32x32x16_bf16 v[144:159], v[80:83], v[52:55], v[144:159]
    v_mfma_f32_32x32x16_bf16 v[192:207], v[84:87], v[48:51], v[192:207]
    v_mfma_f32_32x32x16_bf16 v[208:223], v[84:87], v[52:55], v[208:223]
    buffer_load_dwordx4 v[80:83], v6, s[28:31], s48 offen
    buffer_load_dwordx4 v[84:87], v6, s[28:31], s50 offen
    s_add_u32 s48, s48, 1024
    s_add_u32 s50, s50, 1024
    ds_read_b64_tr_b16 v[48:49], v11 offset:12288
    ds_read_b64_tr_b16 v[50:51], v11 offset:13056
    ds_read_b64_tr_b16 v[52:53], v11 offset:12352
    ds_read_b64_tr_b16 v[54:55], v11 offset:13120
    s_waitcnt vmcnt(14) lgkmcnt(4)
    v_mfma_f32_32x32x16_bf16 v[128:143], v[88:91], v[56:59], v[128:143]
    v_mfma_f32_32x32x16_bf16 v[144:159], v[88:91], v[60:63], v[144:159]
    v_mfma_f32_32x32x16_bf16 v[192:207], v[92:95], v[56:59], v[192:207]
    v_mfma_f32_32x32x16_bf16 v[208:223], v[92:95], v[60:63], v[208:223]
    buffer_load_dwordx4 v[88:91], v6, s[28:31], s48 offen
    buffer_load_dwordx4 v[92:95], v6, s[28:31], s50 offen
    s_add_u32 s48, s48, 1024
    s_add_u32 s50, s50, 1024
    ds_read_b64_tr_b16 v[56:57], v11 offset:15360
    ds_read_b64_tr_b16 v[58:59], v11 offset:16128
    ds_read_b64_tr_b16 v[60:61], v11 offset:15424
    ds_read_b64_tr_b16 v[62:63], v11 offset:16192
    s_waitcnt vmcnt(14) lgkmcnt(4)
    v_mfma_f32_32x32x16_bf16 v[128:143], v[96:99], v[48:51], v[128:143]
    v_mfma_f32_32x32x16_bf16 v[144:159], v[96:99], v[52:55], v[144:159]
    v_mfma_f32_32x32x16_bf16 v[192:207], v[100:103], v[48:51], v[192:207]
    v_mfma_f32_32x32x16_bf16 v[208:223], v[100:103], v[52:55], v[208:223]
    buffer_load_dwordx4 v[96:99], v6, s[28:31], s48 offen
    buffer_load_dwordx4 v[100:103], v6, s[28:31], s50 offen
    s_add_u32 s48, s48, 1024
    s_add_u32 s50, s50, 1024
    ds_read_b64_tr_b16 v[48:49], v11 offset:18432
    ds_read_b64_tr_b16 v[50:51], v11 offset:19200
    ds_read_b64_tr_b16 v[52:53], v11 offset:18496
    ds_read_b64_tr_b16 v[54:55], v11 offset:19264
    s_waitcnt vmcnt(14) lgkmcnt(4)
    v_mfma_f32_32x32x16_bf16 v[128:143], v[104:107], v[56:59], v[128:143]
    v_mfma_f32_32x32x16_bf16 v[144:159], v[104:107], v[60:63], v[144:159]
    v_mfma_f32_32x32x16_bf16 v[192:207], v[108:111], v[56:59], v[192:207]
    v_mfma_f32_32x32x16_bf16 v[208:223], v[108:111], v[60:63], v[208:223]
    buffer_load_dwordx4 v[104:107], v6, s[28:31], s48 offen
    buffer_load_dwordx4 v[108:111], v6, s[28:31], s50 offen
    s_add_u32 s48, s48, 1024
    s_add_u32 s50, s50, 1024
    ds_read_b64_tr_b16 v[56:57], v11 offset:21504
    ds_read_b64_tr_b16 v[58:59], v11 offset:22272
    ds_read_b64_tr_b16 v[60:61], v11 offset:21568
    ds_read_b64_tr_b16 v[62:63], v11 offset:22336
    s_waitcnt vmcnt(14) lgkmcnt(4)
    v_mfma_f32_32x32x16_bf16 v[128:143], v[112:115], v[48:51], v[128:143]
    v_mfma_f32_32x32x16_bf16 v[144:159], v[112:115], v[52:55], v[144:159]
    v_mfma_f32_32x32x16_bf16 v[192:207], v[116:119], v[48:51], v[192:207]
    v_mfma_f32_32x32x16_bf16 v[208:223], v[116:119], v[52:55], v[208:223]
    buffer_load_dwordx4 v[112:115], v6, s[28:31], s48 offen
    buffer_load_dwordx4 v[116:119], v6, s[28:31], s50 offen
    s_add_u32 s48, s48, 1024
    s_add_u32 s50, s50, 1024
    ds_read_b64_tr_b16 v[48:49], v11 offset:24576
    ds_read_b64_tr_b16 v[50:51], v11 offset:25344
    ds_read_b64_tr_b16 v[52:53], v11 offset:24640
    ds_read_b64_tr_b16 v[54:55], v11 offset:25408
    s_waitcnt vmcnt(14) lgkmcnt(4)
    v_mfma_f32_32x32x16_bf16 v[128:143], v[120:123], v[56:59], v[128:143]
    v_mfma_f32_32x32x16_bf16 v[144:159], v[120:123], v[60:63], v[144:159]
    v_mfma_f32_32x32x16_bf16 v[192:207], v[124:127], v[56:59], v[192:207]
    v_mfma_f32_32x32x16_bf16 v[208:223], v[124:127], v[60:63], v[208:223]
    buffer_load_dwordx4 v[120:123], v6, s[28:31], s48 offen
    buffer_load_dwordx4 v[124:127], v6, s[28:31], s50 offen
    s_add_u32 s48, s48, 1024
    s_add_u32 s50, s50, 1024
    ds_read_b64_tr_b16 v[56:57], v11 offset:27648
    ds_read_b64_tr_b16 v[58:59], v11 offset:28416
    ds_read_b64_tr_b16 v[60:61], v11 offset:27712
    ds_read_b64_tr_b16 v[62:63], v11 offset:28480
    s_waitcnt vmcnt(14) lgkmcnt(4)
    v_mfma_f32_32x32x16_bf16 v[128:143], v[64:67], v[48:51], v[128:143]
    v_mfma_f32_32x32x16_bf16 v[144:159], v[64:67], v[52:55], v[144:159]
    v_mfma_f32_32x32x16_bf16 v[192:207], v[68:71], v[48:51], v[192:207]
    v_mfma_f32_32x32x16_bf16 v[208:223], v[68:71], v[52:55], v[208:223]
    buffer_load_dwordx4 v[64:67], v6, s[28:31], s48 offen
    buffer_load_dwordx4 v[68:71], v6, s[28:31], s50 offen
    s_add_u32 s48, s48, 1024
    s_add_u32 s50, s50, 1024
    ds_read_b64_tr_b16 v[48:49], v11 offset:30720
    ds_read_b64_tr_b16 v[50:51], v11 offset:31488
    ds_read_b64_tr_b16 v[52:53], v11 offset:30784
    ds_read_b64_tr_b16 v[54:55], v11 offset:31552
    s_waitcnt vmcnt(14) lgkmcnt(4)
    v_mfma_f32_32x32x16_bf16 v[128:143], v[72:75], v[56:59], v[128:143]
    v_mfma_f32_32x32x16_bf16 v[144:159], v[72:75], v[60:63], v[144:159]
    v_mfma_f32_32x32x16_bf16 v[192:207], v[76:79], v[56:59], v[192:207]
    v_mfma_f32_32x32x16_bf16 v[208:223], v[76:79], v[60:63], v[208:223]
    buffer_load_dwordx4 v[72:75], v6, s[28:31], s48 offen
    buffer_load_dwordx4 v[76:79], v6, s[28:31], s50 offen
    s_add_u32 s48, s48, 1024
    s_add_u32 s50, s50, 1024
    ds_read_b64_tr_b16 v[56:57], v11 offset:33792
    ds_read_b64_tr_b16 v[58:59], v11 offset:34560
    ds_read_b64_tr_b16 v[60:61], v11 offset:33856
    ds_read_b64_tr_b16 v[62:63], v11 offset:34624
    s_waitcnt vmcnt(14) lgkmcnt(4)
    v_mfma_f32_32x32x16_bf16 v[128:143], v[80:83], v[48:51], v[128:143]
    v_mfma_f32_32x32x16_bf16 v[144:159], v[80:83], v[52:55], v[144:159]
    v_mfma_f32_32x32x16_bf16 v[192:207], v[84:87], v[48:51], v[192:207]
    v_mfma_f32_32x32x16_bf16 v[208:223], v[84:87], v[52:55], v[208:223]
    buffer_load_dwordx4 v[80:83], v6, s[28:31], s48 offen
    buffer_load_dwordx4 v[84:87], v6, s[28:31], s50 offen
    s_add_u32 s48, s48, 1024
    s_add_u32 s50, s50, 1024
    ds_read_b64_tr_b16 v[48:49], v11 offset:36864
    ds_read_b64_tr_b16 v[50:51], v11 offset:37632
    ds_read_b64_tr_b16 v[52:53], v11 offset:36928
    ds_read_b64_tr_b16 v[54:55], v11 offset:37696
    s_waitcnt vmcnt(14) lgkmcnt(4)
    v_mfma_f32_32x32x16_bf16 v[128:143], v[88:91], v[56:59], v[128:143]
    v_mfma_f32_32x32x16_bf16 v[144:159], v[88:91], v[60:63], v[144:159]
    v_mfma_f32_32x32x16_bf16 v[192:207], v[92:95], v[56:59], v[192:207]
    v_mfma_f32_32x32x16_bf16 v[208:223], v[92:95], v[60:63], v[208:223]
    buffer_load_dwordx4 v[88:91], v6, s[28:31], s48 offen
    buffer_load_dwordx4 v[92:95], v6, s[28:31], s50 offen
    s_add_u32 s48, s48, 1024
    s_add_u32 s50, s50, 1024
    ds_read_b64_tr_b16 v[56:57], v11 offset:39936
    ds_read_b64_tr_b16 v[58:59], v11 offset:40704
    ds_read_b64_tr_b16 v[60:61], v11 offset:40000
    ds_read_b64_tr_b16 v[62:63], v11 offset:40768
    s_waitcnt vmcnt(14) lgkmcnt(4)
    v_mfma_f32_32x32x16_bf16 v[128:143], v[96:99], v[48:51], v[128:143]
    v_mfma_f32_32x32x16_bf16 v[144:159], v[96:99], v[52:55], v[144:159]
    v_mfma_f32_32x32x16_bf16 v[192:207], v[100:103], v[48:51], v[192:207]
    v_mfma_f32_32x32x16_bf16 v[208:223], v[100:103], v[52:55], v[208:223]
    buffer_load_dwordx4 v[96:99], v6, s[28:31], s48 offen
    buffer_load_dwordx4 v[100:103], v6, s[28:31], s50 offen
    s_add_u32 s48, s48, 1024
    s_add_u32 s50, s50, 1024
    ds_read_b64_tr_b16 v[48:49], v11 offset:43008
    ds_read_b64_tr_b16 v[50:51], v11 offset:43776
    ds_read_b64_tr_b16 v[52:53], v11 offset:43072
    ds_read_b64_tr_b16 v[54:55], v11 offset:43840
    s_waitcnt vmcnt(14) lgkmcnt(4)
    v_mfma_f32_32x32x16_bf16 v[128:143], v[104:107], v[56:59], v[128:143]
    v_mfma_f32_32x32x16_bf16 v[144:159], v[104:107], v[60:63], v[144:159]
    v_mfma_f32_32x32x16_bf16 v[192:207], v[108:111], v[56:59], v[192:207]
    v_mfma_f32_32x32x16_bf16 v[208:223], v[108:111], v[60:63], v[208:223]
    buffer_load_dwordx4 v[104:107], v6, s[28:31], s48 offen
    buffer_load_dwordx4 v[108:111], v6, s[28:31], s50 offen
    s_add_u32 s48, s48, 1024
    s_add_u32 s50, s50, 1024
    ds_read_b64_tr_b16 v[56:57], v11 offset:46080
    ds_read_b64_tr_b16 v[58:59], v11 offset:46848
    ds_read_b64_tr_b16 v[60:61], v11 offset:46144
    ds_read_b64_tr_b16 v[62:63], v11 offset:46912
    s_waitcnt vmcnt(14) lgkmcnt(4)
    v_mfma_f32_32x32x16_bf16 v[128:143], v[112:115], v[48:51], v[128:143]
    v_mfma_f32_32x32x16_bf16 v[144:159], v[112:115], v[52:55], v[144:159]
    v_mfma_f32_32x32x16_bf16 v[192:207], v[116:119], v[48:51], v[192:207]
    v_mfma_f32_32x32x16_bf16 v[208:223], v[116:119], v[52:55], v[208:223]
    buffer_load_dwordx4 v[112:115], v6, s[28:31], s48 offen
    buffer_load_dwordx4 v[116:119], v6, s[28:31], s50 offen
    s_add_u32 s48, s48, 1024
    s_add_u32 s50, s50, 1024
    ds_read_b64_tr_b16 v[48:49], v12 offset:0
    ds_read_b64_tr_b16 v[50:51], v12 offset:768
    ds_read_b64_tr_b16 v[52:53], v12 offset:64
    ds_read_b64_tr_b16 v[54:55], v12 offset:832
    s_waitcnt vmcnt(14) lgkmcnt(4)
    v_mfma_f32_32x32x16_bf16 v[128:143], v[120:123], v[56:59], v[128:143]
    v_mfma_f32_32x32x16_bf16 v[144:159], v[120:123], v[60:63], v[144:159]
    v_mfma_f32_32x32x16_bf16 v[192:207], v[124:127], v[56:59], v[192:207]
    v_mfma_f32_32x32x16_bf16 v[208:223], v[124:127], v[60:63], v[208:223]
    buffer_load_dwordx4 v[120:123], v6, s[28:31], s48 offen
    buffer_load_dwordx4 v[124:127], v6, s[28:31], s50 offen
    s_add_u32 s48, s48, 1024
    s_add_u32 s50, s50, 1024
    ds_read_b64_tr_b16 v[56:57], v12 offset:3072
    ds_read_b64_tr_b16 v[58:59], v12 offset:3840
    ds_read_b64_tr_b16 v[60:61], v12 offset:3136
    ds_read_b64_tr_b16 v[62:63], v12 offset:3904
    s_waitcnt vmcnt(14) lgkmcnt(4)
    v_mfma_f32_32x32x16_bf16 v[128:143], v[64:67], v[48:51], v[128:143]
    v_mfma_f32_32x32x16_bf16 v[144:159], v[64:67], v[52:55], v[144:159]
    v_mfma_f32_32x32x16_bf16 v[192:207], v[68:71], v[48:51], v[192:207]
    v_mfma_f32_32x32x16_bf16 v[208:223], v[68:71], v[52:55], v[208:223]
    buffer_load_dwordx4 v[64:67], v6, s[28:31], s48 offen
    buffer_load_dwordx4 v[68:71], v6, s[28:31], s50 offen
    s_add_u32 s48, s48, 1024
    s_add_u32 s50, s50, 1024
    ds_read_b64_tr_b16 v[48:49], v12 offset:6144
    ds_read_b64_tr_b16 v[50:51], v12 offset:6912
    ds_read_b64_tr_b16 v[52:53], v12 offset:6208
    ds_read_b64_tr_b16 v[54:55], v12 offset:6976
    s_waitcnt vmcnt(14) lgkmcnt(4)
    v_mfma_f32_32x32x16_bf16 v[128:143], v[72:75], v[56:59], v[128:143]
    v_mfma_f32_32x32x16_bf16 v[144:159], v[72:75], v[60:63], v[144:159]
    v_mfma_f32_32x32x16_bf16 v[192:207], v[76:79], v[56:59], v[192:207]
    v_mfma_f32_32x32x16_bf16 v[208:223], v[76:79], v[60:63], v[208:223]
    buffer_load_dwordx4 v[72:75], v6, s[28:31], s48 offen
    buffer_load_dwordx4 v[76:79], v6, s[28:31], s50 offen
    s_add_u32 s48, s48, 1024
    s_add_u32 s50, s50, 1024
    ds_read_b64_tr_b16 v[56:57], v12 offset:9216
    ds_read_b64_tr_b16 v[58:59], v12 offset:9984
    ds_read_b64_tr_b16 v[60:61], v12 offset:9280
    ds_read_b64_tr_b16 v[62:63], v12 offset:10048
    s_waitcnt vmcnt(14) lgkmcnt(4)
    v_mfma_f32_32x32x16_bf16 v[128:143], v[80:83], v[48:51], v[128:143]
    v_mfma_f32_32x32x16_bf16 v[144:159], v[80:83], v[52:55], v[144:159]
    v_mfma_f32_32x32x16_bf16 v[192:207], v[84:87], v[48:51], v[192:207]
    v_mfma_f32_32x32x16_bf16 v[208:223], v[84:87], v[52:55], v[208:223]
    buffer_load_dwordx4 v[80:83], v6, s[28:31], s48 offen
    buffer_load_dwordx4 v[84:87], v6, s[28:31], s50 offen
    s_add_u32 s48, s48, 1024
    s_add_u32 s50, s50, 1024
    ds_read_b64_tr_b16 v[48:49], v12 offset:12288
    ds_read_b64_tr_b16 v[50:51], v12 offset:13056
    ds_read_b64_tr_b16 v[52:53], v12 offset:12352
    ds_read_b64_tr_b16 v[54:55], v12 offset:13120
    s_waitcnt vmcnt(14) lgkmcnt(4)
    v_mfma_f32_32x32x16_bf16 v[128:143], v[88:91], v[56:59], v[128:143]
    v_mfma_f32_32x32x16_bf16 v[144:159], v[88:91], v[60:63], v[144:159]
    v_mfma_f32_32x32x16_bf16 v[192:207], v[92:95], v[56:59], v[192:207]
    v_mfma_f32_32x32x16_bf16 v[208:223], v[92:95], v[60:63], v[208:223]
    buffer_load_dwordx4 v[88:91], v6, s[28:31], s48 offen
    buffer_load_dwordx4 v[92:95], v6, s[28:31], s50 offen
    s_add_u32 s48, s48, 1024
    s_add_u32 s50, s50, 1024
    ds_read_b64_tr_b16 v[56:57], v12 offset:15360
    ds_read_b64_tr_b16 v[58:59], v12 offset:16128
    ds_read_b64_tr_b16 v[60:61], v12 offset:15424
    ds_read_b64_tr_b16 v[62:63], v12 offset:16192
    s_waitcnt vmcnt(14) lgkmcnt(4)
    v_mfma_f32_32x32x16_bf16 v[128:143], v[96:99], v[48:51], v[128:143]
    v_mfma_f32_32x32x16_bf16 v[144:159], v[96:99], v[52:55], v[144:159]
    v_mfma_f32_32x32x16_bf16 v[192:207], v[100:103], v[48:51], v[192:207]
    v_mfma_f32_32x32x16_bf16 v[208:223], v[100:103], v[52:55], v[208:223]
    buffer_load_dwordx4 v[96:99], v6, s[28:31], s48 offen
    buffer_load_dwordx4 v[100:103], v6, s[28:31], s50 offen
    s_add_u32 s48, s48, 1024
    s_add_u32 s50, s50, 1024
    ds_read_b64_tr_b16 v[48:49], v12 offset:18432
    ds_read_b64_tr_b16 v[50:51], v12 offset:19200
    ds_read_b64_tr_b16 v[52:53], v12 offset:18496
    ds_read_b64_tr_b16 v[54:55], v12 offset:19264
    s_waitcnt vmcnt(14) lgkmcnt(4)
    v_mfma_f32_32x32x16_bf16 v[128:143], v[104:107], v[56:59], v[128:143]
    v_mfma_f32_32x32x16_bf16 v[144:159], v[104:107], v[60:63], v[144:159]
    v_mfma_f32_32x32x16_bf16 v[192:207], v[108:111], v[56:59], v[192:207]
    v_mfma_f32_32x32x16_bf16 v[208:223], v[108:111], v[60:63], v[208:223]
    buffer_load_dwordx4 v[104:107], v6, s[28:31], s48 offen
    buffer_load_dwordx4 v[108:111], v6, s[28:31], s50 offen
    s_add_u32 s48, s48, 1024
    s_add_u32 s50, s50, 1024
    ds_read_b64_tr_b16 v[56:57], v12 offset:21504
    ds_read_b64_tr_b16 v[58:59], v12 offset:22272
    ds_read_b64_tr_b16 v[60:61], v12 offset:21568
    ds_read_b64_tr_b16 v[62:63], v12 offset:22336
    s_waitcnt vmcnt(14) lgkmcnt(4)
    v_mfma_f32_32x32x16_bf16 v[128:143], v[112:115], v[48:51], v[128:143]
    v_mfma_f32_32x32x16_bf16 v[144:159], v[112:115], v[52:55], v[144:159]
    v_mfma_f32_32x32x16_bf16 v[192:207], v[116:119], v[48:51], v[192:207]
    v_mfma_f32_32x32x16_bf16 v[208:223], v[116:119], v[52:55], v[208:223]
    buffer_load_dwordx4 v[112:115], v6, s[28:31], s48 offen
    buffer_load_dwordx4 v[116:119], v6, s[28:31], s50 offen
    s_add_u32 s48, s48, 1024
    s_add_u32 s50, s50, 1024
    ds_read_b64_tr_b16 v[48:49], v12 offset:24576
    ds_read_b64_tr_b16 v[50:51], v12 offset:25344
    ds_read_b64_tr_b16 v[52:53], v12 offset:24640
    ds_read_b64_tr_b16 v[54:55], v12 offset:25408
    s_waitcnt vmcnt(14) lgkmcnt(4)
    v_mfma_f32_32x32x16_bf16 v[128:143], v[120:123], v[56:59], v[128:143]
    v_mfma_f32_32x32x16_bf16 v[144:159], v[120:123], v[60:63], v[144:159]
    v_mfma_f32_32x32x16_bf16 v[192:207], v[124:127], v[56:59], v[192:207]
    v_mfma_f32_32x32x16_bf16 v[208:223], v[124:127], v[60:63], v[208:223]
    buffer_load_dwordx4 v[120:123], v6, s[28:31], s48 offen
    buffer_load_dwordx4 v[124:127], v6, s[28:31], s50 offen
    s_add_u32 s48, s48, 1024
    s_add_u32 s50, s50, 1024
    ds_read_b64_tr_b16 v[56:57], v12 offset:27648
    ds_read_b64_tr_b16 v[58:59], v12 offset:28416
    ds_read_b64_tr_b16 v[60:61], v12 offset:27712
    ds_read_b64_tr_b16 v[62:63], v12 offset:28480
    s_waitcnt vmcnt(14) lgkmcnt(4)
    v_mfma_f32_32x32x16_bf16 v[128:143], v[64:67], v[48:51], v[128:143]
    v_mfma_f32_32x32x16_bf16 v[144:159], v[64:67], v[52:55], v[144:159]
    v_mfma_f32_32x32x16_bf16 v[192:207], v[68:71], v[48:51], v[192:207]
    v_mfma_f32_32x32x16_bf16 v[208:223], v[68:71], v[52:55], v[208:223]
    buffer_load_dwordx4 v[64:67], v6, s[28:31], s49 offen
    buffer_load_dwordx4 v[68:71], v6, s[28:31], s51 offen
    s_add_u32 s49, s49, 1024
    s_add_u32 s51, s51, 1024
    ds_read_b64_tr_b16 v[48:49], v12 offset:30720
    ds_read_b64_tr_b16 v[50:51], v12 offset:31488
    ds_read_b64_tr_b16 v[52:53], v12 offset:30784
    ds_read_b64_tr_b16 v[54:55], v12 offset:31552
    s_waitcnt vmcnt(14) lgkmcnt(4)
    v_mfma_f32_32x32x16_bf16 v[128:143], v[72:75], v[56:59], v[128:143]
    v_mfma_f32_32x32x16_bf16 v[144:159], v[72:75], v[60:63], v[144:159]
    v_mfma_f32_32x32x16_bf16 v[192:207], v[76:79], v[56:59], v[192:207]
    v_mfma_f32_32x32x16_bf16 v[208:223], v[76:79], v[60:63], v[208:223]
    buffer_load_dwordx4 v[72:75], v6, s[28:31], s49 offen
    buffer_load_dwordx4 v[76:79], v6, s[28:31], s51 offen
    s_add_u32 s49, s49, 1024
    s_add_u32 s51, s51, 1024
    ds_read_b64_tr_b16 v[56:57], v12 offset:33792
    ds_read_b64_tr_b16 v[58:59], v12 offset:34560
    ds_read_b64_tr_b16 v[60:61], v12 offset:33856
    ds_read_b64_tr_b16 v[62:63], v12 offset:34624
    s_waitcnt vmcnt(14) lgkmcnt(4)
    v_mfma_f32_32x32x16_bf16 v[128:143], v[80:83], v[48:51], v[128:143]
    v_mfma_f32_32x32x16_bf16 v[144:159], v[80:83], v[52:55], v[144:159]
    v_mfma_f32_32x32x16_bf16 v[192:207], v[84:87], v[48:51], v[192:207]
    v_mfma_f32_32x32x16_bf16 v[208:223], v[84:87], v[52:55], v[208:223]
    buffer_load_dwordx4 v[80:83], v6, s[28:31], s49 offen
    buffer_load_dwordx4 v[84:87], v6, s[28:31], s51 offen
    s_add_u32 s49, s49, 1024
    s_add_u32 s51, s51, 1024
    ds_read_b64_tr_b16 v[48:49], v12 offset:36864
    ds_read_b64_tr_b16 v[50:51], v12 offset:37632
    ds_read_b64_tr_b16 v[52:53], v12 offset:36928
    ds_read_b64_tr_b16 v[54:55], v12 offset:37696
    s_waitcnt vmcnt(14) lgkmcnt(4)
    v_mfma_f32_32x32x16_bf16 v[128:143], v[88:91], v[56:59], v[128:143]
    v_mfma_f32_32x32x16_bf16 v[144:159], v[88:91], v[60:63], v[144:159]
    v_mfma_f32_32x32x16_bf16 v[192:207], v[92:95], v[56:59], v[192:207]
    v_mfma_f32_32x32x16_bf16 v[208:223], v[92:95], v[60:63], v[208:223]
    buffer_load_dwordx4 v[88:91], v6, s[28:31], s49 offen
    buffer_load_dwordx4 v[92:95], v6, s[28:31], s51 offen
    s_add_u32 s49, s49, 1024
    s_add_u32 s51, s51, 1024
    ds_read_b64_tr_b16 v[56:57], v12 offset:39936
    ds_read_b64_tr_b16 v[58:59], v12 offset:40704
    ds_read_b64_tr_b16 v[60:61], v12 offset:40000
    ds_read_b64_tr_b16 v[62:63], v12 offset:40768
    s_waitcnt vmcnt(14) lgkmcnt(4)
    v_mfma_f32_32x32x16_bf16 v[128:143], v[96:99], v[48:51], v[128:143]
    v_mfma_f32_32x32x16_bf16 v[144:159], v[96:99], v[52:55], v[144:159]
    v_mfma_f32_32x32x16_bf16 v[192:207], v[100:103], v[48:51], v[192:207]
    v_mfma_f32_32x32x16_bf16 v[208:223], v[100:103], v[52:55], v[208:223]
    buffer_load_dwordx4 v[96:99], v6, s[28:31], s49 offen
    buffer_load_dwordx4 v[100:103], v6, s[28:31], s51 offen
    s_add_u32 s49, s49, 1024
    s_add_u32 s51, s51, 1024
    ds_read_b64_tr_b16 v[48:49], v12 offset:43008
    ds_read_b64_tr_b16 v[50:51], v12 offset:43776
    ds_read_b64_tr_b16 v[52:53], v12 offset:43072
    ds_read_b64_tr_b16 v[54:55], v12 offset:43840
    s_waitcnt vmcnt(14) lgkmcnt(4)
    v_mfma_f32_32x32x16_bf16 v[128:143], v[104:107], v[56:59], v[128:143]
    v_mfma_f32_32x32x16_bf16 v[144:159], v[104:107], v[60:63], v[144:159]
    v_mfma_f32_32x32x16_bf16 v[192:207], v[108:111], v[56:59], v[192:207]
    v_mfma_f32_32x32x16_bf16 v[208:223], v[108:111], v[60:63], v[208:223]
    buffer_load_dwordx4 v[104:107], v6, s[28:31], s49 offen
    buffer_load_dwordx4 v[108:111], v6, s[28:31], s51 offen
    s_add_u32 s49, s49, 1024
    s_add_u32 s51, s51, 1024
    ds_read_b64_tr_b16 v[56:57], v12 offset:46080
    ds_read_b64_tr_b16 v[58:59], v12 offset:46848
    ds_read_b64_tr_b16 v[60:61], v12 offset:46144
    ds_read_b64_tr_b16 v[62:63], v12 offset:46912
    s_waitcnt vmcnt(14) lgkmcnt(4)
    v_mfma_f32_32x32x16_bf16 v[128:143], v[112:115], v[48:51], v[128:143]
    v_mfma_f32_32x32x16_bf16 v[144:159], v[112:115], v[52:55], v[144:159]
    v_mfma_f32_32x32x16_bf16 v[192:207], v[116:119], v[48:51], v[192:207]
    v_mfma_f32_32x32x16_bf16 v[208:223], v[116:119], v[52:55], v[208:223]
    buffer_load_dwordx4 v[112:115], v6, s[28:31], s49 offen
    buffer_load_dwordx4 v[116:119], v6, s[28:31], s51 offen
    s_add_u32 s49, s49, 1024
    s_add_u32 s51, s51, 1024
    s_waitcnt vmcnt(14) lgkmcnt(0)
    v_mfma_f32_32x32x16_bf16 v[128:143], v[120:123], v[56:59], v[128:143]
    v_mfma_f32_32x32x16_bf16 v[144:159], v[120:123], v[60:63], v[144:159]
    v_mfma_f32_32x32x16_bf16 v[192:207], v[124:127], v[56:59], v[192:207]
    v_mfma_f32_32x32x16_bf16 v[208:223], v[124:127], v[60:63], v[208:223]
    buffer_load_dwordx4 v[120:123], v6, s[28:31], s49 offen
    buffer_load_dwordx4 v[124:127], v6, s[28:31], s51 offen
    s_add_u32 s49, s49, 1024
    s_add_u32 s51, s51, 1024
    s_nop 7
    s_nop 7
    ds_read_b64_tr_b16 v[48:49], v11 offset:0
    ds_read_b64_tr_b16 v[50:51], v11 offset:768
    ds_read_b64_tr_b16 v[52:53], v11 offset:64
    ds_read_b64_tr_b16 v[54:55], v11 offset:832
    ds_read_b64_tr_b16 v[56:57], v11 offset:3072
    ds_read_b64_tr_b16 v[58:59], v11 offset:3840
    ds_read_b64_tr_b16 v[60:61], v11 offset:3136
    ds_read_b64_tr_b16 v[62:63], v11 offset:3904
    s_waitcnt vmcnt(14) lgkmcnt(4)
    v_mfma_f32_32x32x16_bf16 v[160:175], v[64:67], v[48:51], v[160:175]
    v_cvt_pk_bf16_f32 v20, v128, v129
    v_cvt_pk_bf16_f32 v21, v192, v193
    v_lshlrev_b32 v22, 16, v20
    v_and_b32 v23, 0xffff0000, v20
    v_mfma_f32_32x32x16_bf16 v[176:191], v[64:67], v[52:55], v[176:191]
    v_mul_f32 v24, v22, v22
    v_mul_f32 v25, v23, v23
    v_fma_f32 v24, v24, s44, v16
    v_fma_f32 v25, v25, s44, v16
    v_mfma_f32_32x32x16_bf16 v[224:239], v[68:71], v[48:51], v[224:239]
    v_mul_f32 v24, v24, v22
    v_mul_f32 v25, v25, v23
    v_exp_f32 v24, v24
    v_exp_f32 v25, v25
    v_mfma_f32_32x32x16_bf16 v[240:255], v[68:71], v[52:55], v[240:255]
    s_nop 0
    v_add_f32 v24, 1.0, v24
    v_add_f32 v25, 1.0, v25
    v_rcp_f32 v24, v24
    buffer_load_dwordx4 v[64:67], v6, s[28:31], s49 offen
    buffer_load_dwordx4 v[68:71], v6, s[28:31], s51 offen
    s_add_u32 s49, s49, 1024
    s_add_u32 s51, s51, 1024
    ds_read_b64_tr_b16 v[48:49], v11 offset:6144
    ds_read_b64_tr_b16 v[50:51], v11 offset:6912
    ds_read_b64_tr_b16 v[52:53], v11 offset:6208
    ds_read_b64_tr_b16 v[54:55], v11 offset:6976
    s_waitcnt vmcnt(14) lgkmcnt(4)
    v_mfma_f32_32x32x16_bf16 v[160:175], v[72:75], v[56:59], v[160:175]
    v_rcp_f32 v25, v25
    s_nop 0
    v_mul_f32 v24, v24, v22
    v_mul_f32 v25, v25, v23
    v_mfma_f32_32x32x16_bf16 v[176:191], v[72:75], v[60:63], v[176:191]
    v_cvt_pk_bf16_f32 v24, v24, v25
    v_lshlrev_b32 v22, 16, v24
    v_and_b32 v23, 0xffff0000, v24
    v_lshlrev_b32 v24, 16, v21
    v_mfma_f32_32x32x16_bf16 v[224:239], v[76:79], v[56:59], v[224:239]
    v_and_b32 v25, 0xffff0000, v21
    v_mul_f32 v22, v22, v24
    v_mul_f32 v23, v23, v25
    v_cvt_pk_bf16_f32 v26, v22, v23
    v_mfma_f32_32x32x16_bf16 v[240:255], v[76:79], v[60:63], v[240:255]
    v_cvt_pk_bf16_f32 v20, v130, v131
    v_cvt_pk_bf16_f32 v21, v194, v195
    v_lshlrev_b32 v22, 16, v20
    v_and_b32 v23, 0xffff0000, v20
    buffer_load_dwordx4 v[72:75], v6, s[28:31], s49 offen
    buffer_load_dwordx4 v[76:79], v6, s[28:31], s51 offen
    s_add_u32 s49, s49, 1024
    s_add_u32 s51, s51, 1024
    ds_read_b64_tr_b16 v[56:57], v11 offset:9216
    ds_read_b64_tr_b16 v[58:59], v11 offset:9984
    ds_read_b64_tr_b16 v[60:61], v11 offset:9280
    ds_read_b64_tr_b16 v[62:63], v11 offset:10048
    s_waitcnt vmcnt(14) lgkmcnt(4)
    v_mfma_f32_32x32x16_bf16 v[160:175], v[80:83], v[48:51], v[160:175]
    v_mul_f32 v24, v22, v22
    v_mul_f32 v25, v23, v23
    v_fma_f32 v24, v24, s44, v16
    v_fma_f32 v25, v25, s44, v16
    v_mfma_f32_32x32x16_bf16 v[176:191], v[80:83], v[52:55], v[176:191]
    v_mul_f32 v24, v24, v22
    v_mul_f32 v25, v25, v23
    v_exp_f32 v24, v24
    v_exp_f32 v25, v25
    v_mfma_f32_32x32x16_bf16 v[224:239], v[84:87], v[48:51], v[224:239]
    s_nop 0
    v_add_f32 v24, 1.0, v24
    v_add_f32 v25, 1.0, v25
    v_rcp_f32 v24, v24
    v_mfma_f32_32x32x16_bf16 v[240:255], v[84:87], v[52:55], v[240:255]
    v_rcp_f32 v25, v25
    s_nop 0
    v_mul_f32 v24, v24, v22
    v_mul_f32 v25, v25, v23
    buffer_load_dwordx4 v[80:83], v6, s[28:31], s49 offen
    buffer_load_dwordx4 v[84:87], v6, s[28:31], s51 offen
    s_add_u32 s49, s49, 1024
    s_add_u32 s51, s51, 1024
    ds_read_b64_tr_b16 v[48:49], v11 offset:12288
    ds_read_b64_tr_b16 v[50:51], v11 offset:13056
    ds_read_b64_tr_b16 v[52:53], v11 offset:12352
    ds_read_b64_tr_b16 v[54:55], v11 offset:13120
    s_waitcnt vmcnt(14) lgkmcnt(4)
    v_mfma_f32_32x32x16_bf16 v[160:175], v[88:91], v[56:59], v[160:175]
    v_cvt_pk_bf16_f32 v24, v24, v25
    v_lshlrev_b32 v22, 16, v24
    v_and_b32 v23, 0xffff0000, v24
    v_lshlrev_b32 v24, 16, v21
    v_mfma_f32_32x32x16_bf16 v[176:191], v[88:91], v[60:63], v[176:191]
    v_and_b32 v25, 0xffff0000, v21
    v_mul_f32 v22, v22, v24
    v_mul_f32 v23, v23, v25
    v_cvt_pk_bf16_f32 v27, v22, v23
    v_mfma_f32_32x32x16_bf16 v[224:239], v[92:95], v[56:59], v[224:239]
    buffer_store_dwordx2 v[26:27], v13, s[28:31], s45 offen offset:0
    v_cvt_pk_bf16_f32 v20, v132, v133
    v_cvt_pk_bf16_f32 v21, v196, v197
    v_lshlrev_b32 v22, 16, v20
    v_mfma_f32_32x32x16_bf16 v[240:255], v[92:95], v[60:63], v[240:255]
    v_and_b32 v23, 0xffff0000, v20
    v_mul_f32 v24, v22, v22
    v_mul_f32 v25, v23, v23
    v_fma_f32 v24, v24, s44, v16
    buffer_load_dwordx4 v[88:91], v6, s[28:31], s49 offen
    buffer_load_dwordx4 v[92:95], v6, s[28:31], s51 offen
    s_add_u32 s49, s49, 1024
    s_add_u32 s51, s51, 1024
    ds_read_b64_tr_b16 v[56:57], v11 offset:15360
    ds_read_b64_tr_b16 v[58:59], v11 offset:16128
    ds_read_b64_tr_b16 v[60:61], v11 offset:15424
    ds_read_b64_tr_b16 v[62:63], v11 offset:16192
    s_waitcnt vmcnt(14) lgkmcnt(4)
    v_mfma_f32_32x32x16_bf16 v[160:175], v[96:99], v[48:51], v[160:175]
    v_fma_f32 v25, v25, s44, v16
    v_mul_f32 v24, v24, v22
    v_mul_f32 v25, v25, v23
    v_exp_f32 v24, v24
    v_mfma_f32_32x32x16_bf16 v[176:191], v[96:99], v[52:55], v[176:191]
    v_exp_f32 v25, v25
    s_nop 0
    v_add_f32 v24, 1.0, v24
    v_add_f32 v25, 1.0, v25
    v_mfma_f32_32x32x16_bf16 v[224:239], v[100:103], v[48:51], v[224:239]
    v_rcp_f32 v24, v24
    v_rcp_f32 v25, v25
    s_nop 0
    v_mul_f32 v24, v24, v22
    v_mfma_f32_32x32x16_bf16 v[240:255], v[100:103], v[52:55], v[240:255]
    v_mul_f32 v25, v25, v23
    v_cvt_pk_bf16_f32 v24, v24, v25
    v_lshlrev_b32 v22, 16, v24
    v_and_b32 v23, 0xffff0000, v24
    buffer_load_dwordx4 v[96:99], v6, s[28:31], s49 offen
    buffer_load_dwordx4 v[100:103], v6, s[28:31], s51 offen
    s_add_u32 s49, s49, 1024
    s_add_u32 s51, s51, 1024
    ds_read_b64_tr_b16 v[48:49], v11 offset:18432
    ds_read_b64_tr_b16 v[50:51], v11 offset:19200
    ds_read_b64_tr_b16 v[52:53], v11 offset:18496
    ds_read_b64_tr_b16 v[54:55], v11 offset:19264
    s_waitcnt vmcnt(14) lgkmcnt(4)
    v_mfma_f32_32x32x16_bf16 v[160:175], v[104:107], v[56:59], v[160:175]
    v_lshlrev_b32 v24, 16, v21
    v_and_b32 v25, 0xffff0000, v21
    v_mul_f32 v22, v22, v24
    v_mul_f32 v23, v23, v25
    v_mfma_f32_32x32x16_bf16 v[176:191], v[104:107], v[60:63], v[176:191]
    v_cvt_pk_bf16_f32 v28, v22, v23
    v_cvt_pk_bf16_f32 v20, v134, v135
    v_cvt_pk_bf16_f32 v21, v198, v199
    v_lshlrev_b32 v22, 16, v20
    v_mfma_f32_32x32x16_bf16 v[224:239], v[108:111], v[56:59], v[224:239]
    v_and_b32 v23, 0xffff0000, v20
    v_mul_f32 v24, v22, v22
    v_mul_f32 v25, v23, v23
    v_fma_f32 v24, v24, s44, v16
    v_mfma_f32_32x32x16_bf16 v[240:255], v[108:111], v[60:63], v[240:255]
    v_fma_f32 v25, v25, s44, v16
    v_mul_f32 v24, v24, v22
    v_mul_f32 v25, v25, v23
    v_exp_f32 v24, v24
    buffer_load_dwordx4 v[104:107], v6, s[28:31], s49 offen
    buffer_load_dwordx4 v[108:111], v6, s[28:31], s51 offen
    s_add_u32 s49, s49, 1024
    s_add_u32 s51, s51, 1024
    ds_read_b64_tr_b16 v[56:57], v11 offset:21504
    ds_read_b64_tr_b16 v[58:59], v11 offset:22272
    ds_read_b64_tr_b16 v[60:61], v11 offset:21568
    ds_read_b64_tr_b16 v[62:63], v11 offset:22336
    s_waitcnt vmcnt(14) lgkmcnt(4)
    v_mfma_f32_32x32x16_bf16 v[160:175], v[112:115], v[48:51], v[160:175]
    v_exp_f32 v25, v25
    s_nop 0
    v_add_f32 v24, 1.0, v24
    v_add_f32 v25, 1.0, v25
    v_mfma_f32_32x32x16_bf16 v[176:191], v[112:115], v[52:55], v[176:191]
    v_rcp_f32 v24, v24
    v_rcp_f32 v25, v25
    s_nop 0
    v_mul_f32 v24, v24, v22
    v_mfma_f32_32x32x16_bf16 v[224:239], v[116:119], v[48:51], v[224:239]
    v_mul_f32 v25, v25, v23
    v_cvt_pk_bf16_f32 v24, v24, v25
    v_lshlrev_b32 v22, 16, v24
    v_and_b32 v23, 0xffff0000, v24
    v_mfma_f32_32x32x16_bf16 v[240:255], v[116:119], v[52:55], v[240:255]
    v_lshlrev_b32 v24, 16, v21
    v_and_b32 v25, 0xffff0000, v21
    v_mul_f32 v22, v22, v24
    v_mul_f32 v23, v23, v25
    buffer_load_dwordx4 v[112:115], v6, s[28:31], s49 offen
    buffer_load_dwordx4 v[116:119], v6, s[28:31], s51 offen
    s_add_u32 s49, s49, 1024
    s_add_u32 s51, s51, 1024
    ds_read_b64_tr_b16 v[48:49], v11 offset:24576
    ds_read_b64_tr_b16 v[50:51], v11 offset:25344
    ds_read_b64_tr_b16 v[52:53], v11 offset:24640
    ds_read_b64_tr_b16 v[54:55], v11 offset:25408
    s_waitcnt vmcnt(14) lgkmcnt(4)
    v_mfma_f32_32x32x16_bf16 v[160:175], v[120:123], v[56:59], v[160:175]
    v_cvt_pk_bf16_f32 v29, v22, v23
    buffer_store_dwordx2 v[28:29], v13, s[28:31], s45 offen offset:512
    v_cvt_pk_bf16_f32 v20, v136, v137
    v_cvt_pk_bf16_f32 v21, v200, v201
    v_mfma_f32_32x32x16_bf16 v[176:191], v[120:123], v[60:63], v[176:191]
    v_lshlrev_b32 v22, 16, v20
    v_and_b32 v23, 0xffff0000, v20
    v_mul_f32 v24, v22, v22
    v_mul_f32 v25, v23, v23
    v_mfma_f32_32x32x16_bf16 v[224:239], v[124:127], v[56:59], v[224:239]
    v_fma_f32 v24, v24, s44, v16
    v_fma_f32 v25, v25, s44, v16
    v_mul_f32 v24, v24, v22
    v_mul_f32 v25, v25, v23
    v_mfma_f32_32x32x16_bf16 v[240:255], v[124:127], v[60:63], v[240:255]
    v_exp_f32 v24, v24
    v_exp_f32 v25, v25
    s_nop 0
    v_add_f32 v24, 1.0, v24
    buffer_load_dwordx4 v[120:123], v6, s[28:31], s49 offen
    buffer_load_dwordx4 v[124:127], v6, s[28:31], s51 offen
    s_add_u32 s49, s49, 1024
    s_add_u32 s51, s51, 1024
    ds_read_b64_tr_b16 v[56:57], v11 offset:27648
    ds_read_b64_tr_b16 v[58:59], v11 offset:28416
    ds_read_b64_tr_b16 v[60:61], v11 offset:27712
    ds_read_b64_tr_b16 v[62:63], v11 offset:28480
    s_waitcnt vmcnt(14) lgkmcnt(4)
    v_mfma_f32_32x32x16_bf16 v[160:175], v[64:67], v[48:51], v[160:175]
    v_add_f32 v25, 1.0, v25
    v_rcp_f32 v24, v24
    v_rcp_f32 v25, v25
    s_nop 0
    v_mfma_f32_32x32x16_bf16 v[176:191], v[64:67], v[52:55], v[176:191]
    v_mul_f32 v24, v24, v22
    v_mul_f32 v25, v25, v23
    v_cvt_pk_bf16_f32 v24, v24, v25
    v_lshlrev_b32 v22, 16, v24
    v_mfma_f32_32x32x16_bf16 v[224:239], v[68:71], v[48:51], v[224:239]
    v_and_b32 v23, 0xffff0000, v24
    v_lshlrev_b32 v24, 16, v21
    v_and_b32 v25, 0xffff0000, v21
    v_mul_f32 v22, v22, v24
    v_mfma_f32_32x32x16_bf16 v[240:255], v[68:71], v[52:55], v[240:255]
    v_mul_f32 v23, v23, v25
    v_cvt_pk_bf16_f32 v26, v22, v23
    v_cvt_pk_bf16_f32 v20, v138, v139
    v_cvt_pk_bf16_f32 v21, v202, v203
    buffer_load_dwordx4 v[64:67], v6, s[28:31], s49 offen
    buffer_load_dwordx4 v[68:71], v6, s[28:31], s51 offen
    s_add_u32 s49, s49, 1024
    s_add_u32 s51, s51, 1024
    ds_read_b64_tr_b16 v[48:49], v11 offset:30720
    ds_read_b64_tr_b16 v[50:51], v11 offset:31488
    ds_read_b64_tr_b16 v[52:53], v11 offset:30784
    ds_read_b64_tr_b16 v[54:55], v11 offset:31552
    s_waitcnt vmcnt(14) lgkmcnt(4)
    v_mfma_f32_32x32x16_bf16 v[160:175], v[72:75], v[56:59], v[160:175]
    v_lshlrev_b32 v22, 16, v20
    v_and_b32 v23, 0xffff0000, v20
    v_mul_f32 v24, v22, v22
    v_mul_f32 v25, v23, v23
    v_mfma_f32_32x32x16_bf16 v[176:191], v[72:75], v[60:63], v[176:191]
    v_fma_f32 v24, v24, s44, v16
    v_fma_f32 v25, v25, s44, v16
    v_mul_f32 v24, v24, v22
    v_mul_f32 v25, v25, v23
    v_mfma_f32_32x32x16_bf16 v[224:239], v[76:79], v[56:59], v[224:239]
    v_exp_f32 v24, v24
    v_exp_f32 v25, v25
    s_nop 0
    v_add_f32 v24, 1.0, v24
    v_mfma_f32_32x32x16_bf16 v[240:255], v[76:79], v[60:63], v[240:255]
    v_add_f32 v25, 1.0, v25
    v_rcp_f32 v24, v24
    v_rcp_f32 v25, v25
    s_nop 0
    buffer_load_dwordx4 v[72:75], v6, s[28:31], s49 offen
    buffer_load_dwordx4 v[76:79], v6, s[28:31], s51 offen
    s_add_u32 s49, s49, 1024
    s_add_u32 s51, s51, 1024
    ds_read_b64_tr_b16 v[56:57], v11 offset:33792
    ds_read_b64_tr_b16 v[58:59], v11 offset:34560
    ds_read_b64_tr_b16 v[60:61], v11 offset:33856
    ds_read_b64_tr_b16 v[62:63], v11 offset:34624
    s_waitcnt vmcnt(14) lgkmcnt(4)
    v_mfma_f32_32x32x16_bf16 v[160:175], v[80:83], v[48:51], v[160:175]
    v_mul_f32 v24, v24, v22
    v_mul_f32 v25, v25, v23
    v_cvt_pk_bf16_f32 v24, v24, v25
    v_lshlrev_b32 v22, 16, v24
    v_mfma_f32_32x32x16_bf16 v[176:191], v[80:83], v[52:55], v[176:191]
    v_and_b32 v23, 0xffff0000, v24
    v_lshlrev_b32 v24, 16, v21
    v_and_b32 v25, 0xffff0000, v21
    v_mul_f32 v22, v22, v24
    v_mfma_f32_32x32x16_bf16 v[224:239], v[84:87], v[48:51], v[224:239]
    v_mul_f32 v23, v23, v25
    v_cvt_pk_bf16_f32 v27, v22, v23
    buffer_store_dwordx2 v[26:27], v13, s[28:31], s45 offen offset:1024
    v_cvt_pk_bf16_f32 v20, v140, v141
    v_mfma_f32_32x32x16_bf16 v[240:255], v[84:87], v[52:55], v[240:255]
    v_cvt_pk_bf16_f32 v21, v204, v205
    v_lshlrev_b32 v22, 16, v20
    v_and_b32 v23, 0xffff0000, v20
    v_mul_f32 v24, v22, v22
    buffer_load_dwordx4 v[80:83], v6, s[28:31], s49 offen
    buffer_load_dwordx4 v[84:87], v6, s[28:31], s51 offen
    s_add_u32 s49, s49, 1024
    s_add_u32 s51, s51, 1024
    ds_read_b64_tr_b16 v[48:49], v11 offset:36864
    ds_read_b64_tr_b16 v[50:51], v11 offset:37632
    ds_read_b64_tr_b16 v[52:53], v11 offset:36928
    ds_read_b64_tr_b16 v[54:55], v11 offset:37696
    s_waitcnt vmcnt(14) lgkmcnt(4)
    v_mfma_f32_32x32x16_bf16 v[160:175], v[88:91], v[56:59], v[160:175]
    v_mul_f32 v25, v23, v23
    v_fma_f32 v24, v24, s44, v16
    v_fma_f32 v25, v25, s44, v16
    v_mul_f32 v24, v24, v22
    v_mfma_f32_32x32x16_bf16 v[176:191], v[88:91], v[60:63], v[176:191]
    v_mul_f32 v25, v25, v23
    v_exp_f32 v24, v24
    v_exp_f32 v25, v25
    s_nop 0
    v_mfma_f32_32x32x16_bf16 v[224:239], v[92:95], v[56:59], v[224:239]
    v_add_f32 v24, 1.0, v24
    v_add_f32 v25, 1.0, v25
    v_rcp_f32 v24, v24
    v_rcp_f32 v25, v25
    v_mfma_f32_32x32x16_bf16 v[240:255], v[92:95], v[60:63], v[240:255]
    s_nop 0
    v_mul_f32 v24, v24, v22
    v_mul_f32 v25, v25, v23
    v_cvt_pk_bf16_f32 v24, v24, v25
    buffer_load_dwordx4 v[88:91], v6, s[28:31], s49 offen
    buffer_load_dwordx4 v[92:95], v6, s[28:31], s51 offen
    s_add_u32 s49, s49, 1024
    s_add_u32 s51, s51, 1024
    ds_read_b64_tr_b16 v[56:57], v11 offset:39936
    ds_read_b64_tr_b16 v[58:59], v11 offset:40704
    ds_read_b64_tr_b16 v[60:61], v11 offset:40000
    ds_read_b64_tr_b16 v[62:63], v11 offset:40768
    s_waitcnt vmcnt(14) lgkmcnt(4)
    v_mfma_f32_32x32x16_bf16 v[160:175], v[96:99], v[48:51], v[160:175]
    v_lshlrev_b32 v22, 16, v24
    v_and_b32 v23, 0xffff0000, v24
    v_lshlrev_b32 v24, 16, v21
    v_and_b32 v25, 0xffff0000, v21
    v_mfma_f32_32x32x16_bf16 v[176:191], v[96:99], v[52:55], v[176:191]
    v_mul_f32 v22, v22, v24
    v_mul_f32 v23, v23, v25
    v_cvt_pk_bf16_f32 v28, v22, v23
    v_cvt_pk_bf16_f32 v20, v142, v143
    v_mfma_f32_32x32x16_bf16 v[224:239], v[100:103], v[48:51], v[224:239]
    v_cvt_pk_bf16_f32 v21, v206, v207
    v_lshlrev_b32 v22, 16, v20
    v_and_b32 v23, 0xffff0000, v20
    v_mul_f32 v24, v22, v22
    v_mfma_f32_32x32x16_bf16 v[240:255], v[100:103], v[52:55], v[240:255]
    v_mul_f32 v25, v23, v23
    v_fma_f32 v24, v24, s44, v16
    v_fma_f32 v25, v25, s44, v16
    v_mul_f32 v24, v24, v22
    buffer_load_dwordx4 v[96:99], v6, s[28:31], s49 offen
    buffer_load_dwordx4 v[100:103], v6, s[28:31], s51 offen
    s_add_u32 s49, s49, 1024
    s_add_u32 s51, s51, 1024
    ds_read_b64_tr_b16 v[48:49], v11 offset:43008
    ds_read_b64_tr_b16 v[50:51], v11 offset:43776
    ds_read_b64_tr_b16 v[52:53], v11 offset:43072
    ds_read_b64_tr_b16 v[54:55], v11 offset:43840
    s_waitcnt vmcnt(14) lgkmcnt(4)
    v_mfma_f32_32x32x16_bf16 v[160:175], v[104:107], v[56:59], v[160:175]
    v_mul_f32 v25, v25, v23
    v_exp_f32 v24, v24
    v_exp_f32 v25, v25
    s_nop 0
    v_mfma_f32_32x32x16_bf16 v[176:191], v[104:107], v[60:63], v[176:191]
    v_add_f32 v24, 1.0, v24
    v_add_f32 v25, 1.0, v25
    v_rcp_f32 v24, v24
    v_rcp_f32 v25, v25
    v_mfma_f32_32x32x16_bf16 v[224:239], v[108:111], v[56:59], v[224:239]
    s_nop 0
    v_mul_f32 v24, v24, v22
    v_mul_f32 v25, v25, v23
    v_cvt_pk_bf16_f32 v24, v24, v25
    v_mfma_f32_32x32x16_bf16 v[240:255], v[108:111], v[60:63], v[240:255]
    v_lshlrev_b32 v22, 16, v24
    v_and_b32 v23, 0xffff0000, v24
    v_lshlrev_b32 v24, 16, v21
    v_and_b32 v25, 0xffff0000, v21
    buffer_load_dwordx4 v[104:107], v6, s[28:31], s49 offen
    buffer_load_dwordx4 v[108:111], v6, s[28:31], s51 offen
    s_add_u32 s49, s49, 1024
    s_add_u32 s51, s51, 1024
    ds_read_b64_tr_b16 v[56:57], v11 offset:46080
    ds_read_b64_tr_b16 v[58:59], v11 offset:46848
    ds_read_b64_tr_b16 v[60:61], v11 offset:46144
    ds_read_b64_tr_b16 v[62:63], v11 offset:46912
    s_waitcnt vmcnt(14) lgkmcnt(4)
    v_mfma_f32_32x32x16_bf16 v[160:175], v[112:115], v[48:51], v[160:175]
    v_mul_f32 v22, v22, v24
    v_mul_f32 v23, v23, v25
    v_cvt_pk_bf16_f32 v29, v22, v23
    buffer_store_dwordx2 v[28:29], v13, s[28:31], s45 offen offset:1536
    v_mfma_f32_32x32x16_bf16 v[176:191], v[112:115], v[52:55], v[176:191]
    v_cvt_pk_bf16_f32 v20, v144, v145
    v_cvt_pk_bf16_f32 v21, v208, v209
    v_lshlrev_b32 v22, 16, v20
    v_and_b32 v23, 0xffff0000, v20
    v_mfma_f32_32x32x16_bf16 v[224:239], v[116:119], v[48:51], v[224:239]
    v_mul_f32 v24, v22, v22
    v_mul_f32 v25, v23, v23
    v_fma_f32 v24, v24, s44, v16
    v_fma_f32 v25, v25, s44, v16
    v_mfma_f32_32x32x16_bf16 v[240:255], v[116:119], v[52:55], v[240:255]
    v_mul_f32 v24, v24, v22
    v_mul_f32 v25, v25, v23
    v_exp_f32 v24, v24
    v_exp_f32 v25, v25
    buffer_load_dwordx4 v[112:115], v6, s[28:31], s49 offen
    buffer_load_dwordx4 v[116:119], v6, s[28:31], s51 offen
    s_add_u32 s49, s49, 1024
    s_add_u32 s51, s51, 1024
    ds_read_b64_tr_b16 v[48:49], v12 offset:0
    ds_read_b64_tr_b16 v[50:51], v12 offset:768
    ds_read_b64_tr_b16 v[52:53], v12 offset:64
    ds_read_b64_tr_b16 v[54:55], v12 offset:832
    s_waitcnt vmcnt(14) lgkmcnt(4)
    v_mfma_f32_32x32x16_bf16 v[160:175], v[120:123], v[56:59], v[160:175]
    s_nop 0
    v_add_f32 v24, 1.0, v24
    v_add_f32 v25, 1.0, v25
    v_rcp_f32 v24, v24
    v_mfma_f32_32x32x16_bf16 v[176:191], v[120:123], v[60:63], v[176:191]
    v_rcp_f32 v25, v25
    s_nop 0
    v_mul_f32 v24, v24, v22
    v_mul_f32 v25, v25, v23
    v_mfma_f32_32x32x16_bf16 v[224:239], v[124:127], v[56:59], v[224:239]
    v_cvt_pk_bf16_f32 v24, v24, v25
    v_lshlrev_b32 v22, 16, v24
    v_and_b32 v23, 0xffff0000, v24
    v_lshlrev_b32 v24, 16, v21
    v_mfma_f32_32x32x16_bf16 v[240:255], v[124:127], v[60:63], v[240:255]
    v_and_b32 v25, 0xffff0000, v21
    v_mul_f32 v22, v22, v24
    v_mul_f32 v23, v23, v25
    v_cvt_pk_bf16_f32 v26, v22, v23
    buffer_load_dwordx4 v[120:123], v6, s[28:31], s49 offen
    buffer_load_dwordx4 v[124:127], v6, s[28:31], s51 offen
    s_add_u32 s49, s49, 1024
    s_add_u32 s51, s51, 1024
    ds_read_b64_tr_b16 v[56:57], v12 offset:3072
    ds_read_b64_tr_b16 v[58:59], v12 offset:3840
    ds_read_b64_tr_b16 v[60:61], v12 offset:3136
    ds_read_b64_tr_b16 v[62:63], v12 offset:3904
    s_waitcnt vmcnt(14) lgkmcnt(4)
    v_mfma_f32_32x32x16_bf16 v[160:175], v[64:67], v[48:51], v[160:175]
    v_cvt_pk_bf16_f32 v20, v146, v147
    v_cvt_pk_bf16_f32 v21, v210, v211
    v_lshlrev_b32 v22, 16, v20
    v_and_b32 v23, 0xffff0000, v20
    v_mfma_f32_32x32x16_bf16 v[176:191], v[64:67], v[52:55], v[176:191]
    v_mul_f32 v24, v22, v22
    v_mul_f32 v25, v23, v23
    v_fma_f32 v24, v24, s44, v16
    v_fma_f32 v25, v25, s44, v16
    v_mfma_f32_32x32x16_bf16 v[224:239], v[68:71], v[48:51], v[224:239]
    v_mul_f32 v24, v24, v22
    v_mul_f32 v25, v25, v23
    v_exp_f32 v24, v24
    v_exp_f32 v25, v25
    v_mfma_f32_32x32x16_bf16 v[240:255], v[68:71], v[52:55], v[240:255]
    s_nop 0
    v_add_f32 v24, 1.0, v24
    v_add_f32 v25, 1.0, v25
    v_rcp_f32 v24, v24
    buffer_load_dwordx4 v[64:67], v6, s[28:31], s49 offen
    buffer_load_dwordx4 v[68:71], v6, s[28:31], s51 offen
    s_add_u32 s49, s49, 1024
    s_add_u32 s51, s51, 1024
    ds_read_b64_tr_b16 v[48:49], v12 offset:6144
    ds_read_b64_tr_b16 v[50:51], v12 offset:6912
    ds_read_b64_tr_b16 v[52:53], v12 offset:6208
    ds_read_b64_tr_b16 v[54:55], v12 offset:6976
    s_waitcnt vmcnt(14) lgkmcnt(4)
    v_mfma_f32_32x32x16_bf16 v[160:175], v[72:75], v[56:59], v[160:175]
    v_rcp_f32 v25, v25
    s_nop 0
    v_mul_f32 v24, v24, v22
    v_mul_f32 v25, v25, v23
    v_mfma_f32_32x32x16_bf16 v[176:191], v[72:75], v[60:63], v[176:191]
    v_cvt_pk_bf16_f32 v24, v24, v25
    v_lshlrev_b32 v22, 16, v24
    v_and_b32 v23, 0xffff0000, v24
    v_lshlrev_b32 v24, 16, v21
    v_mfma_f32_32x32x16_bf16 v[224:239], v[76:79], v[56:59], v[224:239]
    v_and_b32 v25, 0xffff0000, v21
    v_mul_f32 v22, v22, v24
    v_mul_f32 v23, v23, v25
    v_cvt_pk_bf16_f32 v27, v22, v23
    v_mfma_f32_32x32x16_bf16 v[240:255], v[76:79], v[60:63], v[240:255]
    buffer_store_dwordx2 v[26:27], v13, s[28:31], s46 offen offset:0
    v_cvt_pk_bf16_f32 v20, v148, v149
    v_cvt_pk_bf16_f32 v21, v212, v213
    v_lshlrev_b32 v22, 16, v20
    buffer_load_dwordx4 v[72:75], v6, s[28:31], s49 offen
    buffer_load_dwordx4 v[76:79], v6, s[28:31], s51 offen
    s_add_u32 s49, s49, 1024
    s_add_u32 s51, s51, 1024
    ds_read_b64_tr_b16 v[56:57], v12 offset:9216
    ds_read_b64_tr_b16 v[58:59], v12 offset:9984
    ds_read_b64_tr_b16 v[60:61], v12 offset:9280
    ds_read_b64_tr_b16 v[62:63], v12 offset:10048
    s_waitcnt vmcnt(14) lgkmcnt(4)
    v_mfma_f32_32x32x16_bf16 v[160:175], v[80:83], v[48:51], v[160:175]
    v_and_b32 v23, 0xffff0000, v20
    v_mul_f32 v24, v22, v22
    v_mul_f32 v25, v23, v23
    v_fma_f32 v24, v24, s44, v16
    v_mfma_f32_32x32x16_bf16 v[176:191], v[80:83], v[52:55], v[176:191]
    v_fma_f32 v25, v25, s44, v16
    v_mul_f32 v24, v24, v22
    v_mul_f32 v25, v25, v23
    v_exp_f32 v24, v24
    v_mfma_f32_32x32x16_bf16 v[224:239], v[84:87], v[48:51], v[224:239]
    v_exp_f32 v25, v25
    s_nop 0
    v_add_f32 v24, 1.0, v24
    v_add_f32 v25, 1.0, v25
    v_mfma_f32_32x32x16_bf16 v[240:255], v[84:87], v[52:55], v[240:255]
    v_rcp_f32 v24, v24
    v_rcp_f32 v25, v25
    s_nop 0
    v_mul_f32 v24, v24, v22
    buffer_load_dwordx4 v[80:83], v6, s[28:31], s49 offen
    buffer_load_dwordx4 v[84:87], v6, s[28:31], s51 offen
    s_add_u32 s49, s49, 1024
    s_add_u32 s51, s51, 1024
    ds_read_b64_tr_b16 v[48:49], v12 offset:12288
    ds_read_b64_tr_b16 v[50:51], v12 offset:13056
    ds_read_b64_tr_b16 v[52:53], v12 offset:12352
    ds_read_b64_tr_b16 v[54:55], v12 offset:13120
    s_waitcnt vmcnt(14) lgkmcnt(4)
    v_mfma_f32_32x32x16_bf16 v[160:175], v[88:91], v[56:59], v[160:175]
    v_mul_f32 v25, v25, v23
    v_cvt_pk_bf16_f32 v24, v24, v25
    v_lshlrev_b32 v22, 16, v24
    v_and_b32 v23, 0xffff0000, v24
    v_mfma_f32_32x32x16_bf16 v[176:191], v[88:91], v[60:63], v[176:191]
    v_lshlrev_b32 v24, 16, v21
    v_and_b32 v25, 0xffff0000, v21
    v_mul_f32 v22, v22, v24
    v_mul_f32 v23, v23, v25
    v_mfma_f32_32x32x16_bf16 v[224:239], v[92:95], v[56:59], v[224:239]
    v_cvt_pk_bf16_f32 v28, v22, v23
    v_cvt_pk_bf16_f32 v20, v150, v151
    v_cvt_pk_bf16_f32 v21, v214, v215
    v_lshlrev_b32 v22, 16, v20
    v_mfma_f32_32x32x16_bf16 v[240:255], v[92:95], v[60:63], v[240:255]
    v_and_b32 v23, 0xffff0000, v20
    v_mul_f32 v24, v22, v22
    v_mul_f32 v25, v23, v23
    v_fma_f32 v24, v24, s44, v16
    buffer_load_dwordx4 v[88:91], v6, s[28:31], s49 offen
    buffer_load_dwordx4 v[92:95], v6, s[28:31], s51 offen
    s_add_u32 s49, s49, 1024
    s_add_u32 s51, s51, 1024
    ds_read_b64_tr_b16 v[56:57], v12 offset:15360
    ds_read_b64_tr_b16 v[58:59], v12 offset:16128
    ds_read_b64_tr_b16 v[60:61], v12 offset:15424
    ds_read_b64_tr_b16 v[62:63], v12 offset:16192
    s_waitcnt vmcnt(14) lgkmcnt(4)
    v_mfma_f32_32x32x16_bf16 v[160:175], v[96:99], v[48:51], v[160:175]
    v_fma_f32 v25, v25, s44, v16
    v_mul_f32 v24, v24, v22
    v_mul_f32 v25, v25, v23
    v_exp_f32 v24, v24
    v_mfma_f32_32x32x16_bf16 v[176:191], v[96:99], v[52:55], v[176:191]
    v_exp_f32 v25, v25
    s_nop 0
    v_add_f32 v24, 1.0, v24
    v_add_f32 v25, 1.0, v25
    v_mfma_f32_32x32x16_bf16 v[224:239], v[100:103], v[48:51], v[224:239]
    v_rcp_f32 v24, v24
    v_rcp_f32 v25, v25
    s_nop 0
    v_mul_f32 v24, v24, v22
    v_mfma_f32_32x32x16_bf16 v[240:255], v[100:103], v[52:55], v[240:255]
    v_mul_f32 v25, v25, v23
    v_cvt_pk_bf16_f32 v24, v24, v25
    v_lshlrev_b32 v22, 16, v24
    v_and_b32 v23, 0xffff0000, v24
    buffer_load_dwordx4 v[96:99], v6, s[28:31], s49 offen
    buffer_load_dwordx4 v[100:103], v6, s[28:31], s51 offen
    s_add_u32 s49, s49, 1024
    s_add_u32 s51, s51, 1024
    ds_read_b64_tr_b16 v[48:49], v12 offset:18432
    ds_read_b64_tr_b16 v[50:51], v12 offset:19200
    ds_read_b64_tr_b16 v[52:53], v12 offset:18496
    ds_read_b64_tr_b16 v[54:55], v12 offset:19264
    s_waitcnt vmcnt(14) lgkmcnt(4)
    v_mfma_f32_32x32x16_bf16 v[160:175], v[104:107], v[56:59], v[160:175]
    v_lshlrev_b32 v24, 16, v21
    v_and_b32 v25, 0xffff0000, v21
    v_mul_f32 v22, v22, v24
    v_mul_f32 v23, v23, v25
    v_mfma_f32_32x32x16_bf16 v[176:191], v[104:107], v[60:63], v[176:191]
    v_cvt_pk_bf16_f32 v29, v22, v23
    buffer_store_dwordx2 v[28:29], v13, s[28:31], s46 offen offset:512
    v_cvt_pk_bf16_f32 v20, v152, v153
    v_cvt_pk_bf16_f32 v21, v216, v217
    v_mfma_f32_32x32x16_bf16 v[224:239], v[108:111], v[56:59], v[224:239]
    v_lshlrev_b32 v22, 16, v20
    v_and_b32 v23, 0xffff0000, v20
    v_mul_f32 v24, v22, v22
    v_mul_f32 v25, v23, v23
    v_mfma_f32_32x32x16_bf16 v[240:255], v[108:111], v[60:63], v[240:255]
    v_fma_f32 v24, v24, s44, v16
    v_fma_f32 v25, v25, s44, v16
    v_mul_f32 v24, v24, v22
    v_mul_f32 v25, v25, v23
    buffer_load_dwordx4 v[104:107], v6, s[28:31], s49 offen
    buffer_load_dwordx4 v[108:111], v6, s[28:31], s51 offen
    s_add_u32 s49, s49, 1024
    s_add_u32 s51, s51, 1024
    ds_read_b64_tr_b16 v[56:57], v12 offset:21504
    ds_read_b64_tr_b16 v[58:59], v12 offset:22272
    ds_read_b64_tr_b16 v[60:61], v12 offset:21568
    ds_read_b64_tr_b16 v[62:63], v12 offset:22336
    s_waitcnt vmcnt(14) lgkmcnt(4)
    v_mfma_f32_32x32x16_bf16 v[160:175], v[112:115], v[48:51], v[160:175]
    v_exp_f32 v24, v24
    v_exp_f32 v25, v25
    s_nop 0
    v_add_f32 v24, 1.0, v24
    v_mfma_f32_32x32x16_bf16 v[176:191], v[112:115], v[52:55], v[176:191]
    v_add_f32 v25, 1.0, v25
    v_rcp_f32 v24, v24
    v_rcp_f32 v25, v25
    s_nop 0
    v_mfma_f32_32x32x16_bf16 v[224:239], v[116:119], v[48:51], v[224:239]
    v_mul_f32 v24, v24, v22
    v_mul_f32 v25, v25, v23
    v_cvt_pk_bf16_f32 v24, v24, v25
    v_lshlrev_b32 v22, 16, v24
    v_mfma_f32_32x32x16_bf16 v[240:255], v[116:119], v[52:55], v[240:255]
    v_and_b32 v23, 0xffff0000, v24
    v_lshlrev_b32 v24, 16, v21
    v_and_b32 v25, 0xffff0000, v21
    v_mul_f32 v22, v22, v24
    buffer_load_dwordx4 v[112:115], v6, s[28:31], s49 offen
    buffer_load_dwordx4 v[116:119], v6, s[28:31], s51 offen
    s_add_u32 s49, s49, 1024
    s_add_u32 s51, s51, 1024
    ds_read_b64_tr_b16 v[48:49], v12 offset:24576
    ds_read_b64_tr_b16 v[50:51], v12 offset:25344
    ds_read_b64_tr_b16 v[52:53], v12 offset:24640
    ds_read_b64_tr_b16 v[54:55], v12 offset:25408
    s_waitcnt vmcnt(14) lgkmcnt(4)
    v_mfma_f32_32x32x16_bf16 v[160:175], v[120:123], v[56:59], v[160:175]
    v_mul_f32 v23, v23, v25
    v_cvt_pk_bf16_f32 v26, v22, v23
    v_cvt_pk_bf16_f32 v20, v154, v155
    v_cvt_pk_bf16_f32 v21, v218, v219
    v_mfma_f32_32x32x16_bf16 v[176:191], v[120:123], v[60:63], v[176:191]
    v_lshlrev_b32 v22, 16, v20
    v_and_b32 v23, 0xffff0000, v20
    v_mul_f32 v24, v22, v22
    v_mul_f32 v25, v23, v23
    v_mfma_f32_32x32x16_bf16 v[224:239], v[124:127], v[56:59], v[224:239]
    v_fma_f32 v24, v24, s44, v16
    v_fma_f32 v25, v25, s44, v16
    v_mul_f32 v24, v24, v22
    v_mul_f32 v25, v25, v23
    v_mfma_f32_32x32x16_bf16 v[240:255], v[124:127], v[60:63], v[240:255]
    v_exp_f32 v24, v24
    v_exp_f32 v25, v25
    s_nop 0
    v_add_f32 v24, 1.0, v24
    buffer_load_dwordx4 v[120:123], v6, s[28:31], s49 offen
    buffer_load_dwordx4 v[124:127], v6, s[28:31], s51 offen
    s_add_u32 s49, s49, 1024
    s_add_u32 s51, s51, 1024
    ds_read_b64_tr_b16 v[56:57], v12 offset:27648
    ds_read_b64_tr_b16 v[58:59], v12 offset:28416
    ds_read_b64_tr_b16 v[60:61], v12 offset:27712
    ds_read_b64_tr_b16 v[62:63], v12 offset:28480
    s_waitcnt vmcnt(14) lgkmcnt(4)
    v_mfma_f32_32x32x16_bf16 v[160:175], v[64:67], v[48:51], v[160:175]
    v_add_f32 v25, 1.0, v25
    v_rcp_f32 v24, v24
    v_rcp_f32 v25, v25
    s_nop 0
    v_mfma_f32_32x32x16_bf16 v[176:191], v[64:67], v[52:55], v[176:191]
    v_mul_f32 v24, v24, v22
    v_mul_f32 v25, v25, v23
    v_cvt_pk_bf16_f32 v24, v24, v25
    v_lshlrev_b32 v22, 16, v24
    v_mfma_f32_32x32x16_bf16 v[224:239], v[68:71], v[48:51], v[224:239]
    v_and_b32 v23, 0xffff0000, v24
    v_lshlrev_b32 v24, 16, v21
    v_and_b32 v25, 0xffff0000, v21
    v_mul_f32 v22, v22, v24
    v_mfma_f32_32x32x16_bf16 v[240:255], v[68:71], v[52:55], v[240:255]
    v_mul_f32 v23, v23, v25
    v_cvt_pk_bf16_f32 v27, v22, v23
    buffer_store_dwordx2 v[26:27], v13, s[28:31], s46 offen offset:1024
    v_cvt_pk_bf16_f32 v20, v156, v157
    ds_read_b64_tr_b16 v[48:49], v12 offset:30720
    ds_read_b64_tr_b16 v[50:51], v12 offset:31488
    ds_read_b64_tr_b16 v[52:53], v12 offset:30784
    ds_read_b64_tr_b16 v[54:55], v12 offset:31552
    s_waitcnt vmcnt(12) lgkmcnt(4)
    v_mfma_f32_32x32x16_bf16 v[160:175], v[72:75], v[56:59], v[160:175]
    v_cvt_pk_bf16_f32 v21, v220, v221
    v_lshlrev_b32 v22, 16, v20
    v_and_b32 v23, 0xffff0000, v20
    v_mul_f32 v24, v22, v22
    v_mfma_f32_32x32x16_bf16 v[176:191], v[72:75], v[60:63], v[176:191]
    v_mul_f32 v25, v23, v23
    v_fma_f32 v24, v24, s44, v16
    v_fma_f32 v25, v25, s44, v16
    v_mul_f32 v24, v24, v22
    v_mfma_f32_32x32x16_bf16 v[224:239], v[76:79], v[56:59], v[224:239]
    v_mul_f32 v25, v25, v23
    v_exp_f32 v24, v24
    v_exp_f32 v25, v25
    s_nop 0
    v_mfma_f32_32x32x16_bf16 v[240:255], v[76:79], v[60:63], v[240:255]
    v_add_f32 v24, 1.0, v24
    v_add_f32 v25, 1.0, v25
    v_rcp_f32 v24, v24
    v_rcp_f32 v25, v25
    ds_read_b64_tr_b16 v[56:57], v12 offset:33792
    ds_read_b64_tr_b16 v[58:59], v12 offset:34560
    ds_read_b64_tr_b16 v[60:61], v12 offset:33856
    ds_read_b64_tr_b16 v[62:63], v12 offset:34624
    s_waitcnt vmcnt(10) lgkmcnt(4)
    v_mfma_f32_32x32x16_bf16 v[160:175], v[80:83], v[48:51], v[160:175]
    s_nop 0
    v_mul_f32 v24, v24, v22
    v_mul_f32 v25, v25, v23
    v_cvt_pk_bf16_f32 v24, v24, v25
    v_mfma_f32_32x32x16_bf16 v[176:191], v[80:83], v[52:55], v[176:191]
    v_lshlrev_b32 v22, 16, v24
    v_and_b32 v23, 0xffff0000, v24
    v_lshlrev_b32 v24, 16, v21
    v_and_b32 v25, 0xffff0000, v21
    v_mfma_f32_32x32x16_bf16 v[224:239], v[84:87], v[48:51], v[224:239]
    v_mul_f32 v22, v22, v24
    v_mul_f32 v23, v23, v25
    v_cvt_pk_bf16_f32 v28, v22, v23
    v_cvt_pk_bf16_f32 v20, v158, v159
    v_mfma_f32_32x32x16_bf16 v[240:255], v[84:87], v[52:55], v[240:255]
    v_cvt_pk_bf16_f32 v21, v222, v223
    v_lshlrev_b32 v22, 16, v20
    v_and_b32 v23, 0xffff0000, v20
    v_mul_f32 v24, v22, v22
    ds_read_b64_tr_b16 v[48:49], v12 offset:36864
    ds_read_b64_tr_b16 v[50:51], v12 offset:37632
    ds_read_b64_tr_b16 v[52:53], v12 offset:36928
    ds_read_b64_tr_b16 v[54:55], v12 offset:37696
    s_waitcnt vmcnt(8) lgkmcnt(4)
    v_mfma_f32_32x32x16_bf16 v[160:175], v[88:91], v[56:59], v[160:175]
    v_mul_f32 v25, v23, v23
    v_fma_f32 v24, v24, s44, v16
    v_fma_f32 v25, v25, s44, v16
    v_mul_f32 v24, v24, v22
    v_mfma_f32_32x32x16_bf16 v[176:191], v[88:91], v[60:63], v[176:191]
    v_mul_f32 v25, v25, v23
    v_exp_f32 v24, v24
    v_exp_f32 v25, v25
    s_nop 0
    v_mfma_f32_32x32x16_bf16 v[224:239], v[92:95], v[56:59], v[224:239]
    v_add_f32 v24, 1.0, v24
    v_add_f32 v25, 1.0, v25
    v_rcp_f32 v24, v24
    v_rcp_f32 v25, v25
    v_mfma_f32_32x32x16_bf16 v[240:255], v[92:95], v[60:63], v[240:255]
    s_nop 0
    v_mul_f32 v24, v24, v22
    v_mul_f32 v25, v25, v23
    v_cvt_pk_bf16_f32 v24, v24, v25
    ds_read_b64_tr_b16 v[56:57], v12 offset:39936
    ds_read_b64_tr_b16 v[58:59], v12 offset:40704
    ds_read_b64_tr_b16 v[60:61], v12 offset:40000
    ds_read_b64_tr_b16 v[62:63], v12 offset:40768
    s_waitcnt vmcnt(6) lgkmcnt(4)
    v_mfma_f32_32x32x16_bf16 v[160:175], v[96:99], v[48:51], v[160:175]
    v_lshlrev_b32 v22, 16, v24
    v_and_b32 v23, 0xffff0000, v24
    v_lshlrev_b32 v24, 16, v21
    v_and_b32 v25, 0xffff0000, v21
    v_mfma_f32_32x32x16_bf16 v[176:191], v[96:99], v[52:55], v[176:191]
    v_mul_f32 v22, v22, v24
    v_mul_f32 v23, v23, v25
    v_cvt_pk_bf16_f32 v29, v22, v23
    buffer_store_dwordx2 v[28:29], v13, s[28:31], s46 offen offset:1536
    v_mfma_f32_32x32x16_bf16 v[224:239], v[100:103], v[48:51], v[224:239]
    v_mfma_f32_32x32x16_bf16 v[240:255], v[100:103], v[52:55], v[240:255]
    ds_read_b64_tr_b16 v[48:49], v12 offset:43008
    ds_read_b64_tr_b16 v[50:51], v12 offset:43776
    ds_read_b64_tr_b16 v[52:53], v12 offset:43072
    ds_read_b64_tr_b16 v[54:55], v12 offset:43840
    s_waitcnt vmcnt(4) lgkmcnt(4)
    v_mfma_f32_32x32x16_bf16 v[160:175], v[104:107], v[56:59], v[160:175]
    v_mfma_f32_32x32x16_bf16 v[176:191], v[104:107], v[60:63], v[176:191]
    v_mfma_f32_32x32x16_bf16 v[224:239], v[108:111], v[56:59], v[224:239]
    v_mfma_f32_32x32x16_bf16 v[240:255], v[108:111], v[60:63], v[240:255]
    ds_read_b64_tr_b16 v[56:57], v12 offset:46080
    ds_read_b64_tr_b16 v[58:59], v12 offset:46848
    ds_read_b64_tr_b16 v[60:61], v12 offset:46144
    ds_read_b64_tr_b16 v[62:63], v12 offset:46912
    s_waitcnt vmcnt(2) lgkmcnt(4)
    v_mfma_f32_32x32x16_bf16 v[160:175], v[112:115], v[48:51], v[160:175]
    v_mfma_f32_32x32x16_bf16 v[176:191], v[112:115], v[52:55], v[176:191]
    v_mfma_f32_32x32x16_bf16 v[224:239], v[116:119], v[48:51], v[224:239]
    v_mfma_f32_32x32x16_bf16 v[240:255], v[116:119], v[52:55], v[240:255]
    s_waitcnt vmcnt(0) lgkmcnt(0)
    v_mfma_f32_32x32x16_bf16 v[160:175], v[120:123], v[56:59], v[160:175]
    v_mfma_f32_32x32x16_bf16 v[176:191], v[120:123], v[60:63], v[176:191]
    v_mfma_f32_32x32x16_bf16 v[224:239], v[124:127], v[56:59], v[224:239]
    v_mfma_f32_32x32x16_bf16 v[240:255], v[124:127], v[60:63], v[240:255]
    s_nop 7
    s_nop 7
    v_cvt_pk_bf16_f32 v20, v160, v161
    v_cvt_pk_bf16_f32 v21, v224, v225
    v_lshlrev_b32 v22, 16, v20
    v_and_b32 v23, 0xffff0000, v20
    v_mul_f32 v24, v22, v22
    v_mul_f32 v25, v23, v23
    v_fma_f32 v24, v24, s44, v16
    v_fma_f32 v25, v25, s44, v16
    v_mul_f32 v24, v24, v22
    v_mul_f32 v25, v25, v23
    v_exp_f32 v24, v24
    v_exp_f32 v25, v25
    s_nop 0
    v_add_f32 v24, 1.0, v24
    v_add_f32 v25, 1.0, v25
    v_rcp_f32 v24, v24
    v_rcp_f32 v25, v25
    s_nop 0
    v_mul_f32 v24, v24, v22
    v_mul_f32 v25, v25, v23
    v_cvt_pk_bf16_f32 v24, v24, v25
    v_lshlrev_b32 v22, 16, v24
    v_and_b32 v23, 0xffff0000, v24
    v_lshlrev_b32 v24, 16, v21
    v_and_b32 v25, 0xffff0000, v21
    v_mul_f32 v22, v22, v24
    v_mul_f32 v23, v23, v25
    v_cvt_pk_bf16_f32 v26, v22, v23
    v_cvt_pk_bf16_f32 v20, v162, v163
    v_cvt_pk_bf16_f32 v21, v226, v227
    v_lshlrev_b32 v22, 16, v20
    v_and_b32 v23, 0xffff0000, v20
    v_mul_f32 v24, v22, v22
    v_mul_f32 v25, v23, v23
    v_fma_f32 v24, v24, s44, v16
    v_fma_f32 v25, v25, s44, v16
    v_mul_f32 v24, v24, v22
    v_mul_f32 v25, v25, v23
    v_exp_f32 v24, v24
    v_exp_f32 v25, v25
    s_nop 0
    v_add_f32 v24, 1.0, v24
    v_add_f32 v25, 1.0, v25
    v_rcp_f32 v24, v24
    v_rcp_f32 v25, v25
    s_nop 0
    v_mul_f32 v24, v24, v22
    v_mul_f32 v25, v25, v23
    v_cvt_pk_bf16_f32 v24, v24, v25
    v_lshlrev_b32 v22, 16, v24
    v_and_b32 v23, 0xffff0000, v24
    v_lshlrev_b32 v24, 16, v21
    v_and_b32 v25, 0xffff0000, v21
    v_mul_f32 v22, v22, v24
    v_mul_f32 v23, v23, v25
    v_cvt_pk_bf16_f32 v27, v22, v23
    buffer_store_dwordx2 v[26:27], v13, s[28:31], s45 offen offset:2048
    v_cvt_pk_bf16_f32 v20, v164, v165
    v_cvt_pk_bf16_f32 v21, v228, v229
    v_lshlrev_b32 v22, 16, v20
    v_and_b32 v23, 0xffff0000, v20
    v_mul_f32 v24, v22, v22
    v_mul_f32 v25, v23, v23
    v_fma_f32 v24, v24, s44, v16
    v_fma_f32 v25, v25, s44, v16
    v_mul_f32 v24, v24, v22
    v_mul_f32 v25, v25, v23
    v_exp_f32 v24, v24
    v_exp_f32 v25, v25
    s_nop 0
    v_add_f32 v24, 1.0, v24
    v_add_f32 v25, 1.0, v25
    v_rcp_f32 v24, v24
    v_rcp_f32 v25, v25
    s_nop 0
    v_mul_f32 v24, v24, v22
    v_mul_f32 v25, v25, v23
    v_cvt_pk_bf16_f32 v24, v24, v25
    v_lshlrev_b32 v22, 16, v24
    v_and_b32 v23, 0xffff0000, v24
    v_lshlrev_b32 v24, 16, v21
    v_and_b32 v25, 0xffff0000, v21
    v_mul_f32 v22, v22, v24
    v_mul_f32 v23, v23, v25
    v_cvt_pk_bf16_f32 v28, v22, v23
    v_cvt_pk_bf16_f32 v20, v166, v167
    v_cvt_pk_bf16_f32 v21, v230, v231
    v_lshlrev_b32 v22, 16, v20
    v_and_b32 v23, 0xffff0000, v20
    v_mul_f32 v24, v22, v22
    v_mul_f32 v25, v23, v23
    v_fma_f32 v24, v24, s44, v16
    v_fma_f32 v25, v25, s44, v16
    v_mul_f32 v24, v24, v22
    v_mul_f32 v25, v25, v23
    v_exp_f32 v24, v24
    v_exp_f32 v25, v25
    s_nop 0
    v_add_f32 v24, 1.0, v24
    v_add_f32 v25, 1.0, v25
    v_rcp_f32 v24, v24
    v_rcp_f32 v25, v25
    s_nop 0
    v_mul_f32 v24, v24, v22
    v_mul_f32 v25, v25, v23
    v_cvt_pk_bf16_f32 v24, v24, v25
    v_lshlrev_b32 v22, 16, v24
    v_and_b32 v23, 0xffff0000, v24
    v_lshlrev_b32 v24, 16, v21
    v_and_b32 v25, 0xffff0000, v21
    v_mul_f32 v22, v22, v24
    v_mul_f32 v23, v23, v25
    v_cvt_pk_bf16_f32 v29, v22, v23
    buffer_store_dwordx2 v[28:29], v13, s[28:31], s45 offen offset:2560
    v_cvt_pk_bf16_f32 v20, v168, v169
    v_cvt_pk_bf16_f32 v21, v232, v233
    v_lshlrev_b32 v22, 16, v20
    v_and_b32 v23, 0xffff0000, v20
    v_mul_f32 v24, v22, v22
    v_mul_f32 v25, v23, v23
    v_fma_f32 v24, v24, s44, v16
    v_fma_f32 v25, v25, s44, v16
    v_mul_f32 v24, v24, v22
    v_mul_f32 v25, v25, v23
    v_exp_f32 v24, v24
    v_exp_f32 v25, v25
    s_nop 0
    v_add_f32 v24, 1.0, v24
    v_add_f32 v25, 1.0, v25
    v_rcp_f32 v24, v24
    v_rcp_f32 v25, v25
    s_nop 0
    v_mul_f32 v24, v24, v22
    v_mul_f32 v25, v25, v23
    v_cvt_pk_bf16_f32 v24, v24, v25
    v_lshlrev_b32 v22, 16, v24
    v_and_b32 v23, 0xffff0000, v24
    v_lshlrev_b32 v24, 16, v21
    v_and_b32 v25, 0xffff0000, v21
    v_mul_f32 v22, v22, v24
    v_mul_f32 v23, v23, v25
    v_cvt_pk_bf16_f32 v26, v22, v23
    v_cvt_pk_bf16_f32 v20, v170, v171
    v_cvt_pk_bf16_f32 v21, v234, v235
    v_lshlrev_b32 v22, 16, v20
    v_and_b32 v23, 0xffff0000, v20
    v_mul_f32 v24, v22, v22
    v_mul_f32 v25, v23, v23
    v_fma_f32 v24, v24, s44, v16
    v_fma_f32 v25, v25, s44, v16
    v_mul_f32 v24, v24, v22
    v_mul_f32 v25, v25, v23
    v_exp_f32 v24, v24
    v_exp_f32 v25, v25
    s_nop 0
    v_add_f32 v24, 1.0, v24
    v_add_f32 v25, 1.0, v25
    v_rcp_f32 v24, v24
    v_rcp_f32 v25, v25
    s_nop 0
    v_mul_f32 v24, v24, v22
    v_mul_f32 v25, v25, v23
    v_cvt_pk_bf16_f32 v24, v24, v25
    v_lshlrev_b32 v22, 16, v24
    v_and_b32 v23, 0xffff0000, v24
    v_lshlrev_b32 v24, 16, v21
    v_and_b32 v25, 0xffff0000, v21
    v_mul_f32 v22, v22, v24
    v_mul_f32 v23, v23, v25
    v_cvt_pk_bf16_f32 v27, v22, v23
    buffer_store_dwordx2 v[26:27], v13, s[28:31], s45 offen offset:3072
    v_cvt_pk_bf16_f32 v20, v172, v173
    v_cvt_pk_bf16_f32 v21, v236, v237
    v_lshlrev_b32 v22, 16, v20
    v_and_b32 v23, 0xffff0000, v20
    v_mul_f32 v24, v22, v22
    v_mul_f32 v25, v23, v23
    v_fma_f32 v24, v24, s44, v16
    v_fma_f32 v25, v25, s44, v16
    v_mul_f32 v24, v24, v22
    v_mul_f32 v25, v25, v23
    v_exp_f32 v24, v24
    v_exp_f32 v25, v25
    s_nop 0
    v_add_f32 v24, 1.0, v24
    v_add_f32 v25, 1.0, v25
    v_rcp_f32 v24, v24
    v_rcp_f32 v25, v25
    s_nop 0
    v_mul_f32 v24, v24, v22
    v_mul_f32 v25, v25, v23
    v_cvt_pk_bf16_f32 v24, v24, v25
    v_lshlrev_b32 v22, 16, v24
    v_and_b32 v23, 0xffff0000, v24
    v_lshlrev_b32 v24, 16, v21
    v_and_b32 v25, 0xffff0000, v21
    v_mul_f32 v22, v22, v24
    v_mul_f32 v23, v23, v25
    v_cvt_pk_bf16_f32 v28, v22, v23
    v_cvt_pk_bf16_f32 v20, v174, v175
    v_cvt_pk_bf16_f32 v21, v238, v239
    v_lshlrev_b32 v22, 16, v20
    v_and_b32 v23, 0xffff0000, v20
    v_mul_f32 v24, v22, v22
    v_mul_f32 v25, v23, v23
    v_fma_f32 v24, v24, s44, v16
    v_fma_f32 v25, v25, s44, v16
    v_mul_f32 v24, v24, v22
    v_mul_f32 v25, v25, v23
    v_exp_f32 v24, v24
    v_exp_f32 v25, v25
    s_nop 0
    v_add_f32 v24, 1.0, v24
    v_add_f32 v25, 1.0, v25
    v_rcp_f32 v24, v24
    v_rcp_f32 v25, v25
    s_nop 0
    v_mul_f32 v24, v24, v22
    v_mul_f32 v25, v25, v23
    v_cvt_pk_bf16_f32 v24, v24, v25
    v_lshlrev_b32 v22, 16, v24
    v_and_b32 v23, 0xffff0000, v24
    v_lshlrev_b32 v24, 16, v21
    v_and_b32 v25, 0xffff0000, v21
    v_mul_f32 v22, v22, v24
    v_mul_f32 v23, v23, v25
    v_cvt_pk_bf16_f32 v29, v22, v23
    buffer_store_dwordx2 v[28:29], v13, s[28:31], s45 offen offset:3584
    v_cvt_pk_bf16_f32 v20, v176, v177
    v_cvt_pk_bf16_f32 v21, v240, v241
    v_lshlrev_b32 v22, 16, v20
    v_and_b32 v23, 0xffff0000, v20
    v_mul_f32 v24, v22, v22
    v_mul_f32 v25, v23, v23
    v_fma_f32 v24, v24, s44, v16
    v_fma_f32 v25, v25, s44, v16
    v_mul_f32 v24, v24, v22
    v_mul_f32 v25, v25, v23
    v_exp_f32 v24, v24
    v_exp_f32 v25, v25
    s_nop 0
    v_add_f32 v24, 1.0, v24
    v_add_f32 v25, 1.0, v25
    v_rcp_f32 v24, v24
    v_rcp_f32 v25, v25
    s_nop 0
    v_mul_f32 v24, v24, v22
    v_mul_f32 v25, v25, v23
    v_cvt_pk_bf16_f32 v24, v24, v25
    v_lshlrev_b32 v22, 16, v24
    v_and_b32 v23, 0xffff0000, v24
    v_lshlrev_b32 v24, 16, v21
    v_and_b32 v25, 0xffff0000, v21
    v_mul_f32 v22, v22, v24
    v_mul_f32 v23, v23, v25
    v_cvt_pk_bf16_f32 v26, v22, v23
    v_cvt_pk_bf16_f32 v20, v178, v179
    v_cvt_pk_bf16_f32 v21, v242, v243
    v_lshlrev_b32 v22, 16, v20
    v_and_b32 v23, 0xffff0000, v20
    v_mul_f32 v24, v22, v22
    v_mul_f32 v25, v23, v23
    v_fma_f32 v24, v24, s44, v16
    v_fma_f32 v25, v25, s44, v16
    v_mul_f32 v24, v24, v22
    v_mul_f32 v25, v25, v23
    v_exp_f32 v24, v24
    v_exp_f32 v25, v25
    s_nop 0
    v_add_f32 v24, 1.0, v24
    v_add_f32 v25, 1.0, v25
    v_rcp_f32 v24, v24
    v_rcp_f32 v25, v25
    s_nop 0
    v_mul_f32 v24, v24, v22
    v_mul_f32 v25, v25, v23
    v_cvt_pk_bf16_f32 v24, v24, v25
    v_lshlrev_b32 v22, 16, v24
    v_and_b32 v23, 0xffff0000, v24
    v_lshlrev_b32 v24, 16, v21
    v_and_b32 v25, 0xffff0000, v21
    v_mul_f32 v22, v22, v24
    v_mul_f32 v23, v23, v25
    v_cvt_pk_bf16_f32 v27, v22, v23
    buffer_store_dwordx2 v[26:27], v13, s[28:31], s46 offen offset:2048
    v_cvt_pk_bf16_f32 v20, v180, v181
    v_cvt_pk_bf16_f32 v21, v244, v245
    v_lshlrev_b32 v22, 16, v20
    v_and_b32 v23, 0xffff0000, v20
    v_mul_f32 v24, v22, v22
    v_mul_f32 v25, v23, v23
    v_fma_f32 v24, v24, s44, v16
    v_fma_f32 v25, v25, s44, v16
    v_mul_f32 v24, v24, v22
    v_mul_f32 v25, v25, v23
    v_exp_f32 v24, v24
    v_exp_f32 v25, v25
    s_nop 0
    v_add_f32 v24, 1.0, v24
    v_add_f32 v25, 1.0, v25
    v_rcp_f32 v24, v24
    v_rcp_f32 v25, v25
    s_nop 0
    v_mul_f32 v24, v24, v22
    v_mul_f32 v25, v25, v23
    v_cvt_pk_bf16_f32 v24, v24, v25
    v_lshlrev_b32 v22, 16, v24
    v_and_b32 v23, 0xffff0000, v24
    v_lshlrev_b32 v24, 16, v21
    v_and_b32 v25, 0xffff0000, v21
    v_mul_f32 v22, v22, v24
    v_mul_f32 v23, v23, v25
    v_cvt_pk_bf16_f32 v28, v22, v23
    v_cvt_pk_bf16_f32 v20, v182, v183
    v_cvt_pk_bf16_f32 v21, v246, v247
    v_lshlrev_b32 v22, 16, v20
    v_and_b32 v23, 0xffff0000, v20
    v_mul_f32 v24, v22, v22
    v_mul_f32 v25, v23, v23
    v_fma_f32 v24, v24, s44, v16
    v_fma_f32 v25, v25, s44, v16
    v_mul_f32 v24, v24, v22
    v_mul_f32 v25, v25, v23
    v_exp_f32 v24, v24
    v_exp_f32 v25, v25
    s_nop 0
    v_add_f32 v24, 1.0, v24
    v_add_f32 v25, 1.0, v25
    v_rcp_f32 v24, v24
    v_rcp_f32 v25, v25
    s_nop 0
    v_mul_f32 v24, v24, v22
    v_mul_f32 v25, v25, v23
    v_cvt_pk_bf16_f32 v24, v24, v25
    v_lshlrev_b32 v22, 16, v24
    v_and_b32 v23, 0xffff0000, v24
    v_lshlrev_b32 v24, 16, v21
    v_and_b32 v25, 0xffff0000, v21
    v_mul_f32 v22, v22, v24
    v_mul_f32 v23, v23, v25
    v_cvt_pk_bf16_f32 v29, v22, v23
    buffer_store_dwordx2 v[28:29], v13, s[28:31], s46 offen offset:2560
    v_cvt_pk_bf16_f32 v20, v184, v185
    v_cvt_pk_bf16_f32 v21, v248, v249
    v_lshlrev_b32 v22, 16, v20
    v_and_b32 v23, 0xffff0000, v20
    v_mul_f32 v24, v22, v22
    v_mul_f32 v25, v23, v23
    v_fma_f32 v24, v24, s44, v16
    v_fma_f32 v25, v25, s44, v16
    v_mul_f32 v24, v24, v22
    v_mul_f32 v25, v25, v23
    v_exp_f32 v24, v24
    v_exp_f32 v25, v25
    s_nop 0
    v_add_f32 v24, 1.0, v24
    v_add_f32 v25, 1.0, v25
    v_rcp_f32 v24, v24
    v_rcp_f32 v25, v25
    s_nop 0
    v_mul_f32 v24, v24, v22
    v_mul_f32 v25, v25, v23
    v_cvt_pk_bf16_f32 v24, v24, v25
    v_lshlrev_b32 v22, 16, v24
    v_and_b32 v23, 0xffff0000, v24
    v_lshlrev_b32 v24, 16, v21
    v_and_b32 v25, 0xffff0000, v21
    v_mul_f32 v22, v22, v24
    v_mul_f32 v23, v23, v25
    v_cvt_pk_bf16_f32 v26, v22, v23
    v_cvt_pk_bf16_f32 v20, v186, v187
    v_cvt_pk_bf16_f32 v21, v250, v251
    v_lshlrev_b32 v22, 16, v20
    v_and_b32 v23, 0xffff0000, v20
    v_mul_f32 v24, v22, v22
    v_mul_f32 v25, v23, v23
    v_fma_f32 v24, v24, s44, v16
    v_fma_f32 v25, v25, s44, v16
    v_mul_f32 v24, v24, v22
    v_mul_f32 v25, v25, v23
    v_exp_f32 v24, v24
    v_exp_f32 v25, v25
    s_nop 0
    v_add_f32 v24, 1.0, v24
    v_add_f32 v25, 1.0, v25
    v_rcp_f32 v24, v24
    v_rcp_f32 v25, v25
    s_nop 0
    v_mul_f32 v24, v24, v22
    v_mul_f32 v25, v25, v23
    v_cvt_pk_bf16_f32 v24, v24, v25
    v_lshlrev_b32 v22, 16, v24
    v_and_b32 v23, 0xffff0000, v24
    v_lshlrev_b32 v24, 16, v21
    v_and_b32 v25, 0xffff0000, v21
    v_mul_f32 v22, v22, v24
    v_mul_f32 v23, v23, v25
    v_cvt_pk_bf16_f32 v27, v22, v23
    buffer_store_dwordx2 v[26:27], v13, s[28:31], s46 offen offset:3072
    v_cvt_pk_bf16_f32 v20, v188, v189
    v_cvt_pk_bf16_f32 v21, v252, v253
    v_lshlrev_b32 v22, 16, v20
    v_and_b32 v23, 0xffff0000, v20
    v_mul_f32 v24, v22, v22
    v_mul_f32 v25, v23, v23
    v_fma_f32 v24, v24, s44, v16
    v_fma_f32 v25, v25, s44, v16
    v_mul_f32 v24, v24, v22
    v_mul_f32 v25, v25, v23
    v_exp_f32 v24, v24
    v_exp_f32 v25, v25
    s_nop 0
    v_add_f32 v24, 1.0, v24
    v_add_f32 v25, 1.0, v25
    v_rcp_f32 v24, v24
    v_rcp_f32 v25, v25
    s_nop 0
    v_mul_f32 v24, v24, v22
    v_mul_f32 v25, v25, v23
    v_cvt_pk_bf16_f32 v24, v24, v25
    v_lshlrev_b32 v22, 16, v24
    v_and_b32 v23, 0xffff0000, v24
    v_lshlrev_b32 v24, 16, v21
    v_and_b32 v25, 0xffff0000, v21
    v_mul_f32 v22, v22, v24
    v_mul_f32 v23, v23, v25
    v_cvt_pk_bf16_f32 v28, v22, v23
    v_cvt_pk_bf16_f32 v20, v190, v191
    v_cvt_pk_bf16_f32 v21, v254, v255
    v_lshlrev_b32 v22, 16, v20
    v_and_b32 v23, 0xffff0000, v20
    v_mul_f32 v24, v22, v22
    v_mul_f32 v25, v23, v23
    v_fma_f32 v24, v24, s44, v16
    v_fma_f32 v25, v25, s44, v16
    v_mul_f32 v24, v24, v22
    v_mul_f32 v25, v25, v23
    v_exp_f32 v24, v24
    v_exp_f32 v25, v25
    s_nop 0
    v_add_f32 v24, 1.0, v24
    v_add_f32 v25, 1.0, v25
    v_rcp_f32 v24, v24
    v_rcp_f32 v25, v25
    s_nop 0
    v_mul_f32 v24, v24, v22
    v_mul_f32 v25, v25, v23
    v_cvt_pk_bf16_f32 v24, v24, v25
    v_lshlrev_b32 v22, 16, v24
    v_and_b32 v23, 0xffff0000, v24
    v_lshlrev_b32 v24, 16, v21
    v_and_b32 v25, 0xffff0000, v21
    v_mul_f32 v22, v22, v24
    v_mul_f32 v23, v23, v25
    v_cvt_pk_bf16_f32 v29, v22, v23
    buffer_store_dwordx2 v[28:29], v13, s[28:31], s46 offen offset:3584
g1_done:
    s_endpgm
.globl gemm2a_kernel
.p2align 8
.type gemm2a_kernel,@function
gemm2a_kernel:
    s_mov_b32 s20, 0
    s_mov_b32 s23, 0x0
    s_branch g2_common
.globl gemm2b_kernel
.p2align 8
.type gemm2b_kernel,@function
gemm2b_kernel:
    s_mov_b32 s20, 1
    s_mov_b32 s23, 0x400000
g2_common:
    s_cmp_ge_u32 s2, 256
    s_cbranch_scc1 g2_done
    s_load_dwordx2 s[6:7], s[0:1], 120
    s_load_dwordx2 s[8:9], s[0:1], 104
    s_and_b32 s21, s2, 31
    s_lshr_b32 s22, s2, 5
    v_and_b32 v4, 63, v0
    v_lshrrev_b32 v5, 6, v0
    v_mul_u32_u24 v6, 28672, v5
    v_lshl_add_u32 v6, v4, 4, v6
    s_mul_i32 s48, s21, 229376
    s_add_u32 s48, s48, 0x800000
    s_add_u32 s49, s48, 114688
    s_mul_i32 s50, s22, 229376
    s_add_u32 s50, s50, 0x1a00000
    s_add_u32 s51, s50, 114688
    s_waitcnt lgkmcnt(0)
    s_mov_b32 s28, s6
    s_mov_b32 s29, s7
    s_mov_b32 s30, 0x1c00000
    s_mov_b32 s31, 0x00020000
    buffer_load_dwordx4 v[64:67], v6, s[28:31], s48 offen
    buffer_load_dwordx4 v[68:71], v6, s[28:31], s49 offen
    buffer_load_dwordx4 v[72:75], v6, s[28:31], s50 offen
    buffer_load_dwordx4 v[76:79], v6, s[28:31], s51 offen
    s_add_u32 s48, s48, 1024
    s_add_u32 s49, s49, 1024
    s_add_u32 s50, s50, 1024
    s_add_u32 s51, s51, 1024
    buffer_load_dwordx4 v[80:83], v6, s[28:31], s48 offen
    buffer_load_dwordx4 v[84:87], v6, s[28:31], s49 offen
    buffer_load_dwordx4 v[88:91], v6, s[28:31], s50 offen
    buffer_load_dwordx4 v[92:95], v6, s[28:31], s51 offen
    s_add_u32 s48, s48, 1024
    s_add_u32 s49, s49, 1024
    s_add_u32 s50, s50, 1024
    s_add_u32 s51, s51, 1024
    buffer_load_dwordx4 v[96:99], v6, s[28:31], s48 offen
    buffer_load_dwordx4 v[100:103], v6, s[28:31], s49 offen
    buffer_load_dwordx4 v[104:107], v6, s[28:31], s50 offen
    buffer_load_dwordx4 v[108:111], v6, s[28:31], s51 offen
    s_add_u32 s48, s48, 1024
    s_add_u32 s49, s49, 1024
    s_add_u32 s50, s50, 1024
    s_add_u32 s51, s51, 1024
    buffer_load_dwordx4 v[112:115], v6, s[28:31], s48 offen
    buffer_load_dwordx4 v[116:119], v6, s[28:31], s49 offen
    buffer_load_dwordx4 v[120:123], v6, s[28:31], s50 offen
    buffer_load_dwordx4 v[124:127], v6, s[28:31], s51 offen
    s_add_u32 s48, s48, 1024
    s_add_u32 s49, s49, 1024
    s_add_u32 s50, s50, 1024
    s_add_u32 s51, s51, 1024
    buffer_load_dwordx4 v[128:131], v6, s[28:31], s48 offen
    buffer_load_dwordx4 v[132:135], v6, s[28:31], s49 offen
    buffer_load_dwordx4 v[136:139], v6, s[28:31], s50 offen
    buffer_load_dwordx4 v[140:143], v6, s[28:31], s51 offen
    s_add_u32 s48, s48, 1024
    s_add_u32 s49, s49, 1024
    s_add_u32 s50, s50, 1024
    s_add_u32 s51, s51, 1024
    buffer_load_dwordx4 v[144:147], v6, s[28:31], s48 offen
    buffer_load_dwordx4 v[148:151], v6, s[28:31], s49 offen
    buffer_load_dwordx4 v[152:155], v6, s[28:31], s50 offen
    buffer_load_dwordx4 v[156:159], v6, s[28:31], s51 offen
    s_add_u32 s48, s48, 1024
    s_add_u32 s49, s49, 1024
    s_add_u32 s50, s50, 1024
    s_add_u32 s51, s51, 1024
    v_lshrrev_b32 v1, 3, v0
    v_and_b32 v2, 7, v0
    s_lshl_b32 s3, s22, 6
    v_add_u32 v3, s3, v1
    v_lshlrev_b32 v3, 12, v3
    v_lshl_add_u32 v3, v2, 4, v3
    s_lshl_b32 s3, s21, 7
    s_add_u32 s3, s3, s23
    s_add_u32 s4, s3, 131072
    buffer_load_dwordx4 v[224:227], v3, s[28:31], s3 offen
    buffer_load_dwordx4 v[228:231], v3, s[28:31], s4 offen
    v_mov_b32 v160, 0
    v_mov_b32 v161, 0
    v_mov_b32 v162, 0
    v_mov_b32 v163, 0
    v_mov_b32 v164, 0
    v_mov_b32 v165, 0
    v_mov_b32 v166, 0
    v_mov_b32 v167, 0
    v_mov_b32 v168, 0
    v_mov_b32 v169, 0
    v_mov_b32 v170, 0
    v_mov_b32 v171, 0
    v_mov_b32 v172, 0
    v_mov_b32 v173, 0
    v_mov_b32 v174, 0
    v_mov_b32 v175, 0
    v_mov_b32 v176, 0
    v_mov_b32 v177, 0
    v_mov_b32 v178, 0
    v_mov_b32 v179, 0
    v_mov_b32 v180, 0
    v_mov_b32 v181, 0
    v_mov_b32 v182, 0
    v_mov_b32 v183, 0
    v_mov_b32 v184, 0
    v_mov_b32 v185, 0
    v_mov_b32 v186, 0
    v_mov_b32 v187, 0
    v_mov_b32 v188, 0
    v_mov_b32 v189, 0
    v_mov_b32 v190, 0
    v_mov_b32 v191, 0
    v_mov_b32 v192, 0
    v_mov_b32 v193, 0
    v_mov_b32 v194, 0
    v_mov_b32 v195, 0
    v_mov_b32 v196, 0
    v_mov_b32 v197, 0
    v_mov_b32 v198, 0
    v_mov_b32 v199, 0
    v_mov_b32 v200, 0
    v_mov_b32 v201, 0
    v_mov_b32 v202, 0
    v_mov_b32 v203, 0
    v_mov_b32 v204, 0
    v_mov_b32 v205, 0
    v_mov_b32 v206, 0
    v_mov_b32 v207, 0
    v_mov_b32 v208, 0
    v_mov_b32 v209, 0
    v_mov_b32 v210, 0
    v_mov_b32 v211, 0
    v_mov_b32 v212, 0
    v_mov_b32 v213, 0
    v_mov_b32 v214, 0
    v_mov_b32 v215, 0
    v_mov_b32 v216, 0
    v_mov_b32 v217, 0
    v_mov_b32 v218, 0
    v_mov_b32 v219, 0
    v_mov_b32 v220, 0
    v_mov_b32 v221, 0
    v_mov_b32 v222, 0
    v_mov_b32 v223, 0
    s_waitcnt vmcnt(22)
    v_mfma_f32_32x32x16_bf16 v[160:175], v[64:67], v[72:75], v[160:175]
    v_mfma_f32_32x32x16_bf16 v[176:191], v[64:67], v[76:79], v[176:191]
    v_mfma_f32_32x32x16_bf16 v[192:207], v[68:71], v[72:75], v[192:207]
    v_mfma_f32_32x32x16_bf16 v[208:223], v[68:71], v[76:79], v[208:223]
    buffer_load_dwordx4 v[64:67], v6, s[28:31], s48 offen
    buffer_load_dwordx4 v[68:71], v6, s[28:31], s49 offen
    buffer_load_dwordx4 v[72:75], v6, s[28:31], s50 offen
    buffer_load_dwordx4 v[76:79], v6, s[28:31], s51 offen
    s_add_u32 s48, s48, 1024
    s_add_u32 s49, s49, 1024
    s_add_u32 s50, s50, 1024
    s_add_u32 s51, s51, 1024
    s_waitcnt vmcnt(20)
    v_mfma_f32_32x32x16_bf16 v[160:175], v[80:83], v[88:91], v[160:175]
    v_mfma_f32_32x32x16_bf16 v[176:191], v[80:83], v[92:95], v[176:191]
    v_mfma_f32_32x32x16_bf16 v[192:207], v[84:87], v[88:91], v[192:207]
    v_mfma_f32_32x32x16_bf16 v[208:223], v[84:87], v[92:95], v[208:223]
    buffer_load_dwordx4 v[80:83], v6, s[28:31], s48 offen
    buffer_load_dwordx4 v[84:87], v6, s[28:31], s49 offen
    buffer_load_dwordx4 v[88:91], v6, s[28:31], s50 offen
    buffer_load_dwordx4 v[92:95], v6, s[28:31], s51 offen
    s_add_u32 s48, s48, 1024
    s_add_u32 s49, s49, 1024
    s_add_u32 s50, s50, 1024
    s_add_u32 s51, s51, 1024
    s_waitcnt vmcnt(20)
    v_mfma_f32_32x32x16_bf16 v[160:175], v[96:99], v[104:107], v[160:175]
    v_mfma_f32_32x32x16_bf16 v[176:191], v[96:99], v[108:111], v[176:191]
    v_mfma_f32_32x32x16_bf16 v[192:207], v[100:103], v[104:107], v[192:207]
    v_mfma_f32_32x32x16_bf16 v[208:223], v[100:103], v[108:111], v[208:223]
    buffer_load_dwordx4 v[96:99], v6, s[28:31], s48 offen
    buffer_load_dwordx4 v[100:103], v6, s[28:31], s49 offen
    buffer_load_dwordx4 v[104:107], v6, s[28:31], s50 offen
    buffer_load_dwordx4 v[108:111], v6, s[28:31], s51 offen
    s_add_u32 s48, s48, 1024
    s_add_u32 s49, s49, 1024
    s_add_u32 s50, s50, 1024
    s_add_u32 s51, s51, 1024
    s_waitcnt vmcnt(20)
    v_mfma_f32_32x32x16_bf16 v[160:175], v[112:115], v[120:123], v[160:175]
    v_mfma_f32_32x32x16_bf16 v[176:191], v[112:115], v[124:127], v[176:191]
    v_mfma_f32_32x32x16_bf16 v[192:207], v[116:119], v[120:123], v[192:207]
    v_mfma_f32_32x32x16_bf16 v[208:223], v[116:119], v[124:127], v[208:223]
    buffer_load_dwordx4 v[112:115], v6, s[28:31], s48 offen
    buffer_load_dwordx4 v[116:119], v6, s[28:31], s49 offen
    buffer_load_dwordx4 v[120:123], v6, s[28:31], s50 offen
    buffer_load_dwordx4 v[124:127], v6, s[28:31], s51 offen
    s_add_u32 s48, s48, 1024
    s_add_u32 s49, s49, 1024
    s_add_u32 s50, s50, 1024
    s_add_u32 s51, s51, 1024
    s_waitcnt vmcnt(20)
    v_mfma_f32_32x32x16_bf16 v[160:175], v[128:131], v[136:139], v[160:175]
    v_mfma_f32_32x32x16_bf16 v[176:191], v[128:131], v[140:143], v[176:191]
    v_mfma_f32_32x32x16_bf16 v[192:207], v[132:135], v[136:139], v[192:207]
    v_mfma_f32_32x32x16_bf16 v[208:223], v[132:135], v[140:143], v[208:223]
    buffer_load_dwordx4 v[128:131], v6, s[28:31], s48 offen
    buffer_load_dwordx4 v[132:135], v6, s[28:31], s49 offen
    buffer_load_dwordx4 v[136:139], v6, s[28:31], s50 offen
    buffer_load_dwordx4 v[140:143], v6, s[28:31], s51 offen
    s_add_u32 s48, s48, 1024
    s_add_u32 s49, s49, 1024
    s_add_u32 s50, s50, 1024
    s_add_u32 s51, s51, 1024
    s_waitcnt vmcnt(20)
    v_mfma_f32_32x32x16_bf16 v[160:175], v[144:147], v[152:155], v[160:175]
    v_mfma_f32_32x32x16_bf16 v[176:191], v[144:147], v[156:159], v[176:191]
    v_mfma_f32_32x32x16_bf16 v[192:207], v[148:151], v[152:155], v[192:207]
    v_mfma_f32_32x32x16_bf16 v[208:223], v[148:151], v[156:159], v[208:223]
    buffer_load_dwordx4 v[144:147], v6, s[28:31], s48 offen
    buffer_load_dwordx4 v[148:151], v6, s[28:31], s49 offen
    buffer_load_dwordx4 v[152:155], v6, s[28:31], s50 offen
    buffer_load_dwordx4 v[156:159], v6, s[28:31], s51 offen
    s_add_u32 s48, s48, 1024
    s_add_u32 s49, s49, 1024
    s_add_u32 s50, s50, 1024
    s_add_u32 s51, s51, 1024
    s_waitcnt vmcnt(20)
    v_mfma_f32_32x32x16_bf16 v[160:175], v[64:67], v[72:75], v[160:175]
    v_mfma_f32_32x32x16_bf16 v[176:191], v[64:67], v[76:79], v[176:191]
    v_mfma_f32_32x32x16_bf16 v[192:207], v[68:71], v[72:75], v[192:207]
    v_mfma_f32_32x32x16_bf16 v[208:223], v[68:71], v[76:79], v[208:223]
    buffer_load_dwordx4 v[64:67], v6, s[28:31], s48 offen
    buffer_load_dwordx4 v[68:71], v6, s[28:31], s49 offen
    buffer_load_dwordx4 v[72:75], v6, s[28:31], s50 offen
    buffer_load_dwordx4 v[76:79], v6, s[28:31], s51 offen
    s_add_u32 s48, s48, 1024
    s_add_u32 s49, s49, 1024
    s_add_u32 s50, s50, 1024
    s_add_u32 s51, s51, 1024
    s_waitcnt vmcnt(20)
    v_mfma_f32_32x32x16_bf16 v[160:175], v[80:83], v[88:91], v[160:175]
    v_mfma_f32_32x32x16_bf16 v[176:191], v[80:83], v[92:95], v[176:191]
    v_mfma_f32_32x32x16_bf16 v[192:207], v[84:87], v[88:91], v[192:207]
    v_mfma_f32_32x32x16_bf16 v[208:223], v[84:87], v[92:95], v[208:223]
    buffer_load_dwordx4 v[80:83], v6, s[28:31], s48 offen
    buffer_load_dwordx4 v[84:87], v6, s[28:31], s49 offen
    buffer_load_dwordx4 v[88:91], v6, s[28:31], s50 offen
    buffer_load_dwordx4 v[92:95], v6, s[28:31], s51 offen
    s_add_u32 s48, s48, 1024
    s_add_u32 s49, s49, 1024
    s_add_u32 s50, s50, 1024
    s_add_u32 s51, s51, 1024
    s_waitcnt vmcnt(20)
    v_mfma_f32_32x32x16_bf16 v[160:175], v[96:99], v[104:107], v[160:175]
    v_mfma_f32_32x32x16_bf16 v[176:191], v[96:99], v[108:111], v[176:191]
    v_mfma_f32_32x32x16_bf16 v[192:207], v[100:103], v[104:107], v[192:207]
    v_mfma_f32_32x32x16_bf16 v[208:223], v[100:103], v[108:111], v[208:223]
    buffer_load_dwordx4 v[96:99], v6, s[28:31], s48 offen
    buffer_load_dwordx4 v[100:103], v6, s[28:31], s49 offen
    buffer_load_dwordx4 v[104:107], v6, s[28:31], s50 offen
    buffer_load_dwordx4 v[108:111], v6, s[28:31], s51 offen
    s_add_u32 s48, s48, 1024
    s_add_u32 s49, s49, 1024
    s_add_u32 s50, s50, 1024
    s_add_u32 s51, s51, 1024
    s_waitcnt vmcnt(20)
    v_mfma_f32_32x32x16_bf16 v[160:175], v[112:115], v[120:123], v[160:175]
    v_mfma_f32_32x32x16_bf16 v[176:191], v[112:115], v[124:127], v[176:191]
    v_mfma_f32_32x32x16_bf16 v[192:207], v[116:119], v[120:123], v[192:207]
    v_mfma_f32_32x32x16_bf16 v[208:223], v[116:119], v[124:127], v[208:223]
    buffer_load_dwordx4 v[112:115], v6, s[28:31], s48 offen
    buffer_load_dwordx4 v[116:119], v6, s[28:31], s49 offen
    buffer_load_dwordx4 v[120:123], v6, s[28:31], s50 offen
    buffer_load_dwordx4 v[124:127], v6, s[28:31], s51 offen
    s_add_u32 s48, s48, 1024
    s_add_u32 s49, s49, 1024
    s_add_u32 s50, s50, 1024
    s_add_u32 s51, s51, 1024
    s_waitcnt vmcnt(20)
    v_mfma_f32_32x32x16_bf16 v[160:175], v[128:131], v[136:139], v[160:175]
    v_mfma_f32_32x32x16_bf16 v[176:191], v[128:131], v[140:143], v[176:191]
    v_mfma_f32_32x32x16_bf16 v[192:207], v[132:135], v[136:139], v[192:207]
    v_mfma_f32_32x32x16_bf16 v[208:223], v[132:135], v[140:143], v[208:223]
    buffer_load_dwordx4 v[128:131], v6, s[28:31], s48 offen
    buffer_load_dwordx4 v[132:135], v6, s[28:31], s49 offen
    buffer_load_dwordx4 v[136:139], v6, s[28:31], s50 offen
    buffer_load_dwordx4 v[140:143], v6, s[28:31], s51 offen
    s_add_u32 s48, s48, 1024
    s_add_u32 s49, s49, 1024
    s_add_u32 s50, s50, 1024
    s_add_u32 s51, s51, 1024
    s_waitcnt vmcnt(20)
    v_mfma_f32_32x32x16_bf16 v[160:175], v[144:147], v[152:155], v[160:175]
    v_mfma_f32_32x32x16_bf16 v[176:191], v[144:147], v[156:159], v[176:191]
    v_mfma_f32_32x32x16_bf16 v[192:207], v[148:151], v[152:155], v[192:207]
    v_mfma_f32_32x32x16_bf16 v[208:223], v[148:151], v[156:159], v[208:223]
    buffer_load_dwordx4 v[144:147], v6, s[28:31], s48 offen
    buffer_load_dwordx4 v[148:151], v6, s[28:31], s49 offen
    buffer_load_dwordx4 v[152:155], v6, s[28:31], s50 offen
    buffer_load_dwordx4 v[156:159], v6, s[28:31], s51 offen
    s_add_u32 s48, s48, 1024
    s_add_u32 s49, s49, 1024
    s_add_u32 s50, s50, 1024
    s_add_u32 s51, s51, 1024
    s_waitcnt vmcnt(20)
    v_mfma_f32_32x32x16_bf16 v[160:175], v[64:67], v[72:75], v[160:175]
    v_mfma_f32_32x32x16_bf16 v[176:191], v[64:67], v[76:79], v[176:191]
    v_mfma_f32_32x32x16_bf16 v[192:207], v[68:71], v[72:75], v[192:207]
    v_mfma_f32_32x32x16_bf16 v[208:223], v[68:71], v[76:79], v[208:223]
    buffer_load_dwordx4 v[64:67], v6, s[28:31], s48 offen
    buffer_load_dwordx4 v[68:71], v6, s[28:31], s49 offen
    buffer_load_dwordx4 v[72:75], v6, s[28:31], s50 offen
    buffer_load_dwordx4 v[76:79], v6, s[28:31], s51 offen
    s_add_u32 s48, s48, 1024
    s_add_u32 s49, s49, 1024
    s_add_u32 s50, s50, 1024
    s_add_u32 s51, s51, 1024
    s_waitcnt vmcnt(20)
    v_mfma_f32_32x32x16_bf16 v[160:175], v[80:83], v[88:91], v[160:175]
    v_mfma_f32_32x32x16_bf16 v[176:191], v[80:83], v[92:95], v[176:191]
    v_mfma_f32_32x32x16_bf16 v[192:207], v[84:87], v[88:91], v[192:207]
    v_mfma_f32_32x32x16_bf16 v[208:223], v[84:87], v[92:95], v[208:223]
    buffer_load_dwordx4 v[80:83], v6, s[28:31], s48 offen
    buffer_load_dwordx4 v[84:87], v6, s[28:31], s49 offen
    buffer_load_dwordx4 v[88:91], v6, s[28:31], s50 offen
    buffer_load_dwordx4 v[92:95], v6, s[28:31], s51 offen
    s_add_u32 s48, s48, 1024
    s_add_u32 s49, s49, 1024
    s_add_u32 s50, s50, 1024
    s_add_u32 s51, s51, 1024
    s_waitcnt vmcnt(20)
    v_mfma_f32_32x32x16_bf16 v[160:175], v[96:99], v[104:107], v[160:175]
    v_mfma_f32_32x32x16_bf16 v[176:191], v[96:99], v[108:111], v[176:191]
    v_mfma_f32_32x32x16_bf16 v[192:207], v[100:103], v[104:107], v[192:207]
    v_mfma_f32_32x32x16_bf16 v[208:223], v[100:103], v[108:111], v[208:223]
    buffer_load_dwordx4 v[96:99], v6, s[28:31], s48 offen
    buffer_load_dwordx4 v[100:103], v6, s[28:31], s49 offen
    buffer_load_dwordx4 v[104:107], v6, s[28:31], s50 offen
    buffer_load_dwordx4 v[108:111], v6, s[28:31], s51 offen
    s_add_u32 s48, s48, 1024
    s_add_u32 s49, s49, 1024
    s_add_u32 s50, s50, 1024
    s_add_u32 s51, s51, 1024
    s_waitcnt vmcnt(20)
    v_mfma_f32_32x32x16_bf16 v[160:175], v[112:115], v[120:123], v[160:175]
    v_mfma_f32_32x32x16_bf16 v[176:191], v[112:115], v[124:127], v[176:191]
    v_mfma_f32_32x32x16_bf16 v[192:207], v[116:119], v[120:123], v[192:207]
    v_mfma_f32_32x32x16_bf16 v[208:223], v[116:119], v[124:127], v[208:223]
    buffer_load_dwordx4 v[112:115], v6, s[28:31], s48 offen
    buffer_load_dwordx4 v[116:119], v6, s[28:31], s49 offen
    buffer_load_dwordx4 v[120:123], v6, s[28:31], s50 offen
    buffer_load_dwordx4 v[124:127], v6, s[28:31], s51 offen
    s_add_u32 s48, s48, 1024
    s_add_u32 s49, s49, 1024
    s_add_u32 s50, s50, 1024
    s_add_u32 s51, s51, 1024
    s_waitcnt vmcnt(20)
    v_mfma_f32_32x32x16_bf16 v[160:175], v[128:131], v[136:139], v[160:175]
    v_mfma_f32_32x32x16_bf16 v[176:191], v[128:131], v[140:143], v[176:191]
    v_mfma_f32_32x32x16_bf16 v[192:207], v[132:135], v[136:139], v[192:207]
    v_mfma_f32_32x32x16_bf16 v[208:223], v[132:135], v[140:143], v[208:223]
    buffer_load_dwordx4 v[128:131], v6, s[28:31], s48 offen
    buffer_load_dwordx4 v[132:135], v6, s[28:31], s49 offen
    buffer_load_dwordx4 v[136:139], v6, s[28:31], s50 offen
    buffer_load_dwordx4 v[140:143], v6, s[28:31], s51 offen
    s_add_u32 s48, s48, 1024
    s_add_u32 s49, s49, 1024
    s_add_u32 s50, s50, 1024
    s_add_u32 s51, s51, 1024
    s_waitcnt vmcnt(20)
    v_mfma_f32_32x32x16_bf16 v[160:175], v[144:147], v[152:155], v[160:175]
    v_mfma_f32_32x32x16_bf16 v[176:191], v[144:147], v[156:159], v[176:191]
    v_mfma_f32_32x32x16_bf16 v[192:207], v[148:151], v[152:155], v[192:207]
    v_mfma_f32_32x32x16_bf16 v[208:223], v[148:151], v[156:159], v[208:223]
    buffer_load_dwordx4 v[144:147], v6, s[28:31], s48 offen
    buffer_load_dwordx4 v[148:151], v6, s[28:31], s49 offen
    buffer_load_dwordx4 v[152:155], v6, s[28:31], s50 offen
    buffer_load_dwordx4 v[156:159], v6, s[28:31], s51 offen
    s_add_u32 s48, s48, 1024
    s_add_u32 s49, s49, 1024
    s_add_u32 s50, s50, 1024
    s_add_u32 s51, s51, 1024
    s_waitcnt vmcnt(20)
    v_mfma_f32_32x32x16_bf16 v[160:175], v[64:67], v[72:75], v[160:175]
    v_mfma_f32_32x32x16_bf16 v[176:191], v[64:67], v[76:79], v[176:191]
    v_mfma_f32_32x32x16_bf16 v[192:207], v[68:71], v[72:75], v[192:207]
    v_mfma_f32_32x32x16_bf16 v[208:223], v[68:71], v[76:79], v[208:223]
    buffer_load_dwordx4 v[64:67], v6, s[28:31], s48 offen
    buffer_load_dwordx4 v[68:71], v6, s[28:31], s49 offen
    buffer_load_dwordx4 v[72:75], v6, s[28:31], s50 offen
    buffer_load_dwordx4 v[76:79], v6, s[28:31], s51 offen
    s_add_u32 s48, s48, 1024
    s_add_u32 s49, s49, 1024
    s_add_u32 s50, s50, 1024
    s_add_u32 s51, s51, 1024
    s_waitcnt vmcnt(20)
    v_mfma_f32_32x32x16_bf16 v[160:175], v[80:83], v[88:91], v[160:175]
    v_mfma_f32_32x32x16_bf16 v[176:191], v[80:83], v[92:95], v[176:191]
    v_mfma_f32_32x32x16_bf16 v[192:207], v[84:87], v[88:91], v[192:207]
    v_mfma_f32_32x32x16_bf16 v[208:223], v[84:87], v[92:95], v[208:223]
    buffer_load_dwordx4 v[80:83], v6, s[28:31], s48 offen
    buffer_load_dwordx4 v[84:87], v6, s[28:31], s49 offen
    buffer_load_dwordx4 v[88:91], v6, s[28:31], s50 offen
    buffer_load_dwordx4 v[92:95], v6, s[28:31], s51 offen
    s_add_u32 s48, s48, 1024
    s_add_u32 s49, s49, 1024
    s_add_u32 s50, s50, 1024
    s_add_u32 s51, s51, 1024
    s_waitcnt vmcnt(20)
    v_mfma_f32_32x32x16_bf16 v[160:175], v[96:99], v[104:107], v[160:175]
    v_mfma_f32_32x32x16_bf16 v[176:191], v[96:99], v[108:111], v[176:191]
    v_mfma_f32_32x32x16_bf16 v[192:207], v[100:103], v[104:107], v[192:207]
    v_mfma_f32_32x32x16_bf16 v[208:223], v[100:103], v[108:111], v[208:223]
    buffer_load_dwordx4 v[96:99], v6, s[28:31], s48 offen
    buffer_load_dwordx4 v[100:103], v6, s[28:31], s49 offen
    buffer_load_dwordx4 v[104:107], v6, s[28:31], s50 offen
    buffer_load_dwordx4 v[108:111], v6, s[28:31], s51 offen
    s_add_u32 s48, s48, 1024
    s_add_u32 s49, s49, 1024
    s_add_u32 s50, s50, 1024
    s_add_u32 s51, s51, 1024
    s_waitcnt vmcnt(20)
    v_mfma_f32_32x32x16_bf16 v[160:175], v[112:115], v[120:123], v[160:175]
    v_mfma_f32_32x32x16_bf16 v[176:191], v[112:115], v[124:127], v[176:191]
    v_mfma_f32_32x32x16_bf16 v[192:207], v[116:119], v[120:123], v[192:207]
    v_mfma_f32_32x32x16_bf16 v[208:223], v[116:119], v[124:127], v[208:223]
    buffer_load_dwordx4 v[112:115], v6, s[28:31], s48 offen
    buffer_load_dwordx4 v[116:119], v6, s[28:31], s49 offen
    buffer_load_dwordx4 v[120:123], v6, s[28:31], s50 offen
    buffer_load_dwordx4 v[124:127], v6, s[28:31], s51 offen
    s_add_u32 s48, s48, 1024
    s_add_u32 s49, s49, 1024
    s_add_u32 s50, s50, 1024
    s_add_u32 s51, s51, 1024
    s_waitcnt vmcnt(20)
    v_mfma_f32_32x32x16_bf16 v[160:175], v[128:131], v[136:139], v[160:175]
    v_mfma_f32_32x32x16_bf16 v[176:191], v[128:131], v[140:143], v[176:191]
    v_mfma_f32_32x32x16_bf16 v[192:207], v[132:135], v[136:139], v[192:207]
    v_mfma_f32_32x32x16_bf16 v[208:223], v[132:135], v[140:143], v[208:223]
    s_waitcnt vmcnt(16)
    v_mfma_f32_32x32x16_bf16 v[160:175], v[144:147], v[152:155], v[160:175]
    v_mfma_f32_32x32x16_bf16 v[176:191], v[144:147], v[156:159], v[176:191]
    v_mfma_f32_32x32x16_bf16 v[192:207], v[148:151], v[152:155], v[192:207]
    v_mfma_f32_32x32x16_bf16 v[208:223], v[148:151], v[156:159], v[208:223]
    s_waitcnt vmcnt(12)
    v_mfma_f32_32x32x16_bf16 v[160:175], v[64:67], v[72:75], v[160:175]
    v_mfma_f32_32x32x16_bf16 v[176:191], v[64:67], v[76:79], v[176:191]
    v_mfma_f32_32x32x16_bf16 v[192:207], v[68:71], v[72:75], v[192:207]
    v_mfma_f32_32x32x16_bf16 v[208:223], v[68:71], v[76:79], v[208:223]
    s_waitcnt vmcnt(8)
    v_mfma_f32_32x32x16_bf16 v[160:175], v[80:83], v[88:91], v[160:175]
    v_mfma_f32_32x32x16_bf16 v[176:191], v[80:83], v[92:95], v[176:191]
    v_mfma_f32_32x32x16_bf16 v[192:207], v[84:87], v[88:91], v[192:207]
    v_mfma_f32_32x32x16_bf16 v[208:223], v[84:87], v[92:95], v[208:223]
    s_waitcnt vmcnt(4)
    v_mfma_f32_32x32x16_bf16 v[160:175], v[96:99], v[104:107], v[160:175]
    v_mfma_f32_32x32x16_bf16 v[176:191], v[96:99], v[108:111], v[176:191]
    v_mfma_f32_32x32x16_bf16 v[192:207], v[100:103], v[104:107], v[192:207]
    v_mfma_f32_32x32x16_bf16 v[208:223], v[100:103], v[108:111], v[208:223]
    s_waitcnt vmcnt(0)
    v_mfma_f32_32x32x16_bf16 v[160:175], v[112:115], v[120:123], v[160:175]
    v_mfma_f32_32x32x16_bf16 v[176:191], v[112:115], v[124:127], v[176:191]
    v_mfma_f32_32x32x16_bf16 v[192:207], v[116:119], v[120:123], v[192:207]
    v_mfma_f32_32x32x16_bf16 v[208:223], v[116:119], v[124:127], v[208:223]
    v_and_b32 v7, 31, v4
    v_mul_u32_u24 v7, 272, v7
    v_lshrrev_b32 v8, 5, v4
    v_lshl_add_u32 v7, v8, 4, v7
    v_mul_u32_u24 v8, 17408, v5
    v_add_u32 v7, v7, v8
    s_nop 7
    s_nop 7
    ds_write_b128 v7, v[160:163] offset:0
    ds_write_b128 v7, v[164:167] offset:32
    ds_write_b128 v7, v[168:171] offset:64
    ds_write_b128 v7, v[172:175] offset:96
    ds_write_b128 v7, v[176:179] offset:8704
    ds_write_b128 v7, v[180:183] offset:8736
    ds_write_b128 v7, v[184:187] offset:8768
    ds_write_b128 v7, v[188:191] offset:8800
    ds_write_b128 v7, v[192:195] offset:128
    ds_write_b128 v7, v[196:199] offset:160
    ds_write_b128 v7, v[200:203] offset:192
    ds_write_b128 v7, v[204:207] offset:224
    ds_write_b128 v7, v[208:211] offset:8832
    ds_write_b128 v7, v[212:215] offset:8864
    ds_write_b128 v7, v[216:219] offset:8896
    ds_write_b128 v7, v[220:223] offset:8928
    s_waitcnt lgkmcnt(0) vmcnt(0)
    s_barrier
    v_mul_u32_u24 v9, 272, v1
    v_lshl_add_u32 v9, v2, 5, v9
    ds_read_b128 v[64:67], v9 offset:0
    ds_read_b128 v[68:71], v9 offset:16
    ds_read_b128 v[72:75], v9 offset:17408
    ds_read_b128 v[76:79], v9 offset:17424
    ds_read_b128 v[80:83], v9 offset:34816
    ds_read_b128 v[84:87], v9 offset:34832
    ds_read_b128 v[88:91], v9 offset:52224
    ds_read_b128 v[92:95], v9 offset:52240
    ds_read_b128 v[96:99], v9 offset:8704
    ds_read_b128 v[100:103], v9 offset:8720
    ds_read_b128 v[104:107], v9 offset:26112
    ds_read_b128 v[108:111], v9 offset:26128
    ds_read_b128 v[112:115], v9 offset:43520
    ds_read_b128 v[116:119], v9 offset:43536
    ds_read_b128 v[120:123], v9 offset:60928
    ds_read_b128 v[124:127], v9 offset:60944
    s_waitcnt lgkmcnt(0)
    v_pk_add_f32 v[64:65], v[64:65], v[72:73]
    v_pk_add_f32 v[66:67], v[66:67], v[74:75]
    v_pk_add_f32 v[68:69], v[68:69], v[76:77]
    v_pk_add_f32 v[70:71], v[70:71], v[78:79]
    v_pk_add_f32 v[64:65], v[64:65], v[80:81]
    v_pk_add_f32 v[66:67], v[66:67], v[82:83]
    v_pk_add_f32 v[68:69], v[68:69], v[84:85]
    v_pk_add_f32 v[70:71], v[70:71], v[86:87]
    v_pk_add_f32 v[64:65], v[64:65], v[88:89]
    v_pk_add_f32 v[66:67], v[66:67], v[90:91]
    v_pk_add_f32 v[68:69], v[68:69], v[92:93]
    v_pk_add_f32 v[70:71], v[70:71], v[94:95]
    v_cvt_pk_bf16_f32 v10, v64, v65
    v_lshlrev_b32 v12, 16, v10
    v_and_b32 v13, 0xffff0000, v10
    v_lshlrev_b32 v14, 16, v224
    v_and_b32 v15, 0xffff0000, v224
    v_add_f32 v12, v12, v14
    v_add_f32 v13, v13, v15
    v_cvt_pk_bf16_f32 v128, v12, v13
    v_cvt_pk_bf16_f32 v10, v66, v67
    v_lshlrev_b32 v12, 16, v10
    v_and_b32 v13, 0xffff0000, v10
    v_lshlrev_b32 v14, 16, v225
    v_and_b32 v15, 0xffff0000, v225
    v_add_f32 v12, v12, v14
    v_add_f32 v13, v13, v15
    v_cvt_pk_bf16_f32 v129, v12, v13
    v_cvt_pk_bf16_f32 v10, v68, v69
    v_lshlrev_b32 v12, 16, v10
    v_and_b32 v13, 0xffff0000, v10
    v_lshlrev_b32 v14, 16, v226
    v_and_b32 v15, 0xffff0000, v226
    v_add_f32 v12, v12, v14
    v_add_f32 v13, v13, v15
    v_cvt_pk_bf16_f32 v130, v12, v13
    v_cvt_pk_bf16_f32 v10, v70, v71
    v_lshlrev_b32 v12, 16, v10
    v_and_b32 v13, 0xffff0000, v10
    v_lshlrev_b32 v14, 16, v227
    v_and_b32 v15, 0xffff0000, v227
    v_add_f32 v12, v12, v14
    v_add_f32 v13, v13, v15
    v_cvt_pk_bf16_f32 v131, v12, v13
    v_pk_add_f32 v[96:97], v[96:97], v[104:105]
    v_pk_add_f32 v[98:99], v[98:99], v[106:107]
    v_pk_add_f32 v[100:101], v[100:101], v[108:109]
    v_pk_add_f32 v[102:103], v[102:103], v[110:111]
    v_pk_add_f32 v[96:97], v[96:97], v[112:113]
    v_pk_add_f32 v[98:99], v[98:99], v[114:115]
    v_pk_add_f32 v[100:101], v[100:101], v[116:117]
    v_pk_add_f32 v[102:103], v[102:103], v[118:119]
    v_pk_add_f32 v[96:97], v[96:97], v[120:121]
    v_pk_add_f32 v[98:99], v[98:99], v[122:123]
    v_pk_add_f32 v[100:101], v[100:101], v[124:125]
    v_pk_add_f32 v[102:103], v[102:103], v[126:127]
    v_cvt_pk_bf16_f32 v10, v96, v97
    v_lshlrev_b32 v12, 16, v10
    v_and_b32 v13, 0xffff0000, v10
    v_lshlrev_b32 v14, 16, v228
    v_and_b32 v15, 0xffff0000, v228
    v_add_f32 v12, v12, v14
    v_add_f32 v13, v13, v15
    v_cvt_pk_bf16_f32 v132, v12, v13
    v_cvt_pk_bf16_f32 v10, v98, v99
    v_lshlrev_b32 v12, 16, v10
    v_and_b32 v13, 0xffff0000, v10
    v_lshlrev_b32 v14, 16, v229
    v_and_b32 v15, 0xffff0000, v229
    v_add_f32 v12, v12, v14
    v_add_f32 v13, v13, v15
    v_cvt_pk_bf16_f32 v133, v12, v13
    v_cvt_pk_bf16_f32 v10, v100, v101
    v_lshlrev_b32 v12, 16, v10
    v_and_b32 v13, 0xffff0000, v10
    v_lshlrev_b32 v14, 16, v230
    v_and_b32 v15, 0xffff0000, v230
    v_add_f32 v12, v12, v14
    v_add_f32 v13, v13, v15
    v_cvt_pk_bf16_f32 v134, v12, v13
    v_cvt_pk_bf16_f32 v10, v102, v103
    v_lshlrev_b32 v12, 16, v10
    v_and_b32 v13, 0xffff0000, v10
    v_lshlrev_b32 v14, 16, v231
    v_and_b32 v15, 0xffff0000, v231
    v_add_f32 v12, v12, v14
    v_add_f32 v13, v13, v15
    v_cvt_pk_bf16_f32 v135, v12, v13
    s_cmp_eq_u32 s20, 1
    s_cbranch_scc1 g2_outmode
    s_lshl_b32 s3, s21, 7
    s_add_u32 s3, s3, 0x200000
    s_add_u32 s4, s3, 131072
    buffer_store_dwordx4 v[128:131], v3, s[28:31], s3 offen
    buffer_store_dwordx4 v[132:135], v3, s[28:31], s4 offen
    s_barrier
    v_lshlrev_b32 v64, 16, v128
    v_and_b32 v65, 0xffff0000, v128
    v_lshlrev_b32 v66, 16, v129
    v_and_b32 v67, 0xffff0000, v129
    v_lshlrev_b32 v68, 16, v130
    v_and_b32 v69, 0xffff0000, v130
    v_lshlrev_b32 v70, 16, v131
    v_and_b32 v71, 0xffff0000, v131
    ds_write_b128 v9, v[64:67] offset:0
    ds_write_b128 v9, v[68:71] offset:16
    v_lshlrev_b32 v72, 16, v132
    v_and_b32 v73, 0xffff0000, v132
    v_lshlrev_b32 v74, 16, v133
    v_and_b32 v75, 0xffff0000, v133
    v_lshlrev_b32 v76, 16, v134
    v_and_b32 v77, 0xffff0000, v134
    v_lshlrev_b32 v78, 16, v135
    v_and_b32 v79, 0xffff0000, v135
    ds_write_b128 v9, v[72:75] offset:8704
    ds_write_b128 v9, v[76:79] offset:8720
    s_waitcnt lgkmcnt(0)
    s_barrier
    v_cmp_gt_u32 vcc, 64, v0
    s_and_saveexec_b64 s[42:43], vcc
    s_cbranch_execz g2_done
    v_lshlrev_b32 v10, 2, v0
    ds_read_b32 v64, v10 offset:0
    ds_read_b32 v65, v10 offset:272
    ds_read_b32 v66, v10 offset:544
    ds_read_b32 v67, v10 offset:816
    ds_read_b32 v68, v10 offset:1088
    ds_read_b32 v69, v10 offset:1360
    ds_read_b32 v70, v10 offset:1632
    ds_read_b32 v71, v10 offset:1904
    ds_read_b32 v72, v10 offset:2176
    ds_read_b32 v73, v10 offset:2448
    ds_read_b32 v74, v10 offset:2720
    ds_read_b32 v75, v10 offset:2992
    ds_read_b32 v76, v10 offset:3264
    ds_read_b32 v77, v10 offset:3536
    ds_read_b32 v78, v10 offset:3808
    ds_read_b32 v79, v10 offset:4080
    ds_read_b32 v80, v10 offset:4352
    ds_read_b32 v81, v10 offset:4624
    ds_read_b32 v82, v10 offset:4896
    ds_read_b32 v83, v10 offset:5168
    ds_read_b32 v84, v10 offset:5440
    ds_read_b32 v85, v10 offset:5712
    ds_read_b32 v86, v10 offset:5984
    ds_read_b32 v87, v10 offset:6256
    ds_read_b32 v88, v10 offset:6528
    ds_read_b32 v89, v10 offset:6800
    ds_read_b32 v90, v10 offset:7072
    ds_read_b32 v91, v10 offset:7344
    ds_read_b32 v92, v10 offset:7616
    ds_read_b32 v93, v10 offset:7888
    ds_read_b32 v94, v10 offset:8160
    ds_read_b32 v95, v10 offset:8432
    ds_read_b32 v96, v10 offset:8704
    ds_read_b32 v97, v10 offset:8976
    ds_read_b32 v98, v10 offset:9248
    ds_read_b32 v99, v10 offset:9520
    ds_read_b32 v100, v10 offset:9792
    ds_read_b32 v101, v10 offset:10064
    ds_read_b32 v102, v10 offset:10336
    ds_read_b32 v103, v10 offset:10608
    ds_read_b32 v104, v10 offset:10880
    ds_read_b32 v105, v10 offset:11152
    ds_read_b32 v106, v10 offset:11424
    ds_read_b32 v107, v10 offset:11696
    ds_read_b32 v108, v10 offset:11968
    ds_read_b32 v109, v10 offset:12240
    ds_read_b32 v110, v10 offset:12512
    ds_read_b32 v111, v10 offset:12784
    ds_read_b32 v112, v10 offset:13056
    ds_read_b32 v113, v10 offset:13328
    ds_read_b32 v114, v10 offset:13600
    ds_read_b32 v115, v10 offset:13872
    ds_read_b32 v116, v10 offset:14144
    ds_read_b32 v117, v10 offset:14416
    ds_read_b32 v118, v10 offset:14688
    ds_read_b32 v119, v10 offset:14960
    ds_read_b32 v120, v10 offset:15232
    ds_read_b32 v121, v10 offset:15504
    ds_read_b32 v122, v10 offset:15776
    ds_read_b32 v123, v10 offset:16048
    ds_read_b32 v124, v10 offset:16320
    ds_read_b32 v125, v10 offset:16592
    ds_read_b32 v126, v10 offset:16864
    ds_read_b32 v127, v10 offset:17136
    s_waitcnt lgkmcnt(0)
    v_add_f32 v128, v64, v65
    v_add_f32 v129, v66, v67
    v_add_f32 v130, v68, v69
    v_add_f32 v131, v70, v71
    v_add_f32 v132, v72, v73
    v_add_f32 v133, v74, v75
    v_add_f32 v134, v76, v77
    v_add_f32 v135, v78, v79
    v_add_f32 v136, v80, v81
    v_add_f32 v137, v82, v83
    v_add_f32 v138, v84, v85
    v_add_f32 v139, v86, v87
    v_add_f32 v140, v88, v89
    v_add_f32 v141, v90, v91
    v_add_f32 v142, v92, v93
    v_add_f32 v143, v94, v95
    v_add_f32 v144, v96, v97
    v_add_f32 v145, v98, v99
    v_add_f32 v146, v100, v101
    v_add_f32 v147, v102, v103
    v_add_f32 v148, v104, v105
    v_add_f32 v149, v106, v107
    v_add_f32 v150, v108, v109
    v_add_f32 v151, v110, v111
    v_add_f32 v152, v112, v113
    v_add_f32 v153, v114, v115
    v_add_f32 v154, v116, v117
    v_add_f32 v155, v118, v119
    v_add_f32 v156, v120, v121
    v_add_f32 v157, v122, v123
    v_add_f32 v158, v124, v125
    v_add_f32 v159, v126, v127
    v_add_f32 v128, v128, v144
    v_add_f32 v129, v129, v145
    v_add_f32 v130, v130, v146
    v_add_f32 v131, v131, v147
    v_add_f32 v132, v132, v148
    v_add_f32 v133, v133, v149
    v_add_f32 v134, v134, v150
    v_add_f32 v135, v135, v151
    v_add_f32 v136, v136, v152
    v_add_f32 v137, v137, v153
    v_add_f32 v138, v138, v154
    v_add_f32 v139, v139, v155
    v_add_f32 v140, v140, v156
    v_add_f32 v141, v141, v157
    v_add_f32 v142, v142, v158
    v_add_f32 v143, v143, v159
    v_add_f32 v128, v128, v136
    v_add_f32 v129, v129, v137
    v_add_f32 v130, v130, v138
    v_add_f32 v131, v131, v139
    v_add_f32 v132, v132, v140
    v_add_f32 v133, v133, v141
    v_add_f32 v134, v134, v142
    v_add_f32 v135, v135, v143
    v_add_f32 v128, v128, v132
    v_add_f32 v129, v129, v133
    v_add_f32 v130, v130, v134
    v_add_f32 v131, v131, v135
    v_add_f32 v128, v128, v130
    v_add_f32 v129, v129, v131
    v_add_f32 v128, v128, v129
    v_mul_f32 v128, 0x3c800000, v128
    v_sub_f32 v11, v64, v128
    v_mul_f32 v129, v11, v11
    v_sub_f32 v11, v65, v128
    v_fma_f32 v129, v11, v11, v129
    v_sub_f32 v11, v66, v128
    v_fma_f32 v129, v11, v11, v129
    v_sub_f32 v11, v67, v128
    v_fma_f32 v129, v11, v11, v129
    v_sub_f32 v11, v68, v128
    v_fma_f32 v129, v11, v11, v129
    v_sub_f32 v11, v69, v128
    v_fma_f32 v129, v11, v11, v129
    v_sub_f32 v11, v70, v128
    v_fma_f32 v129, v11, v11, v129
    v_sub_f32 v11, v71, v128
    v_fma_f32 v129, v11, v11, v129
    v_sub_f32 v11, v72, v128
    v_fma_f32 v129, v11, v11, v129
    v_sub_f32 v11, v73, v128
    v_fma_f32 v129, v11, v11, v129
    v_sub_f32 v11, v74, v128
    v_fma_f32 v129, v11, v11, v129
    v_sub_f32 v11, v75, v128
    v_fma_f32 v129, v11, v11, v129
    v_sub_f32 v11, v76, v128
    v_fma_f32 v129, v11, v11, v129
    v_sub_f32 v11, v77, v128
    v_fma_f32 v129, v11, v11, v129
    v_sub_f32 v11, v78, v128
    v_fma_f32 v129, v11, v11, v129
    v_sub_f32 v11, v79, v128
    v_fma_f32 v129, v11, v11, v129
    v_sub_f32 v11, v80, v128
    v_fma_f32 v129, v11, v11, v129
    v_sub_f32 v11, v81, v128
    v_fma_f32 v129, v11, v11, v129
    v_sub_f32 v11, v82, v128
    v_fma_f32 v129, v11, v11, v129
    v_sub_f32 v11, v83, v128
    v_fma_f32 v129, v11, v11, v129
    v_sub_f32 v11, v84, v128
    v_fma_f32 v129, v11, v11, v129
    v_sub_f32 v11, v85, v128
    v_fma_f32 v129, v11, v11, v129
    v_sub_f32 v11, v86, v128
    v_fma_f32 v129, v11, v11, v129
    v_sub_f32 v11, v87, v128
    v_fma_f32 v129, v11, v11, v129
    v_sub_f32 v11, v88, v128
    v_fma_f32 v129, v11, v11, v129
    v_sub_f32 v11, v89, v128
    v_fma_f32 v129, v11, v11, v129
    v_sub_f32 v11, v90, v128
    v_fma_f32 v129, v11, v11, v129
    v_sub_f32 v11, v91, v128
    v_fma_f32 v129, v11, v11, v129
    v_sub_f32 v11, v92, v128
    v_fma_f32 v129, v11, v11, v129
    v_sub_f32 v11, v93, v128
    v_fma_f32 v129, v11, v11, v129
    v_sub_f32 v11, v94, v128
    v_fma_f32 v129, v11, v11, v129
    v_sub_f32 v11, v95, v128
    v_fma_f32 v129, v11, v11, v129
    v_sub_f32 v11, v96, v128
    v_fma_f32 v129, v11, v11, v129
    v_sub_f32 v11, v97, v128
    v_fma_f32 v129, v11, v11, v129
    v_sub_f32 v11, v98, v128
    v_fma_f32 v129, v11, v11, v129
    v_sub_f32 v11, v99, v128
    v_fma_f32 v129, v11, v11, v129
    v_sub_f32 v11, v100, v128
    v_fma_f32 v129, v11, v11, v129
    v_sub_f32 v11, v101, v128
    v_fma_f32 v129, v11, v11, v129
    v_sub_f32 v11, v102, v128
    v_fma_f32 v129, v11, v11, v129
    v_sub_f32 v11, v103, v128
    v_fma_f32 v129, v11, v11, v129
    v_sub_f32 v11, v104, v128
    v_fma_f32 v129, v11, v11, v129
    v_sub_f32 v11, v105, v128
    v_fma_f32 v129, v11, v11, v129
    v_sub_f32 v11, v106, v128
    v_fma_f32 v129, v11, v11, v129
    v_sub_f32 v11, v107, v128
    v_fma_f32 v129, v11, v11, v129
    v_sub_f32 v11, v108, v128
    v_fma_f32 v129, v11, v11, v129
    v_sub_f32 v11, v109, v128
    v_fma_f32 v129, v11, v11, v129
    v_sub_f32 v11, v110, v128
    v_fma_f32 v129, v11, v11, v129
    v_sub_f32 v11, v111, v128
    v_fma_f32 v129, v11, v11, v129
    v_sub_f32 v11, v112, v128
    v_fma_f32 v129, v11, v11, v129
    v_sub_f32 v11, v113, v128
    v_fma_f32 v129, v11, v11, v129
    v_sub_f32 v11, v114, v128
    v_fma_f32 v129, v11, v11, v129
    v_sub_f32 v11, v115, v128
    v_fma_f32 v129, v11, v11, v129
    v_sub_f32 v11, v116, v128
    v_fma_f32 v129, v11, v11, v129
    v_sub_f32 v11, v117, v128
    v_fma_f32 v129, v11, v11, v129
    v_sub_f32 v11, v118, v128
    v_fma_f32 v129, v11, v11, v129
    v_sub_f32 v11, v119, v128
    v_fma_f32 v129, v11, v11, v129
    v_sub_f32 v11, v120, v128
    v_fma_f32 v129, v11, v11, v129
    v_sub_f32 v11, v121, v128
    v_fma_f32 v129, v11, v11, v129
    v_sub_f32 v11, v122, v128
    v_fma_f32 v129, v11, v11, v129
    v_sub_f32 v11, v123, v128
    v_fma_f32 v129, v11, v11, v129
    v_sub_f32 v11, v124, v128
    v_fma_f32 v129, v11, v11, v129
    v_sub_f32 v11, v125, v128
    v_fma_f32 v129, v11, v11, v129
    v_sub_f32 v11, v126, v128
    v_fma_f32 v129, v11, v11, v129
    v_sub_f32 v11, v127, v128
    v_fma_f32 v129, v11, v11, v129
    s_lshl_b32 s3, s22, 13
    s_lshl_b32 s4, s21, 8
    s_add_u32 s3, s3, s4
    s_add_u32 s3, s3, 0x1020000
    s_add_u32 s4, s3, 0x10000
    buffer_store_dword v128, v10, s[28:31], s3 offen
    buffer_store_dword v129, v10, s[28:31], s4 offen
    s_branch g2_done
g2_outmode:
    s_mov_b32 s24, s8
    s_mov_b32 s25, s9
    s_mov_b32 s26, 0x200000
    s_mov_b32 s27, 0x00020000
    s_barrier
    v_mul_u32_u24 v10, 1152, v2
    v_lshl_add_u32 v10, v1, 1, v10
    ds_write_b16 v10, v128 offset:0
    ds_write_b16_d16_hi v10, v128 offset:144
    ds_write_b16 v10, v129 offset:288
    ds_write_b16_d16_hi v10, v129 offset:432
    ds_write_b16 v10, v130 offset:576
    ds_write_b16_d16_hi v10, v130 offset:720
    ds_write_b16 v10, v131 offset:864
    ds_write_b16_d16_hi v10, v131 offset:1008
    ds_write_b16 v10, v132 offset:64
    ds_write_b16_d16_hi v10, v132 offset:208
    ds_write_b16 v10, v133 offset:352
    ds_write_b16_d16_hi v10, v133 offset:496
    ds_write_b16 v10, v134 offset:640
    ds_write_b16_d16_hi v10, v134 offset:784
    ds_write_b16 v10, v135 offset:928
    ds_write_b16_d16_hi v10, v135 offset:1072
    s_waitcnt lgkmcnt(0)
    s_barrier
    v_mul_u32_u24 v10, 144, v1
    v_lshl_add_u32 v10, v2, 4, v10
    ds_read_b128 v[64:67], v10
    ds_read_b128 v[68:71], v10 offset:4608
    v_lshlrev_b32 v11, 10, v1
    v_lshl_add_u32 v11, v2, 4, v11
    s_lshl_b32 s3, s21, 16
    s_lshl_b32 s4, s22, 7
    s_add_u32 s3, s3, s4
    s_add_u32 s4, s3, 32768
    s_waitcnt lgkmcnt(0)
    buffer_store_dwordx4 v[64:67], v11, s[24:27], s3 offen
    buffer_store_dwordx4 v[68:71], v11, s[24:27], s4 offen
g2_done:
    s_endpgm
.section .rodata,"a"
.p2align 6
.amdhsa_kernel kgen_kernel
  .amdhsa_next_free_vgpr 128
  .amdhsa_next_free_sgpr 102
  .amdhsa_accum_offset 128
  .amdhsa_group_segment_fixed_size 0
  .amdhsa_kernarg_size 128
  .amdhsa_user_sgpr_count 2
  .amdhsa_user_sgpr_kernarg_segment_ptr 1
  .amdhsa_system_sgpr_workgroup_id_x 1
.end_amdhsa_kernel
.p2align 6
.amdhsa_kernel conva_kernel
  .amdhsa_next_free_vgpr 248
  .amdhsa_next_free_sgpr 102
  .amdhsa_accum_offset 248
  .amdhsa_group_segment_fixed_size 0
  .amdhsa_kernarg_size 128
  .amdhsa_user_sgpr_count 2
  .amdhsa_user_sgpr_kernarg_segment_ptr 1
  .amdhsa_system_sgpr_workgroup_id_x 1
.end_amdhsa_kernel
.p2align 6
.amdhsa_kernel convb_kernel
  .amdhsa_next_free_vgpr 248
  .amdhsa_next_free_sgpr 102
  .amdhsa_accum_offset 248
  .amdhsa_group_segment_fixed_size 0
  .amdhsa_kernarg_size 128
  .amdhsa_user_sgpr_count 2
  .amdhsa_user_sgpr_kernarg_segment_ptr 1
  .amdhsa_system_sgpr_workgroup_id_x 1
.end_amdhsa_kernel
.p2align 6
.amdhsa_kernel gemm1a_kernel
  .amdhsa_next_free_vgpr 256
  .amdhsa_next_free_sgpr 102
  .amdhsa_accum_offset 256
  .amdhsa_group_segment_fixed_size 0
  .amdhsa_kernarg_size 128
  .amdhsa_user_sgpr_count 2
  .amdhsa_user_sgpr_kernarg_segment_ptr 1
  .amdhsa_system_sgpr_workgroup_id_x 1
.end_amdhsa_kernel
.p2align 6
.amdhsa_kernel gemm1b_kernel
  .amdhsa_next_free_vgpr 256
  .amdhsa_next_free_sgpr 102
  .amdhsa_accum_offset 256
  .amdhsa_group_segment_fixed_size 0
  .amdhsa_kernarg_size 128
  .amdhsa_user_sgpr_count 2
  .amdhsa_user_sgpr_kernarg_segment_ptr 1
  .amdhsa_system_sgpr_workgroup_id_x 1
.end_amdhsa_kernel
.p2align 6
.amdhsa_kernel gemm2a_kernel
  .amdhsa_next_free_vgpr 232
  .amdhsa_next_free_sgpr 102
  .amdhsa_accum_offset 232
  .amdhsa_group_segment_fixed_size 0
  .amdhsa_kernarg_size 128
  .amdhsa_user_sgpr_count 2
  .amdhsa_user_sgpr_kernarg_segment_ptr 1
  .amdhsa_system_sgpr_workgroup_id_x 1
.end_amdhsa_kernel
.p2align 6
.amdhsa_kernel gemm2b_kernel
  .amdhsa_next_free_vgpr 232
  .amdhsa_next_free_sgpr 102
  .amdhsa_accum_offset 232
  .amdhsa_group_segment_fixed_size 0
  .amdhsa_kernarg_size 128
  .amdhsa_user_sgpr_count 2
  .amdhsa_user_sgpr_kernarg_segment_ptr 1
  .amdhsa_system_sgpr_workgroup_id_x 1
.end_amdhsa_kernel
```
